```python
import torch

def _softmax(x, axis=-1):
    return torch.softmax(x, dim=axis)
def _gelu(x):
    return torch.nn.functional.gelu(x, approximate="tanh")
def _silu(x):
    return torch.nn.functional.silu(x)
def _sigmoid(x):
    return torch.sigmoid(x)
def _layernorm(x, axis=-1, eps=1e-5):
    m = x.mean(dim=axis, keepdim=True)
    v = x.var(dim=axis, keepdim=True, unbiased=False)
    return (x - m) / torch.sqrt(v + eps)
def _scatter_add(tgt, idx, src, axis=0):
    return tgt.clone().index_add_(axis, idx, src)
def _segment_sum(src, seg, n):
    out = torch.zeros((n,) + src.shape[1:], dtype=src.dtype)
    return out.index_add_(0, seg, src)
def _pad(x, pw):
    flat = tuple(v for pair in reversed(pw) for v in pair)
    return torch.nn.functional.pad(x, flat)

kernel_name = 'gated_mix__linear_kernel_hedgehog__grouped_kv_mqa__prompt'

def setup_inputs():

    _w = (lambda a: (lambda t: t.to(torch.bfloat16) if t.is_floating_point() else t)(torch.as_tensor(a)))
    def _A_setup():
        B, S, D, H = 1, 2048, 576, 32
        Dh = D // H
        return {
            "x": _w((lambda *s: torch.randn(*s, dtype=torch.bfloat16) * 0.05)(B, S, D)),
            "wqkv": _w((lambda *s: torch.randn(*s, dtype=torch.bfloat16) * 1.6)(D, 3 * D)),
            "w_phi": _w((lambda *s: torch.randn(*s, dtype=torch.bfloat16) * 1.6)(H, Dh, Dh) * (Dh ** -0.5)),
            "wo": _w((lambda *s: torch.randn(*s, dtype=torch.bfloat16) * 0.05)(D, D)),
        }
    _A_in = _A_setup()

    def _B_setup():
        B, S, D, H = 1, 2048, 576, 32
        Dh = D // H
        return {
            "x": _w((lambda *s: torch.randn(*s, dtype=torch.bfloat16) * 0.05)(B, S, D)),
            "wq": _w((lambda *s: torch.randn(*s, dtype=torch.bfloat16) * 1.6)(D, H * Dh)),
            "wk": _w((lambda *s: torch.randn(*s, dtype=torch.bfloat16) * 1.6)(D, Dh)),
            "wv": _w((lambda *s: torch.randn(*s, dtype=torch.bfloat16) * 0.05)(D, Dh)),
            "wo": _w((lambda *s: torch.randn(*s, dtype=torch.bfloat16) * 0.05)(H * Dh, D)),
        }
    _B_in = _B_setup()

    return {
        "A_x": _A_in["x"],
        "A_wqkv": _A_in["wqkv"],
        "A_w_phi": _A_in["w_phi"],
        "A_wo": _A_in["wo"],
        "B_x": _B_in["x"],
        "B_wq": _B_in["wq"],
        "B_wk": _B_in["wk"],
        "B_wv": _B_in["wv"],
        "B_wo": _B_in["wo"],
        "gate_w": _w((lambda *s: torch.randn(*s, dtype=torch.bfloat16) * 0.05)(576) * 16.0),
    }

def reference(A_x, A_wqkv, A_w_phi, A_wo, B_x, B_wq, B_wk, B_wv, B_wo, gate_w):
    def _A_ref(x, wqkv, w_phi, wo):
        B, S, D = x.shape
        H = 32; Dh = D // H
        qkv = (lambda x, *d: x.permute(*d))((x @ wqkv).reshape(B, S, 3, H, Dh), 2, 0, 3, 1, 4)
        q, k, v = qkv[0], qkv[1], qkv[2]
        pq = torch.einsum("bhsd,hdf->bhsf", q, w_phi)
        pk = torch.einsum("bhsd,hdf->bhsf", k, w_phi)
        phi_q = torch.concatenate([_softmax(pq, axis=-1), _softmax(-pq, axis=-1)], axis=-1)
        phi_k = torch.concatenate([_softmax(pk, axis=-1), _softmax(-pk, axis=-1)], axis=-1)
        kv = torch.einsum("bhsf,bhsd->bhfd", phi_k, v)
        z  = torch.einsum("bhsf->bhf", phi_k)
        num = torch.einsum("bhqf,bhfd->bhqd", phi_q, kv)
        den = torch.einsum("bhqf,bhf->bhq", phi_q, z)[..., None] + 1e-6
        o = num / den
        return (lambda x, *d: x.permute(*d))(o, 0, 2, 1, 3).reshape(B, S, D) @ wo

    def _B_ref(x, wq, wk, wv, wo):
        B, S, D = x.shape
        H = 32
        Dh = D // H
        q = (lambda x, *d: x.permute(*d))((x @ wq).reshape(B, S, H, Dh), 0, 2, 1, 3)
        k = x @ wk
        v = x @ wv
        scores = torch.einsum("bhqd,bkd->bhqk", q, k) * (Dh ** -0.5)
        p = _softmax(scores, axis=-1)
        o = torch.einsum("bhqk,bkd->bhqd", p, v)
        return (lambda x, *d: x.permute(*d))(o, 0, 2, 1, 3).reshape(B, S, H * Dh) @ wo

    x = A_x
    g = _sigmoid((x * gate_w).sum(-1, keepdims=True))
    a = _A_ref(x, A_wqkv, A_w_phi, A_wo)
    b = _B_ref(x, B_wq, B_wk, B_wv, B_wo)
    return g * a + (1 - g) * b
```

```asm
; @launch grid=(256,1,1) block=(512,1,1) lds=163840
.amdgcn_target "amdgcn-amd-amdhsa--gfx950"
.text
.globl gated_mix__linear_kernel_hedgehog__grouped_kv_mqa__prompt_kernel
.p2align 8
.type gated_mix__linear_kernel_hedgehog__grouped_kv_mqa__prompt_kernel,@function
gated_mix__linear_kernel_hedgehog__grouped_kv_mqa__prompt_kernel:
    s_cmp_ge_u32 s2, 256
    s_cbranch_scc1 L_end
    s_load_dwordx16 s[16:31], s[0:1], 0
    s_load_dwordx8 s[32:39], s[0:1], 64
    s_load_dwordx2 s[40:41], s[0:1], 96
    v_lshrrev_b32 v32, 6, v0
    v_and_b32 v1, 63, v0
    v_readfirstlane_b32 s4, v32
    s_and_b32 s12, s2, 7
    s_lshr_b32 s13, s2, 3
    s_lshr_b32 s14, s12, 1
    s_lshl_b32 s14, s14, 2
    s_and_b32 s15, s13, 3
    s_add_u32 s5, s14, s15
    s_and_b32 s12, s12, 1
    s_lshr_b32 s13, s13, 2
    s_mov_b32 s80, s13
    s_and_b32 s7, s13, 1
    s_lshr_b32 s14, s13, 1
    s_lshl_b32 s15, s12, 2
    s_add_u32 s6, s14, s15
    s_mov_b32 s7, s12
    s_mov_b32 s6, s13
    s_lshr_b32 s12, s13, 2
    s_xor_b32 s14, s7, s12
    s_lshl_b32 s8, s6, 1
    s_add_u32 s8, s8, s14
    s_and_b32 s15, s5, 3
    s_lshl_b32 s15, s15, 1
    s_add_u32 s72, s13, s15
    s_cmp_ge_u32 s72, 9
    s_cselect_b32 s15, 9, 0
    s_sub_u32 s72, s72, s15
    s_and_b32 s10, s4, 3
    s_lshr_b32 s11, s4, 2
    v_lshrrev_b32 v38, 4, v1
    v_and_b32 v39, 7, v1
    v_xor_b32 v39, v39, v38
    v_lshrrev_b32 v2, 3, v1
    v_mul_u32_u24 v2, 1152, v2
    v_lshl_add_u32 v3, v39, 4, v2
    v_xor_b32 v39, 4, v39
    v_lshl_add_u32 v2, v39, 4, v2
    v_add_u32 v2, 9216, v2
    s_mov_b32 s46, 2359296
    s_mov_b32 s47, 0x00020000
    s_mov_b32 s50, 1990656
    s_mov_b32 s51, 0x00020000
    s_lshl_b32 s12, s5, 3
    s_add_u32 s12, s12, s4
    s_mul_i32 s73, s12, 18432
    s_mul_i32 s74, s6, 144
    s_cmp_eq_u32 s7, 0
    s_cselect_b32 s12, 1152, 0
    s_add_u32 s74, s74, s12
    s_lshl_b32 s78, s4, 10
    s_lshl_b32 s79, s4, 11
    v_mul_u32_u24 v48, 57, v0
    v_lshrrev_b32 v48, 9, v48
    v_mul_u32_u24 v49, 9, v48
    v_sub_u32 v49, v0, v49
    v_and_b32 v50, 3, v48
    v_bfe_u32 v4, v48, 2, 2
    v_lshl_or_b32 v4, v50, 2, v4
    v_and_b32 v50, 48, v48
    v_or_b32 v4, v4, v50
    v_mul_u32_u24 v4, 3456, v4
    v_lshl_add_u32 v4, v49, 4, v4
    s_waitcnt lgkmcnt(0)
    s_mov_b32 s44, s16
    s_mov_b32 s45, s17
    s_mov_b32 s48, s18
    s_mov_b32 s49, s19
    s_lshl_b32 s68, s72, 7
    s_add_u32 m0, s79, 0
    s_add_u32 s68, s68, s73
    buffer_load_dwordx4 v3, s[44:47], s68 offen lds
    s_add_u32 m0, s79, 1024
    s_mul_i32 s69, s72, 221184
    buffer_load_dwordx4 v2, s[44:47], s68 offen lds
    s_add_u32 m0, s78, 49152
    s_add_u32 s69, s69, s74
    buffer_load_dwordx4 v4, s[48:51], s69 offen lds
    s_cmp_eq_u32 s7, 1
    s_cbranch_scc1 L_d1
    s_add_u32 m0, s78, 58400
    s_add_u32 s69, s69, 1152
    buffer_load_dwordx4 v4, s[48:51], s69 offen lds
L_d1:
    s_load_dword s42, s[40:41], 0
    s_lshl_b32 s12, s4, 6
    s_sub_u32 s12, s12, 128
    s_mov_b32 s13, 13108
    s_mov_b32 s14, 5
    s_movk_i32 s15, 1152
    s_mul_i32 s75, s8, 72
    s_add_u32 s77, s78, 65616
    s_mov_b32 s54, 663552
    s_cmp_eq_u32 s4, 7
    s_cselect_b32 s12, 0, s12
    s_cselect_b32 s13, 65536, s13
    s_cselect_b32 s14, 1, s14
    s_cselect_b32 s15, 2, s15
    s_cselect_b32 s75, 0, s75
    s_cselect_b32 s54, 1168, s54
    s_cselect_b32 s52, s34, s26
    s_cselect_b32 s53, s35, s27
    s_mul_i32 s43, s4, 1152
    s_add_u32 s43, s43, s74
    s_mul_i32 s3, s4, 9248
    s_add_u32 s3, s3, 57344
    s_cmp_lt_u32 s4, 2
    s_cselect_b32 s12, 512, s12
    s_cselect_b32 s13, 7282, s13
    s_cselect_b32 s14, 9, s14
    s_cselect_b32 s15, 3456, s15
    s_cselect_b32 s75, s43, s75
    s_cselect_b32 s77, s3, s77
    s_cselect_b32 s54, s50, s54
    s_cselect_b32 s52, s18, s52
    s_cselect_b32 s53, s19, s53
    s_cselect_b32 s3, 128, 56
    s_cmp_ge_u32 s6, 3
    s_cselect_b32 s43, 3, 0
    s_cselect_b32 s56, s30, s28
    s_cselect_b32 s57, s31, s29
    s_sub_u32 s43, s6, s43
    s_lshl_b32 s43, s43, 4
    s_cmp_ge_u32 s6, 6
    s_cselect_b32 s58, 0, 20736
    s_lshl_b32 s59, s4, 1
    s_or_b32 s59, s59, s7
    s_cmp_eq_u32 s59, 3
    s_cselect_b32 s12, 0, s12
    s_cselect_b32 s13, 65536, s13
    s_cselect_b32 s14, 1, s14
    s_cselect_b32 s15, 36, s15
    s_cselect_b32 s75, s43, s75
    s_cselect_b32 s77, 58400, s77
    s_cselect_b32 s54, s58, s54
    s_cselect_b32 s52, s56, s52
    s_cselect_b32 s53, s57, s53
    s_mov_b32 s55, 0x00020000
    s_lshl_b32 s76, s15, 6
    v_add_u32 v51, s12, v1
    v_mul_u32_u24 v48, s13, v51
    v_lshrrev_b32 v48, 16, v48
    v_mul_u32_u24 v49, s14, v48
    v_sub_u32 v49, v51, v49
    v_lshlrev_b32 v49, 4, v49
    v_min_u32 v49, s3, v49
    v_and_b32 v50, 3, v48
    v_bfe_u32 v5, v48, 2, 2
    v_lshl_or_b32 v5, v50, 2, v5
    v_and_b32 v50, 48, v48
    v_or_b32 v5, v5, v50
    v_mad_u32_u24 v5, v5, s15, v49
    s_mul_i32 s14, s72, s76
    s_add_u32 m0, s77, 0
    s_add_u32 s14, s14, s75
    buffer_load_dwordx4 v5, s[52:55], s14 offen lds
    s_add_u32 s72, s72, 1
    s_cmp_ge_u32 s72, 9
    s_cselect_b32 s72, 0, s72
    v_mul_u32_u24 v32, 171, v0
    v_lshrrev_b32 v32, 9, v32
    v_mul_u32_u24 v32, 3, v32
    v_sub_u32 v32, v0, v32
    v_mul_u32_u24 v33, 12, v0
    v_lshl_add_u32 v34, v32, 2, v33
    s_nop 0
    s_mov_b32 s60, s40
    s_mov_b32 s61, s41
    s_mov_b32 s62, 10485760
    s_mov_b32 s63, 0x00020000
    v_lshlrev_b32 v253, 4, v1
    s_mov_b32 s81, 0
    s_cmp_eq_u32 s11, 1
    s_cbranch_scc1 L_m2
    s_mov_b32 s64, s20
    s_mov_b32 s65, s21
    s_mov_b32 s66, 20736
    s_mov_b32 s67, 0x00020000
    s_add_u32 m0, s78, 154624
    s_mul_i32 s15, s6, 2592
    buffer_load_dwordx4 v34, s[64:67], s15 offen lds
    s_lshl_b32 s68, s72, 7
    s_add_u32 m0, s79, 16384
    s_add_u32 s68, s68, s73
    buffer_load_dwordx4 v3, s[44:47], s68 offen lds
    s_add_u32 m0, s79, 17408
    s_mul_i32 s69, s72, 221184
    buffer_load_dwordx4 v2, s[44:47], s68 offen lds
    s_add_u32 m0, s78, 73808
    s_add_u32 s69, s69, s74
    buffer_load_dwordx4 v4, s[48:51], s69 offen lds
    s_cmp_eq_u32 s7, 1
    s_cbranch_scc1 L_d3
    s_add_u32 m0, s78, 83056
    s_add_u32 s69, s69, 1152
    buffer_load_dwordx4 v4, s[48:51], s69 offen lds
L_d3:
    s_mul_i32 s14, s72, s76
    s_add_u32 m0, s77, 24656
    s_add_u32 s14, s14, s75
    buffer_load_dwordx4 v5, s[52:55], s14 offen lds
    s_add_u32 s72, s72, 1
    s_cmp_ge_u32 s72, 9
    s_cselect_b32 s72, 0, s72
L_m2:
    v_mov_b32 v33, 0
    v_lshlrev_b32 v32, 2, v0
    v_add_u32 v32, 161792, v32
    ds_write_b32 v32, v33
    v_and_b32 v32, 31, v1
    v_lshrrev_b32 v33, 5, v1
    v_bfe_u32 v34, v1, 1, 3
    v_xor_b32 v34, v34, v33
    v_lshlrev_b32 v34, 4, v34
    v_lshl_add_u32 v34, v32, 7, v34
    s_lshl_b32 s12, s10, 12
    v_add_u32 v6, s12, v34
    v_xor_b32 v7, 32, v6
    v_xor_b32 v8, 64, v6
    v_xor_b32 v9, 96, v6
    v_lshlrev_b32 v246, 15, v33
    v_lshl_or_b32 v245, v32, 4, v246
    v_lshlrev_b32 v246, 2, v1
    v_bfe_u32 v34, v1, 2, 2
    v_lshlrev_b32 v34, 1, v34
    v_add_u32 v34, v34, v33
    v_lshlrev_b32 v34, 1, v34
    v_bfe_u32 v35, v1, 4, 1
    v_and_b32 v36, 3, v1
    v_lshl_add_u32 v35, v35, 2, v36
    s_mul_i32 s12, s11, 72
    s_add_u32 s12, s12, 49152
    v_mul_u32_u24 v10, 144, v34
    v_lshl_add_u32 v10, v35, 3, v10
    v_add_u32 v10, s12, v10
    s_mul_i32 s13, s11, 40
    s_add_u32 s13, s13, 67648
    v_lshl_add_u32 v36, v35, 3, s13
    v_mov_b32 v37, 80
    s_lshl_b32 s14, s11, 3
    v_add_u32 v38, s14, v36
    v_cmp_le_u32 vcc, 4, v35
    v_mov_b32 v39, 67696
    s_add_u32 s12, s12, 64
    v_cndmask_b32 v36, v36, v38, vcc
    v_cmp_eq_u32 vcc, 1, v35
    v_mov_b32 v38, s12
    v_add_u32 v28, 9248, v10
    v_cndmask_b32 v36, v36, v39, vcc
    v_cmp_eq_u32 vcc, 0, v35
    v_mov_b32 v39, 144
    s_add_u32 s12, s12, 9248
    s_mul_i32 s13, s11, 14384
    s_sub_u32 s13, 72784, s13
    s_cmp_eq_u32 s7, 1
    s_cselect_b32 s12, s13, s12
    s_cselect_b32 s14, 16, 144
    v_cndmask_b32 v36, v36, v38, vcc
    v_cndmask_b32 v37, v37, v39, vcc
    v_mov_b32 v40, s12
    v_mov_b32 v39, s14
    v_cmp_eq_u32 vcc, 6, v35
    v_and_b32 v254, 15, v1
    s_lshl_b32 s13, s7, 3
    s_add_u32 s12, s12, s13
    s_cmp_eq_u32 s11, 0
    s_cselect_b32 s12, 72784, s12
    s_cselect_b32 s14, 16, s14
    v_cndmask_b32 v36, v36, v40, vcc
    v_cndmask_b32 v37, v37, v39, vcc
    v_mov_b32 v40, s12
    v_mov_b32 v39, s14
    v_cmp_eq_u32 vcc, 7, v35
    v_min_u32 v31, 47, v1
    s_cmp_lg_u32 s4, 0
    s_cselect_b32 s15, 49, 63
    v_and_b32 v31, s15, v31
    v_lshl_add_u32 v31, s4, 1, v31
    v_mul_u32_u24 v31, 64, v31
    v_lshlrev_b32 v254, 2, v254
    v_cndmask_b32 v36, v36, v40, vcc
    v_cndmask_b32 v37, v37, v39, vcc
    s_mov_b32 s83, 49152
    s_mov_b32 s43, 52224
    v_mad_u32_u24 v11, v34, v37, v36
    v_mad_u32_u24 v12, v37, 1, v11
    v_mad_u32_u24 v13, v37, 16, v11
    v_mad_u32_u24 v14, v37, 17, v11
    v_mad_u32_u24 v15, v37, 32, v11
    v_mad_u32_u24 v16, v37, 33, v11
    v_mad_u32_u24 v17, v37, 48, v11
    v_mad_u32_u24 v18, v37, 49, v11
    v_bfe_u32 v34, v1, 2, 2
    v_lshl_add_u32 v34, v33, 2, v34
    v_and_b32 v36, 1, v35
    v_lshrrev_b32 v37, 1, v35
    v_mul_u32_u24 v38, 48, v34
    v_lshl_add_u32 v38, v37, 3, v38
    s_mul_i32 s12, s11, 1728
    s_add_u32 s12, s12, 154624
    v_add_u32 v38, s12, v38
    v_mul_u32_u24 v36, 18, v36
    v_sub_u32 v34, v34, v36
    v_mov_b32 v39, 161792
    v_add_u32 v36, 0, v34
    v_cmp_gt_u32 vcc, 18, v36
    v_add_u32 v37, 0, v38
    v_mov_b32 v216, 0
    v_cndmask_b32 v22, v39, v37, vcc
    v_add_u32 v36, 8, v34
    v_cmp_gt_u32 vcc, 18, v36
    v_add_u32 v37, 384, v38
    v_mov_b32 v217, 0
    v_cndmask_b32 v23, v39, v37, vcc
    v_add_u32 v36, 16, v34
    v_cmp_gt_u32 vcc, 18, v36
    v_add_u32 v37, 768, v38
    v_mov_b32 v216, 0
    v_cndmask_b32 v24, v39, v37, vcc
    v_add_u32 v36, 24, v34
    v_cmp_gt_u32 vcc, 18, v36
    v_add_u32 v37, 1152, v38
    v_mov_b32 v217, 0
    v_cndmask_b32 v25, v39, v37, vcc
    v_add_u32 v36, 32, v34
    v_cmp_gt_u32 vcc, 18, v36
    v_add_u32 v37, 1536, v38
    v_mov_b32 v216, 0
    v_cndmask_b32 v26, v39, v37, vcc
    v_add_u32 v36, 40, v34
    v_cmp_gt_u32 vcc, 18, v36
    v_add_u32 v37, 1920, v38
    v_mov_b32 v217, 0
    v_cndmask_b32 v27, v39, v37, vcc
    v_and_b32 v32, 3, v1
    v_bfe_u32 v33, v1, 2, 1
    v_lshl_or_b32 v32, v33, 3, v32
    v_bfe_u32 v33, v1, 3, 1
    v_lshl_or_b32 v32, v33, 2, v32
    v_and_b32 v33, 31, v1
    v_cmp_gt_u32 vcc, 16, v33
    v_cmp_gt_u32 s[12:13], 18, v33
    v_mov_b32 v34, 2147483648
    v_cndmask_b32 v32, v33, v32, vcc
    v_cmp_eq_u32 vcc, 20, v33
    v_lshrrev_b32 v33, 5, v1
    v_lshlrev_b32 v33, 7, v33
    v_cndmask_b32 v32, v32, 18, vcc
    s_or_b64 vcc, vcc, s[12:13]
    v_lshrrev_b32 v247, 3, v32
    v_lshl_or_b32 v33, v247, 15, v33
    v_and_b32 v32, 7, v32
    v_lshl_or_b32 v32, v32, 4, v33
    v_cndmask_b32 v247, v34, v32, vcc
    v_mfma_f32_32x32x8_bf16 v[64:79], v[216:217], v[216:217], 0
    v_mfma_f32_32x32x8_bf16 v[80:95], v[216:217], v[216:217], 0
    v_mfma_f32_32x32x8_bf16 v[96:111], v[216:217], v[216:217], 0
    s_mov_b32 s86, 0x3fb8aa3b
    s_mov_b32 s87, 0x3fb8aa3b
    s_waitcnt lgkmcnt(0)
    s_and_b32 s12, s2, 1
    s_lshl_b32 s12, s12, 3
    s_lshr_b32 s13, s2, 5
    s_add_u32 s24, s12, s13
    s_mul_i32 s9, s42, 0x0019660d
    s_add_u32 s9, s9, 0x3c6ef35f
    s_cmp_eq_u32 s11, 0
    s_cbranch_scc1 L_m4
    s_lshl_b32 s68, s72, 7
    s_add_u32 m0, s79, 16384
    s_add_u32 s68, s68, s73
    buffer_load_dwordx4 v3, s[44:47], s68 offen lds
    s_add_u32 m0, s79, 17408
    s_mul_i32 s69, s72, 221184
    buffer_load_dwordx4 v2, s[44:47], s68 offen lds
    s_add_u32 m0, s78, 73808
    s_add_u32 s69, s69, s74
    buffer_load_dwordx4 v4, s[48:51], s69 offen lds
    s_cmp_eq_u32 s7, 1
    s_cbranch_scc1 L_d5
    s_add_u32 m0, s78, 83056
    s_add_u32 s69, s69, 1152
    buffer_load_dwordx4 v4, s[48:51], s69 offen lds
L_d5:
    s_mul_i32 s14, s72, s76
    s_add_u32 m0, s77, 24656
    s_add_u32 s14, s14, s75
    buffer_load_dwordx4 v5, s[52:55], s14 offen lds
    s_add_u32 s72, s72, 1
    s_cmp_ge_u32 s72, 9
    s_cselect_b32 s72, 0, s72
L_m4:
    s_mov_b32 s71, 0
    s_cmp_eq_u32 s7, 1
    s_cbranch_scc1 L_front1
    v_and_b32 v132, 15, v1
    v_lshrrev_b32 v133, 4, v1
    v_mul_u32_u24 v249, 1152, v132
    v_lshl_add_u32 v249, v133, 3, v249
    v_lshlrev_b32 v134, 3, v132
    v_lshl_add_u32 v251, v133, 8, v134
    v_and_b32 v135, 1, v133
    v_lshl_add_u32 v248, v135, 2, v134
    v_lshrrev_b32 v244, 5, v1
    v_lshl_add_u32 v244, v135, 1, v244
    v_lshlrev_b32 v244, 4, v244
    v_add_lshl_u32 v244, v244, v132, 4
    v_and_b32 v134, 7, v1
    v_lshl_add_u32 v133, v133, 3, v134
    s_mul_i32 s12, s11, 74752
    v_lshl_add_u32 v240, v133, 4, s12
    v_add_u32 v252, s12, v253
    v_add_u32 v250, 147456, v253
    v_and_b32 v132, 31, v1
    v_lshrrev_b32 v133, 5, v1
    v_mul_u32_u24 v234, 48, v132
    v_add_u32 v234, 61440, v234
    v_lshl_add_u32 v233, v133, 4, v234
    v_add_u32 v234, 32, v234
    s_mul_i32 s12, s10, 2560
    s_add_u32 s12, s12, 79872
    v_lshl_add_u32 v235, v1, 3, s12
    s_lshl_b32 s12, s10, 2
    s_add_u32 s12, s12, 162304
    v_mov_b32 v236, s12
    v_mov_b32 v232, 0xdddddddd
    s_mul_i32 s12, s11, 162124
    v_mov_b32 v238, s12
    v_mov_b32 v239, s11
    s_lshl_b32 s12, s10, 5
    v_add_u32 v132, s12, v132
    v_lshlrev_b32 v202, 2, v132
    v_add_u32 v202, 73728, v202
    v_mul_u32_u24 v134, 80, v132
    s_mul_i32 s12, s11, 10240
    s_add_u32 s13, s12, 40960
    v_lshl_add_u32 v203, v133, 3, v134
    v_add_u32 v203, s13, v203
    s_lshl_b32 s12, s12, 1
    v_mul_u32_u24 v204, 10240, v133
    v_add3_u32 v204, v204, s12, v134
    v_and_b32 v134, 0x70, v132
    v_add_u32 v134, v134, v132
    v_mul_u32_u24 v134, 48, v134
    s_mul_i32 s12, s11, 768
    s_add_u32 s12, s12, 61440
    v_add_u32 v134, s12, v134
    s_lshl_b32 s12, s11, 2
    v_lshl_add_u32 v200, v133, 3, v134
    v_add_u32 v200, s12, v200
    s_lshl_b32 s12, s11, 5
    s_add_u32 s12, s12, 4
    v_mul_u32_u24 v135, s12, v133
    v_sub_u32 v135, 36, v135
    v_add_u32 v201, v134, v135
    v_bfe_u32 v132, v1, 2, 2
    v_lshl_add_u32 v132, v132, 1, v133
    v_mul_u32_u24 v132, 160, v132
    v_bfe_u32 v133, v1, 4, 1
    v_and_b32 v134, 3, v1
    v_lshl_add_u32 v133, v133, 2, v134
    v_and_b32 v134, 1, v133
    v_bfe_u32 v135, v133, 1, 1
    v_lshl_or_b32 v134, v134, 1, v135
    v_and_b32 v135, 4, v133
    v_or_b32 v134, v134, v135
    s_mul_i32 s12, s10, 10240
    v_lshl_add_u32 v205, v134, 3, v132
    v_add_u32 v205, s12, v205
    s_and_b32 s13, s10, 1
    s_lshl_b32 s14, s13, 2
    v_cmp_eq_u32 vcc, 5, v133
    v_add_u32 v206, s14, v133
    s_lshr_b32 s12, s10, 1
    s_mul_i32 s12, s12, 10240
    s_add_u32 s12, s12, 40960
    v_cndmask_b32 v206, v206, 9, vcc
    v_lshl_add_u32 v206, v206, 3, v132
    v_add_u32 v206, s12, v206
    s_waitcnt vmcnt(5)
    s_barrier
    ds_read_b128 v[44:47], v6 offset:0
    ds_read_b64_tr_b16 v[32:33], v10 offset:0
    ds_read_b64_tr_b16 v[34:35], v10 offset:144
    ds_read_b64_tr_b16 v[36:37], v11 offset:0
    ds_read_b64_tr_b16 v[38:39], v12 offset:0
    ds_read_b64_tr_b16 v[40:41], v28 offset:0
    ds_read_b64_tr_b16 v[42:43], v28 offset:144
    ds_read_b128 v[60:63], v7 offset:0
    ds_read_b64_tr_b16 v[48:49], v10 offset:2304
    ds_read_b64_tr_b16 v[50:51], v10 offset:2448
    ds_read_b64_tr_b16 v[52:53], v13 offset:0
    s_lshl_b32 s68, s72, 7
    s_add_u32 m0, s79, 32768
    s_add_u32 s68, s68, s73
    buffer_load_dwordx4 v3, s[44:47], s68 offen lds
    ds_read_b64_tr_b16 v[54:55], v14 offset:0
    ds_read_b64_tr_b16 v[56:57], v28 offset:2304
    ds_read_b64_tr_b16 v[58:59], v28 offset:2448
    s_waitcnt lgkmcnt(12)
    ds_read_b128 v[124:127], v8 offset:0
    ds_read_b64_tr_b16 v[112:113], v10 offset:4608
    ds_read_b64_tr_b16 v[114:115], v10 offset:4752
    s_waitcnt lgkmcnt(12)
    ds_read_b64_tr_b16 v[116:117], v15 offset:0
    ds_read_b64_tr_b16 v[118:119], v16 offset:0
    ds_read_b64_tr_b16 v[120:121], v28 offset:4608
    s_add_u32 m0, s79, 33792
    s_mul_i32 s69, s72, 221184
    buffer_load_dwordx4 v2, s[44:47], s68 offen lds
    v_mfma_f32_32x32x16_bf16 v[64:79], v[32:35], v[44:47], v[64:79]
    s_waitcnt lgkmcnt(12)
    ds_read_b64_tr_b16 v[122:123], v28 offset:4752
    ds_read_b128 v[228:231], v9 offset:0
    ds_read_b64_tr_b16 v[216:217], v10 offset:6912
    v_mfma_f32_32x32x16_bf16 v[80:95], v[36:39], v[44:47], v[80:95]
    s_waitcnt lgkmcnt(12)
    ds_read_b64_tr_b16 v[218:219], v10 offset:7056
    ds_read_b64_tr_b16 v[220:221], v17 offset:0
    ds_read_b64_tr_b16 v[222:223], v18 offset:0
    v_mfma_f32_32x32x16_bf16 v[96:111], v[40:43], v[44:47], v[96:111]
    s_waitcnt lgkmcnt(13)
    ds_read_b64_tr_b16 v[224:225], v28 offset:6912
    ds_read_b64_tr_b16 v[226:227], v28 offset:7056
    s_add_u32 m0, s78, 98464
    s_add_u32 s69, s69, s74
    buffer_load_dwordx4 v4, s[48:51], s69 offen lds
    v_mfma_f32_32x32x16_bf16 v[64:79], v[48:51], v[60:63], v[64:79]
    s_add_u32 m0, s78, 107712
    s_add_u32 s69, s69, 1152
    buffer_load_dwordx4 v4, s[48:51], s69 offen lds
    v_mfma_f32_32x32x16_bf16 v[80:95], v[52:55], v[60:63], v[80:95]
    s_mul_i32 s14, s72, s76
    s_add_u32 m0, s77, 49312
    s_add_u32 s14, s14, s75
    buffer_load_dwordx4 v5, s[52:55], s14 offen lds
    s_add_u32 s72, s72, 1
    s_cmp_ge_u32 s72, 9
    s_cselect_b32 s72, 0, s72
    s_waitcnt lgkmcnt(14)
    v_mfma_f32_32x32x16_bf16 v[96:111], v[56:59], v[60:63], v[96:111]
    s_waitcnt vmcnt(5) lgkmcnt(0)
    s_barrier
    v_mfma_f32_32x32x16_bf16 v[64:79], v[112:115], v[124:127], v[64:79]
    ds_read_b128 v[44:47], v6 offset:16384
    ds_read_b64_tr_b16 v[32:33], v10 offset:24656
    ds_read_b64_tr_b16 v[34:35], v10 offset:24800
    ds_read_b64_tr_b16 v[36:37], v11 offset:24656
    v_mfma_f32_32x32x16_bf16 v[80:95], v[116:119], v[124:127], v[80:95]
    ds_read_b64_tr_b16 v[38:39], v12 offset:24656
    ds_read_b64_tr_b16 v[40:41], v28 offset:24656
    ds_read_b64_tr_b16 v[42:43], v28 offset:24800
    ds_read_b128 v[60:63], v7 offset:16384
    v_mfma_f32_32x32x16_bf16 v[96:111], v[120:123], v[124:127], v[96:111]
    ds_read_b64_tr_b16 v[48:49], v10 offset:26960
    ds_read_b64_tr_b16 v[50:51], v10 offset:27104
    ds_read_b64_tr_b16 v[52:53], v13 offset:24656
    s_lshl_b32 s68, s72, 7
    s_add_u32 m0, s79, 0
    s_add_u32 s68, s68, s73
    buffer_load_dwordx4 v3, s[44:47], s68 offen lds
    v_mfma_f32_32x32x16_bf16 v[64:79], v[216:219], v[228:231], v[64:79]
    ds_read_b64_tr_b16 v[54:55], v14 offset:24656
    ds_read_b64_tr_b16 v[56:57], v28 offset:26960
    ds_read_b64_tr_b16 v[58:59], v28 offset:27104
    v_mfma_f32_32x32x16_bf16 v[80:95], v[220:223], v[228:231], v[80:95]
    s_waitcnt lgkmcnt(12)
    ds_read_b128 v[124:127], v8 offset:16384
    ds_read_b64_tr_b16 v[112:113], v10 offset:29264
    ds_read_b64_tr_b16 v[114:115], v10 offset:29408
    v_mfma_f32_32x32x16_bf16 v[96:111], v[224:227], v[228:231], v[96:111]
    s_waitcnt lgkmcnt(12)
    ds_read_b64_tr_b16 v[116:117], v15 offset:24656
    ds_read_b64_tr_b16 v[118:119], v16 offset:24656
    ds_read_b64_tr_b16 v[120:121], v28 offset:29264
    s_add_u32 m0, s79, 1024
    s_mul_i32 s69, s72, 221184
    buffer_load_dwordx4 v2, s[44:47], s68 offen lds
    v_mfma_f32_32x32x16_bf16 v[64:79], v[32:35], v[44:47], v[64:79]
    s_waitcnt lgkmcnt(12)
    ds_read_b64_tr_b16 v[122:123], v28 offset:29408
    ds_read_b128 v[228:231], v9 offset:16384
    ds_read_b64_tr_b16 v[216:217], v10 offset:31568
    v_mfma_f32_32x32x16_bf16 v[80:95], v[36:39], v[44:47], v[80:95]
    s_waitcnt lgkmcnt(12)
    ds_read_b64_tr_b16 v[218:219], v10 offset:31712
    ds_read_b64_tr_b16 v[220:221], v17 offset:24656
    ds_read_b64_tr_b16 v[222:223], v18 offset:24656
    v_mfma_f32_32x32x16_bf16 v[96:111], v[40:43], v[44:47], v[96:111]
    s_waitcnt lgkmcnt(13)
    ds_read_b64_tr_b16 v[224:225], v28 offset:31568
    ds_read_b64_tr_b16 v[226:227], v28 offset:31712
    s_add_u32 m0, s78, 49152
    s_add_u32 s69, s69, s74
    buffer_load_dwordx4 v4, s[48:51], s69 offen lds
    v_mfma_f32_32x32x16_bf16 v[64:79], v[48:51], v[60:63], v[64:79]
    s_add_u32 m0, s78, 58400
    s_add_u32 s69, s69, 1152
    buffer_load_dwordx4 v4, s[48:51], s69 offen lds
    v_mfma_f32_32x32x16_bf16 v[80:95], v[52:55], v[60:63], v[80:95]
    s_mul_i32 s14, s72, s76
    s_add_u32 m0, s77, 0
    s_add_u32 s14, s14, s75
    buffer_load_dwordx4 v5, s[52:55], s14 offen lds
    s_add_u32 s72, s72, 1
    s_cmp_ge_u32 s72, 9
    s_cselect_b32 s72, 0, s72
    s_waitcnt lgkmcnt(14)
    v_mfma_f32_32x32x16_bf16 v[96:111], v[56:59], v[60:63], v[96:111]
    s_waitcnt vmcnt(5) lgkmcnt(0)
    s_barrier
    v_mfma_f32_32x32x16_bf16 v[64:79], v[112:115], v[124:127], v[64:79]
    ds_read_b128 v[44:47], v6 offset:32768
    ds_read_b64_tr_b16 v[32:33], v10 offset:49312
    ds_read_b64_tr_b16 v[34:35], v10 offset:49456
    ds_read_b64_tr_b16 v[36:37], v11 offset:49312
    v_mfma_f32_32x32x16_bf16 v[80:95], v[116:119], v[124:127], v[80:95]
    ds_read_b64_tr_b16 v[38:39], v12 offset:49312
    ds_read_b64_tr_b16 v[40:41], v28 offset:49312
    ds_read_b64_tr_b16 v[42:43], v28 offset:49456
    ds_read_b128 v[60:63], v7 offset:32768
    v_mfma_f32_32x32x16_bf16 v[96:111], v[120:123], v[124:127], v[96:111]
    ds_read_b64_tr_b16 v[48:49], v10 offset:51616
    ds_read_b64_tr_b16 v[50:51], v10 offset:51760
    ds_read_b64_tr_b16 v[52:53], v13 offset:49312
    s_lshl_b32 s68, s72, 7
    s_add_u32 m0, s79, 16384
    s_add_u32 s68, s68, s73
    buffer_load_dwordx4 v3, s[44:47], s68 offen lds
    v_mfma_f32_32x32x16_bf16 v[64:79], v[216:219], v[228:231], v[64:79]
    ds_read_b64_tr_b16 v[54:55], v14 offset:49312
    ds_read_b64_tr_b16 v[56:57], v28 offset:51616
    ds_read_b64_tr_b16 v[58:59], v28 offset:51760
    v_mfma_f32_32x32x16_bf16 v[80:95], v[220:223], v[228:231], v[80:95]
    s_waitcnt lgkmcnt(12)
    ds_read_b128 v[124:127], v8 offset:32768
    ds_read_b64_tr_b16 v[112:113], v10 offset:53920
    ds_read_b64_tr_b16 v[114:115], v10 offset:54064
    v_mfma_f32_32x32x16_bf16 v[96:111], v[224:227], v[228:231], v[96:111]
    s_waitcnt lgkmcnt(12)
    ds_read_b64_tr_b16 v[116:117], v15 offset:49312
    ds_read_b64_tr_b16 v[118:119], v16 offset:49312
    ds_read_b64_tr_b16 v[120:121], v28 offset:53920
    s_add_u32 m0, s79, 17408
    s_mul_i32 s69, s72, 221184
    buffer_load_dwordx4 v2, s[44:47], s68 offen lds
    v_mfma_f32_32x32x16_bf16 v[64:79], v[32:35], v[44:47], v[64:79]
    s_waitcnt lgkmcnt(12)
    ds_read_b64_tr_b16 v[122:123], v28 offset:54064
    ds_read_b128 v[228:231], v9 offset:32768
    ds_read_b64_tr_b16 v[216:217], v10 offset:56224
    v_mfma_f32_32x32x16_bf16 v[80:95], v[36:39], v[44:47], v[80:95]
    s_waitcnt lgkmcnt(12)
    ds_read_b64_tr_b16 v[218:219], v10 offset:56368
    ds_read_b64_tr_b16 v[220:221], v17 offset:49312
    ds_read_b64_tr_b16 v[222:223], v18 offset:49312
    v_mfma_f32_32x32x16_bf16 v[96:111], v[40:43], v[44:47], v[96:111]
    s_waitcnt lgkmcnt(13)
    ds_read_b64_tr_b16 v[224:225], v28 offset:56224
    ds_read_b64_tr_b16 v[226:227], v28 offset:56368
    s_add_u32 m0, s78, 73808
    s_add_u32 s69, s69, s74
    buffer_load_dwordx4 v4, s[48:51], s69 offen lds
    v_mfma_f32_32x32x16_bf16 v[64:79], v[48:51], v[60:63], v[64:79]
    s_add_u32 m0, s78, 83056
    s_add_u32 s69, s69, 1152
    buffer_load_dwordx4 v4, s[48:51], s69 offen lds
    v_mfma_f32_32x32x16_bf16 v[80:95], v[52:55], v[60:63], v[80:95]
    s_mul_i32 s14, s72, s76
    s_add_u32 m0, s77, 24656
    s_add_u32 s14, s14, s75
    buffer_load_dwordx4 v5, s[52:55], s14 offen lds
    s_add_u32 s72, s72, 1
    s_cmp_ge_u32 s72, 9
    s_cselect_b32 s72, 0, s72
    s_waitcnt lgkmcnt(14)
    v_mfma_f32_32x32x16_bf16 v[96:111], v[56:59], v[60:63], v[96:111]
    s_waitcnt vmcnt(5) lgkmcnt(0)
    s_barrier
    v_mfma_f32_32x32x16_bf16 v[64:79], v[112:115], v[124:127], v[64:79]
    ds_read_b128 v[44:47], v6 offset:0
    ds_read_b64_tr_b16 v[32:33], v10 offset:0
    ds_read_b64_tr_b16 v[34:35], v10 offset:144
    ds_read_b64_tr_b16 v[36:37], v11 offset:0
    v_mfma_f32_32x32x16_bf16 v[80:95], v[116:119], v[124:127], v[80:95]
    ds_read_b64_tr_b16 v[38:39], v12 offset:0
    ds_read_b64_tr_b16 v[40:41], v28 offset:0
    ds_read_b64_tr_b16 v[42:43], v28 offset:144
    ds_read_b128 v[60:63], v7 offset:0
    v_mfma_f32_32x32x16_bf16 v[96:111], v[120:123], v[124:127], v[96:111]
    ds_read_b64_tr_b16 v[48:49], v10 offset:2304
    ds_read_b64_tr_b16 v[50:51], v10 offset:2448
    ds_read_b64_tr_b16 v[52:53], v13 offset:0
    s_lshl_b32 s68, s72, 7
    s_add_u32 m0, s79, 32768
    s_add_u32 s68, s68, s73
    buffer_load_dwordx4 v3, s[44:47], s68 offen lds
    v_mfma_f32_32x32x16_bf16 v[64:79], v[216:219], v[228:231], v[64:79]
    ds_read_b64_tr_b16 v[54:55], v14 offset:0
    ds_read_b64_tr_b16 v[56:57], v28 offset:2304
    ds_read_b64_tr_b16 v[58:59], v28 offset:2448
    v_mfma_f32_32x32x16_bf16 v[80:95], v[220:223], v[228:231], v[80:95]
    s_waitcnt lgkmcnt(12)
    ds_read_b128 v[124:127], v8 offset:0
    ds_read_b64_tr_b16 v[112:113], v10 offset:4608
    ds_read_b64_tr_b16 v[114:115], v10 offset:4752
    v_mfma_f32_32x32x16_bf16 v[96:111], v[224:227], v[228:231], v[96:111]
    s_waitcnt lgkmcnt(12)
    ds_read_b64_tr_b16 v[116:117], v15 offset:0
    ds_read_b64_tr_b16 v[118:119], v16 offset:0
    ds_read_b64_tr_b16 v[120:121], v28 offset:4608
    s_add_u32 m0, s79, 33792
    s_mul_i32 s69, s72, 221184
    buffer_load_dwordx4 v2, s[44:47], s68 offen lds
    v_mfma_f32_32x32x16_bf16 v[64:79], v[32:35], v[44:47], v[64:79]
    s_waitcnt lgkmcnt(12)
    ds_read_b64_tr_b16 v[122:123], v28 offset:4752
    ds_read_b128 v[228:231], v9 offset:0
    ds_read_b64_tr_b16 v[216:217], v10 offset:6912
    v_mfma_f32_32x32x16_bf16 v[80:95], v[36:39], v[44:47], v[80:95]
    s_waitcnt lgkmcnt(12)
    ds_read_b64_tr_b16 v[218:219], v10 offset:7056
    ds_read_b64_tr_b16 v[220:221], v17 offset:0
    ds_read_b64_tr_b16 v[222:223], v18 offset:0
    v_mfma_f32_32x32x16_bf16 v[96:111], v[40:43], v[44:47], v[96:111]
    s_waitcnt lgkmcnt(13)
    ds_read_b64_tr_b16 v[224:225], v28 offset:6912
    ds_read_b64_tr_b16 v[226:227], v28 offset:7056
    s_add_u32 m0, s78, 98464
    s_add_u32 s69, s69, s74
    buffer_load_dwordx4 v4, s[48:51], s69 offen lds
    v_mfma_f32_32x32x16_bf16 v[64:79], v[48:51], v[60:63], v[64:79]
    s_add_u32 m0, s78, 107712
    s_add_u32 s69, s69, 1152
    buffer_load_dwordx4 v4, s[48:51], s69 offen lds
    v_mfma_f32_32x32x16_bf16 v[80:95], v[52:55], v[60:63], v[80:95]
    s_mul_i32 s14, s72, s76
    s_add_u32 m0, s77, 49312
    s_add_u32 s14, s14, s75
    buffer_load_dwordx4 v5, s[52:55], s14 offen lds
    s_add_u32 s72, s72, 1
    s_cmp_ge_u32 s72, 9
    s_cselect_b32 s72, 0, s72
    s_waitcnt lgkmcnt(14)
    v_mfma_f32_32x32x16_bf16 v[96:111], v[56:59], v[60:63], v[96:111]
    s_waitcnt vmcnt(5) lgkmcnt(0)
    s_barrier
    v_mfma_f32_32x32x16_bf16 v[64:79], v[112:115], v[124:127], v[64:79]
    ds_read_b128 v[44:47], v6 offset:16384
    ds_read_b64_tr_b16 v[32:33], v10 offset:24656
    ds_read_b64_tr_b16 v[34:35], v10 offset:24800
    ds_read_b64_tr_b16 v[36:37], v11 offset:24656
    v_mfma_f32_32x32x16_bf16 v[80:95], v[116:119], v[124:127], v[80:95]
    ds_read_b64_tr_b16 v[38:39], v12 offset:24656
    ds_read_b64_tr_b16 v[40:41], v28 offset:24656
    ds_read_b64_tr_b16 v[42:43], v28 offset:24800
    ds_read_b128 v[60:63], v7 offset:16384
    v_mfma_f32_32x32x16_bf16 v[96:111], v[120:123], v[124:127], v[96:111]
    ds_read_b64_tr_b16 v[48:49], v10 offset:26960
    ds_read_b64_tr_b16 v[50:51], v10 offset:27104
    ds_read_b64_tr_b16 v[52:53], v13 offset:24656
    s_lshl_b32 s68, s72, 7
    s_add_u32 m0, s79, 0
    s_add_u32 s68, s68, s73
    buffer_load_dwordx4 v3, s[44:47], s68 offen lds
    v_mfma_f32_32x32x16_bf16 v[64:79], v[216:219], v[228:231], v[64:79]
    ds_read_b64_tr_b16 v[54:55], v14 offset:24656
    ds_read_b64_tr_b16 v[56:57], v28 offset:26960
    ds_read_b64_tr_b16 v[58:59], v28 offset:27104
    v_mfma_f32_32x32x16_bf16 v[80:95], v[220:223], v[228:231], v[80:95]
    s_waitcnt lgkmcnt(12)
    ds_read_b128 v[124:127], v8 offset:16384
    ds_read_b64_tr_b16 v[112:113], v10 offset:29264
    ds_read_b64_tr_b16 v[114:115], v10 offset:29408
    v_mfma_f32_32x32x16_bf16 v[96:111], v[224:227], v[228:231], v[96:111]
    s_waitcnt lgkmcnt(12)
    ds_read_b64_tr_b16 v[116:117], v15 offset:24656
    ds_read_b64_tr_b16 v[118:119], v16 offset:24656
    ds_read_b64_tr_b16 v[120:121], v28 offset:29264
    s_add_u32 m0, s79, 1024
    s_mul_i32 s69, s72, 221184
    buffer_load_dwordx4 v2, s[44:47], s68 offen lds
    v_mfma_f32_32x32x16_bf16 v[64:79], v[32:35], v[44:47], v[64:79]
    s_waitcnt lgkmcnt(12)
    ds_read_b64_tr_b16 v[122:123], v28 offset:29408
    ds_read_b128 v[228:231], v9 offset:16384
    ds_read_b64_tr_b16 v[216:217], v10 offset:31568
    v_mfma_f32_32x32x16_bf16 v[80:95], v[36:39], v[44:47], v[80:95]
    s_waitcnt lgkmcnt(12)
    ds_read_b64_tr_b16 v[218:219], v10 offset:31712
    ds_read_b64_tr_b16 v[220:221], v17 offset:24656
    ds_read_b64_tr_b16 v[222:223], v18 offset:24656
    v_mfma_f32_32x32x16_bf16 v[96:111], v[40:43], v[44:47], v[96:111]
    s_waitcnt lgkmcnt(13)
    ds_read_b64_tr_b16 v[224:225], v28 offset:31568
    ds_read_b64_tr_b16 v[226:227], v28 offset:31712
    s_add_u32 m0, s78, 49152
    s_add_u32 s69, s69, s74
    buffer_load_dwordx4 v4, s[48:51], s69 offen lds
    v_mfma_f32_32x32x16_bf16 v[64:79], v[48:51], v[60:63], v[64:79]
    s_add_u32 m0, s78, 58400
    s_add_u32 s69, s69, 1152
    buffer_load_dwordx4 v4, s[48:51], s69 offen lds
    v_mfma_f32_32x32x16_bf16 v[80:95], v[52:55], v[60:63], v[80:95]
    s_mul_i32 s14, s72, s76
    s_add_u32 m0, s77, 0
    s_add_u32 s14, s14, s75
    buffer_load_dwordx4 v5, s[52:55], s14 offen lds
    s_add_u32 s72, s72, 1
    s_cmp_ge_u32 s72, 9
    s_cselect_b32 s72, 0, s72
    s_waitcnt lgkmcnt(14)
    v_mfma_f32_32x32x16_bf16 v[96:111], v[56:59], v[60:63], v[96:111]
    s_waitcnt lgkmcnt(11)
    ds_read_b64_tr_b16 v[144:145], v22 offset:0
    ds_read_b64_tr_b16 v[156:157], v22 offset:32
    ds_read_b64_tr_b16 v[146:147], v23 offset:0
    ds_read_b64_tr_b16 v[158:159], v23 offset:32
    s_waitcnt vmcnt(5) lgkmcnt(0)
    s_barrier
    v_mfma_f32_32x32x16_bf16 v[64:79], v[112:115], v[124:127], v[64:79]
    ds_read_b128 v[44:47], v6 offset:32768
    ds_read_b64_tr_b16 v[32:33], v10 offset:49312
    ds_read_b64_tr_b16 v[34:35], v10 offset:49456
    ds_read_b64_tr_b16 v[36:37], v11 offset:49312
    v_mfma_f32_32x32x16_bf16 v[80:95], v[116:119], v[124:127], v[80:95]
    ds_read_b64_tr_b16 v[38:39], v12 offset:49312
    ds_read_b64_tr_b16 v[40:41], v28 offset:49312
    ds_read_b64_tr_b16 v[42:43], v28 offset:49456
    ds_read_b128 v[60:63], v7 offset:32768
    v_mfma_f32_32x32x16_bf16 v[96:111], v[120:123], v[124:127], v[96:111]
    ds_read_b64_tr_b16 v[48:49], v10 offset:51616
    ds_read_b64_tr_b16 v[50:51], v10 offset:51760
    ds_read_b64_tr_b16 v[52:53], v13 offset:49312
    s_lshl_b32 s68, s72, 7
    s_add_u32 m0, s79, 16384
    s_add_u32 s68, s68, s73
    buffer_load_dwordx4 v3, s[44:47], s68 offen lds
    v_mfma_f32_32x32x16_bf16 v[64:79], v[216:219], v[228:231], v[64:79]
    ds_read_b64_tr_b16 v[54:55], v14 offset:49312
    ds_read_b64_tr_b16 v[56:57], v28 offset:51616
    ds_read_b64_tr_b16 v[58:59], v28 offset:51760
    v_mfma_f32_32x32x16_bf16 v[80:95], v[220:223], v[228:231], v[80:95]
    s_waitcnt lgkmcnt(12)
    ds_read_b128 v[124:127], v8 offset:32768
    ds_read_b64_tr_b16 v[112:113], v10 offset:53920
    ds_read_b64_tr_b16 v[114:115], v10 offset:54064
    v_mfma_f32_32x32x16_bf16 v[96:111], v[224:227], v[228:231], v[96:111]
    s_waitcnt lgkmcnt(12)
    ds_read_b64_tr_b16 v[116:117], v15 offset:49312
    ds_read_b64_tr_b16 v[118:119], v16 offset:49312
    ds_read_b64_tr_b16 v[120:121], v28 offset:53920
    s_add_u32 m0, s79, 17408
    s_mul_i32 s69, s72, 221184
    buffer_load_dwordx4 v2, s[44:47], s68 offen lds
    v_mfma_f32_32x32x16_bf16 v[64:79], v[32:35], v[44:47], v[64:79]
    s_waitcnt lgkmcnt(12)
    ds_read_b64_tr_b16 v[122:123], v28 offset:54064
    ds_read_b128 v[228:231], v9 offset:32768
    ds_read_b64_tr_b16 v[216:217], v10 offset:56224
    v_mfma_f32_32x32x16_bf16 v[80:95], v[36:39], v[44:47], v[80:95]
    s_waitcnt lgkmcnt(12)
    ds_read_b64_tr_b16 v[218:219], v10 offset:56368
    ds_read_b64_tr_b16 v[220:221], v17 offset:49312
    ds_read_b64_tr_b16 v[222:223], v18 offset:49312
    v_mfma_f32_32x32x16_bf16 v[96:111], v[40:43], v[44:47], v[96:111]
    s_waitcnt lgkmcnt(13)
    ds_read_b64_tr_b16 v[224:225], v28 offset:56224
    ds_read_b64_tr_b16 v[226:227], v28 offset:56368
    s_add_u32 m0, s78, 73808
    s_add_u32 s69, s69, s74
    buffer_load_dwordx4 v4, s[48:51], s69 offen lds
    v_mfma_f32_32x32x16_bf16 v[64:79], v[48:51], v[60:63], v[64:79]
    s_add_u32 m0, s78, 83056
    s_add_u32 s69, s69, 1152
    buffer_load_dwordx4 v4, s[48:51], s69 offen lds
    v_mfma_f32_32x32x16_bf16 v[80:95], v[52:55], v[60:63], v[80:95]
    s_mul_i32 s14, s72, s76
    s_add_u32 m0, s77, 24656
    s_add_u32 s14, s14, s75
    buffer_load_dwordx4 v5, s[52:55], s14 offen lds
    s_add_u32 s72, s72, 1
    s_cmp_ge_u32 s72, 9
    s_cselect_b32 s72, 0, s72
    s_waitcnt lgkmcnt(14)
    v_mfma_f32_32x32x16_bf16 v[96:111], v[56:59], v[60:63], v[96:111]
    s_waitcnt lgkmcnt(11)
    ds_read_b64_tr_b16 v[148:149], v24 offset:0
    ds_read_b64_tr_b16 v[208:209], v24 offset:32
    ds_read_b64_tr_b16 v[150:151], v25 offset:0
    ds_read_b64_tr_b16 v[210:211], v25 offset:32
    s_waitcnt vmcnt(5) lgkmcnt(0)
    s_barrier
    v_mfma_f32_32x32x16_bf16 v[64:79], v[112:115], v[124:127], v[64:79]
    ds_read_b128 v[44:47], v6 offset:0
    ds_read_b64_tr_b16 v[32:33], v10 offset:0
    ds_read_b64_tr_b16 v[34:35], v10 offset:144
    ds_read_b64_tr_b16 v[36:37], v11 offset:0
    v_mfma_f32_32x32x16_bf16 v[80:95], v[116:119], v[124:127], v[80:95]
    ds_read_b64_tr_b16 v[38:39], v12 offset:0
    ds_read_b64_tr_b16 v[40:41], v28 offset:0
    ds_read_b64_tr_b16 v[42:43], v28 offset:144
    ds_read_b128 v[60:63], v7 offset:0
    v_mfma_f32_32x32x16_bf16 v[96:111], v[120:123], v[124:127], v[96:111]
    ds_read_b64_tr_b16 v[48:49], v10 offset:2304
    ds_read_b64_tr_b16 v[50:51], v10 offset:2448
    ds_read_b64_tr_b16 v[52:53], v13 offset:0
    s_lshl_b32 s68, s72, 7
    s_add_u32 m0, s79, 32768
    s_add_u32 s68, s68, s73
    buffer_load_dwordx4 v3, s[44:47], s68 offen lds
    v_mfma_f32_32x32x16_bf16 v[64:79], v[216:219], v[228:231], v[64:79]
    ds_read_b64_tr_b16 v[54:55], v14 offset:0
    ds_read_b64_tr_b16 v[56:57], v28 offset:2304
    ds_read_b64_tr_b16 v[58:59], v28 offset:2448
    v_mfma_f32_32x32x16_bf16 v[80:95], v[220:223], v[228:231], v[80:95]
    s_waitcnt lgkmcnt(12)
    ds_read_b128 v[124:127], v8 offset:0
    ds_read_b64_tr_b16 v[112:113], v10 offset:4608
    ds_read_b64_tr_b16 v[114:115], v10 offset:4752
    v_mfma_f32_32x32x16_bf16 v[96:111], v[224:227], v[228:231], v[96:111]
    s_waitcnt lgkmcnt(12)
    ds_read_b64_tr_b16 v[116:117], v15 offset:0
    ds_read_b64_tr_b16 v[118:119], v16 offset:0
    ds_read_b64_tr_b16 v[120:121], v28 offset:4608
    s_add_u32 m0, s79, 33792
    s_mul_i32 s69, s72, 221184
    buffer_load_dwordx4 v2, s[44:47], s68 offen lds
    v_mfma_f32_32x32x16_bf16 v[64:79], v[32:35], v[44:47], v[64:79]
    s_waitcnt lgkmcnt(12)
    ds_read_b64_tr_b16 v[122:123], v28 offset:4752
    ds_read_b128 v[228:231], v9 offset:0
    ds_read_b64_tr_b16 v[216:217], v10 offset:6912
    v_mfma_f32_32x32x16_bf16 v[80:95], v[36:39], v[44:47], v[80:95]
    s_waitcnt lgkmcnt(12)
    ds_read_b64_tr_b16 v[218:219], v10 offset:7056
    ds_read_b64_tr_b16 v[220:221], v17 offset:0
    ds_read_b64_tr_b16 v[222:223], v18 offset:0
    v_mfma_f32_32x32x16_bf16 v[96:111], v[40:43], v[44:47], v[96:111]
    s_waitcnt lgkmcnt(13)
    ds_read_b64_tr_b16 v[224:225], v28 offset:6912
    ds_read_b64_tr_b16 v[226:227], v28 offset:7056
    s_add_u32 m0, s78, 98464
    s_add_u32 s69, s69, s74
    buffer_load_dwordx4 v4, s[48:51], s69 offen lds
    v_mfma_f32_32x32x16_bf16 v[64:79], v[48:51], v[60:63], v[64:79]
    s_add_u32 m0, s78, 107712
    s_add_u32 s69, s69, 1152
    buffer_load_dwordx4 v4, s[48:51], s69 offen lds
    v_mfma_f32_32x32x16_bf16 v[80:95], v[52:55], v[60:63], v[80:95]
    s_mul_i32 s14, s72, s76
    s_add_u32 m0, s77, 49312
    s_add_u32 s14, s14, s75
    buffer_load_dwordx4 v5, s[52:55], s14 offen lds
    s_add_u32 s72, s72, 1
    s_cmp_ge_u32 s72, 9
    s_cselect_b32 s72, 0, s72
    s_waitcnt lgkmcnt(14)
    v_mfma_f32_32x32x16_bf16 v[96:111], v[56:59], v[60:63], v[96:111]
    s_waitcnt lgkmcnt(11)
    ds_read_b64_tr_b16 v[152:153], v26 offset:0
    ds_read_b64_tr_b16 v[212:213], v26 offset:32
    ds_read_b64_tr_b16 v[154:155], v27 offset:0
    ds_read_b64_tr_b16 v[214:215], v27 offset:32
    s_waitcnt vmcnt(5) lgkmcnt(0)
    s_barrier
    v_mov_b32 v242, 0
    v_mov_b32 v128, 2147483648
    v_mov_b32 v130, 2147483648
    s_cmp_eq_u32 s11, 0
    s_cbranch_scc1 L_pr7
    s_lshl_b32 s15, s10, 4
    s_add_u32 s15, s15, s5
    s_cmp_ge_u32 s15, 20
    s_cbranch_scc1 L_pr7
    s_mul_i32 s14, s15, 52
    s_lshr_b32 s14, s14, 8
    s_mul_i32 s12, s14, 5
    s_sub_u32 s12, s15, s12
    s_mul_i32 s14, s14, 5120
    s_lshr_b32 s3, s12, 1
    s_lshl_b32 s3, s3, 11
    s_add_u32 s14, s14, s3
    s_and_b32 s3, s12, 1
    s_lshl_b32 s3, s3, 9
    s_add_u32 s14, s14, s3
    s_cmp_eq_u32 s12, 4
    s_cselect_b32 s3, 0, 512
    v_lshrrev_b32 v242, 5, v1
    v_mul_u32_u24 v242, s3, v242
    v_add_u32 v242, v242, v253
    s_mul_i32 s13, s6, 327680
    s_add_u32 s14, s13, s14
    s_add_u32 s81, s14, 393216
    v_and_b32 v128, 15, v1
    v_mul_u32_u24 v128, 20480, v128
    v_lshrrev_b32 v129, 4, v1
    v_min_u32 v129, 2, v129
    v_lshl_add_u32 v128, v129, 7, v128
    v_add_u32 v130, s3, v128
L_pr7:
    v_mfma_f32_32x32x16_bf16 v[64:79], v[112:115], v[124:127], v[64:79]
    ds_read_b128 v[44:47], v6 offset:16384
    ds_read_b64_tr_b16 v[32:33], v10 offset:24656
    ds_read_b64_tr_b16 v[34:35], v10 offset:24800
    ds_read_b64_tr_b16 v[36:37], v11 offset:24656
    v_mfma_f32_32x32x16_bf16 v[80:95], v[116:119], v[124:127], v[80:95]
    ds_read_b64_tr_b16 v[38:39], v12 offset:24656
    ds_read_b64_tr_b16 v[40:41], v28 offset:24656
    ds_read_b64_tr_b16 v[42:43], v28 offset:24800
    ds_read_b128 v[60:63], v7 offset:16384
    v_mfma_f32_32x32x16_bf16 v[96:111], v[120:123], v[124:127], v[96:111]
    ds_read_b64_tr_b16 v[48:49], v10 offset:26960
    ds_read_b64_tr_b16 v[50:51], v10 offset:27104
    ds_read_b64_tr_b16 v[52:53], v13 offset:24656
    v_mfma_f32_32x32x16_bf16 v[64:79], v[216:219], v[228:231], v[64:79]
    ds_read_b64_tr_b16 v[54:55], v14 offset:24656
    ds_read_b64_tr_b16 v[56:57], v28 offset:26960
    ds_read_b64_tr_b16 v[58:59], v28 offset:27104
    v_mfma_f32_32x32x16_bf16 v[80:95], v[220:223], v[228:231], v[80:95]
    s_waitcnt lgkmcnt(12)
    ds_read_b128 v[124:127], v8 offset:16384
    ds_read_b64_tr_b16 v[112:113], v10 offset:29264
    ds_read_b64_tr_b16 v[114:115], v10 offset:29408
    v_mfma_f32_32x32x16_bf16 v[96:111], v[224:227], v[228:231], v[96:111]
    s_waitcnt lgkmcnt(12)
    ds_read_b64_tr_b16 v[116:117], v15 offset:24656
    ds_read_b64_tr_b16 v[118:119], v16 offset:24656
    ds_read_b64_tr_b16 v[120:121], v28 offset:29264
    v_mfma_f32_32x32x16_bf16 v[64:79], v[32:35], v[44:47], v[64:79]
    s_waitcnt lgkmcnt(12)
    ds_read_b64_tr_b16 v[122:123], v28 offset:29408
    ds_read_b128 v[228:231], v9 offset:16384
    ds_read_b64_tr_b16 v[216:217], v10 offset:31568
    v_mfma_f32_32x32x16_bf16 v[80:95], v[36:39], v[44:47], v[80:95]
    s_waitcnt lgkmcnt(12)
    ds_read_b64_tr_b16 v[218:219], v10 offset:31712
    ds_read_b64_tr_b16 v[220:221], v17 offset:24656
    ds_read_b64_tr_b16 v[222:223], v18 offset:24656
    v_mfma_f32_32x32x16_bf16 v[96:111], v[40:43], v[44:47], v[96:111]
    s_waitcnt lgkmcnt(13)
    ds_read_b64_tr_b16 v[224:225], v28 offset:31568
    ds_read_b64_tr_b16 v[226:227], v28 offset:31712
    v_mfma_f32_32x32x16_bf16 v[64:79], v[48:51], v[60:63], v[64:79]
    v_mfma_f32_32x32x16_bf16 v[80:95], v[52:55], v[60:63], v[80:95]
    s_waitcnt lgkmcnt(14)
    v_mfma_f32_32x32x16_bf16 v[96:111], v[56:59], v[60:63], v[96:111]
    s_waitcnt vmcnt(0) lgkmcnt(0)
    s_barrier
    s_cmp_eq_u32 s11, 0
    s_cbranch_scc1 L_pr8
    buffer_load_dword v192, v128, s[60:63], s81 offen sc1
    buffer_load_dword v193, v130, s[60:63], s81 offen offset:512 sc1
L_pr8:
    s_cmp_eq_u32 s11, 1
    s_cbranch_scc1 L_ps9
    s_lshl_b32 s12, s5, 3
    s_add_u32 s12, s12, s10
    s_mul_i32 s15, s12, 36864
    s_add_u32 s15, s15, 3164160
    s_lshl_b32 s14, s8, 10
    s_add_u32 s14, s14, s15
    s_lshl_b32 s13, s8, 7
    s_add_u32 s13, s13, s15
    s_add_u32 s13, s13, 16384
    v_mov_b32 v196, -1
    v_mov_b32 v197, -1
    v_mov_b32 v198, -1
    v_mov_b32 v199, -1
    buffer_store_dwordx4 v[196:199], v253, s[60:63], s14 offen sc1
    s_add_u32 s14, s14, 147456
    s_nop 0
    buffer_store_dwordx4 v[196:199], v253, s[60:63], s14 offen sc1
    s_mov_b64 exec, 0xff
    buffer_store_dwordx4 v[196:199], v253, s[60:63], s13 offen sc1
    s_add_u32 s13, s13, 147456
    s_nop 0
    buffer_store_dwordx4 v[196:199], v253, s[60:63], s13 offen sc1
    s_lshl_b32 s15, s10, 4
    s_add_u32 s15, s15, s5
    s_cmp_ge_u32 s15, 20
    s_cbranch_scc1 L_ps9
    s_mov_b32 exec_lo, 0xffffff
    s_mul_i32 s13, s6, 20
    s_add_u32 s13, s13, s15
    s_lshl_b32 s13, s13, 9
    s_add_u32 s13, s13, 262144
    buffer_store_dwordx4 v[196:199], v253, s[60:63], s13 offen sc1
L_ps9:
    s_mov_b64 exec, -1
    v_mfma_f32_32x32x16_bf16 v[64:79], v[112:115], v[124:127], v[64:79]
    ds_read_b128 v[44:47], v6 offset:32768
    ds_read_b64_tr_b16 v[32:33], v10 offset:49312
    ds_read_b64_tr_b16 v[34:35], v10 offset:49456
    ds_read_b64_tr_b16 v[36:37], v11 offset:49312
    v_mfma_f32_32x32x16_bf16 v[80:95], v[116:119], v[124:127], v[80:95]
    ds_read_b64_tr_b16 v[38:39], v12 offset:49312
    ds_read_b64_tr_b16 v[40:41], v28 offset:49312
    ds_read_b64_tr_b16 v[42:43], v28 offset:49456
    ds_read_b128 v[60:63], v7 offset:32768
    v_mfma_f32_32x32x16_bf16 v[96:111], v[120:123], v[124:127], v[96:111]
    ds_read_b64_tr_b16 v[48:49], v10 offset:51616
    ds_read_b64_tr_b16 v[50:51], v10 offset:51760
    ds_read_b64_tr_b16 v[52:53], v13 offset:49312
    v_mfma_f32_32x32x16_bf16 v[64:79], v[216:219], v[228:231], v[64:79]
    ds_read_b64_tr_b16 v[54:55], v14 offset:49312
    ds_read_b64_tr_b16 v[56:57], v28 offset:51616
    ds_read_b64_tr_b16 v[58:59], v28 offset:51760
    v_mfma_f32_32x32x16_bf16 v[80:95], v[220:223], v[228:231], v[80:95]
    s_waitcnt lgkmcnt(12)
    ds_read_b128 v[124:127], v8 offset:32768
    ds_read_b64_tr_b16 v[112:113], v10 offset:53920
    ds_read_b64_tr_b16 v[114:115], v10 offset:54064
    v_mfma_f32_32x32x16_bf16 v[96:111], v[224:227], v[228:231], v[96:111]
    s_waitcnt lgkmcnt(12)
    ds_read_b64_tr_b16 v[116:117], v15 offset:49312
    ds_read_b64_tr_b16 v[118:119], v16 offset:49312
    ds_read_b64_tr_b16 v[120:121], v28 offset:53920
    v_mfma_f32_32x32x16_bf16 v[64:79], v[32:35], v[44:47], v[64:79]
    s_waitcnt lgkmcnt(12)
    ds_read_b64_tr_b16 v[122:123], v28 offset:54064
    ds_read_b128 v[228:231], v9 offset:32768
    ds_read_b64_tr_b16 v[216:217], v10 offset:56224
    v_mfma_f32_32x32x16_bf16 v[80:95], v[36:39], v[44:47], v[80:95]
    s_waitcnt lgkmcnt(12)
    ds_read_b64_tr_b16 v[218:219], v10 offset:56368
    ds_read_b64_tr_b16 v[220:221], v17 offset:49312
    ds_read_b64_tr_b16 v[222:223], v18 offset:49312
    v_mfma_f32_32x32x16_bf16 v[96:111], v[40:43], v[44:47], v[96:111]
    s_waitcnt lgkmcnt(13)
    ds_read_b64_tr_b16 v[224:225], v28 offset:56224
    ds_read_b64_tr_b16 v[226:227], v28 offset:56368
    v_mfma_f32_32x32x16_bf16 v[64:79], v[48:51], v[60:63], v[64:79]
    v_mfma_f32_32x32x16_bf16 v[80:95], v[52:55], v[60:63], v[80:95]
    s_waitcnt lgkmcnt(14)
    v_mfma_f32_32x32x16_bf16 v[96:111], v[56:59], v[60:63], v[96:111]
    s_waitcnt lgkmcnt(0)
    s_barrier
    v_mfma_f32_32x32x16_bf16 v[64:79], v[112:115], v[124:127], v[64:79]
    v_mfma_f32_32x32x16_bf16 v[80:95], v[116:119], v[124:127], v[80:95]
    v_mfma_f32_32x32x16_bf16 v[96:111], v[120:123], v[124:127], v[96:111]
    v_mfma_f32_32x32x16_bf16 v[64:79], v[216:219], v[228:231], v[64:79]
    v_mfma_f32_32x32x16_bf16 v[80:95], v[220:223], v[228:231], v[80:95]
    v_mfma_f32_32x32x16_bf16 v[96:111], v[224:227], v[228:231], v[96:111]
    s_setprio 3
    s_cmp_eq_u32 s11, 0
    s_cbranch_scc1 L_pr10
    s_setprio 2
L_pr10:
    s_mov_b32 vcc_lo, 0
    s_mov_b32 vcc_hi, -1
    s_nop 4
    v_cvt_pk_bf16_f32 v216, v64, v65
    v_cvt_pk_bf16_f32 v217, v66, v67
    v_cvt_pk_bf16_f32 v218, v68, v69
    v_cvt_pk_bf16_f32 v219, v70, v71
    v_cvt_pk_bf16_f32 v220, v72, v73
    v_cvt_pk_bf16_f32 v221, v74, v75
    v_cvt_pk_bf16_f32 v222, v76, v77
    v_cvt_pk_bf16_f32 v223, v78, v79
    v_cvt_pk_bf16_f32 v224, v80, v81
    v_cvt_pk_bf16_f32 v225, v82, v83
    v_cvt_pk_bf16_f32 v226, v84, v85
    v_cvt_pk_bf16_f32 v227, v86, v87
    v_cvt_pk_bf16_f32 v228, v88, v89
    v_cvt_pk_bf16_f32 v229, v90, v91
    ds_write2_b32 v200, v226, v227 offset0:0 offset1:1
    ds_write2_b32 v200, v228, v229 offset0:4 offset1:5
    v_mfma_f32_32x32x16_bf16 v[112:127], v[144:147], v[216:219], 0
    s_cmp_eq_u32 s11, 1
    s_cselect_b64 s[12:13], -1, 0
    v_cndmask_b32 v6, v80, v82, s[12:13]
    v_cndmask_b32 v7, v81, v83, s[12:13]
    v_cndmask_b32 v8, v224, v225, s[12:13]
    v_mul_f32 v9, v6, v6
    v_fmac_f32 v9, v7, v7
    v_mfma_f32_32x32x16_bf16 v[64:79], v[156:159], v[216:219], 0
    v_cndmask_b32 v9, 0, v9, vcc
    v_fmac_f32 v9, v84, v84
    v_fmac_f32 v9, v85, v85
    v_fmac_f32 v9, v86, v86
    v_fmac_f32 v9, v87, v87
    v_fmac_f32 v9, v88, v88
    v_mfma_f32_32x32x16_bf16 v[112:127], v[148:151], v[220:223], v[112:127]
    v_fmac_f32 v9, v89, v89
    v_fmac_f32 v9, v90, v90
    v_fmac_f32 v9, v91, v91
    v_mov_b32 v10, v9
    v_mfma_f32_32x32x16_bf16 v[64:79], v[208:211], v[220:223], v[64:79]
    s_nop 0
    v_permlane32_swap_b32 v9, v10
    v_add_f32 v9, v9, v10
    v_sqrt_f32 v9, v9
    s_nop 0
    v_mul_f32 v9, 0xbf8147ae, v9
    v_mfma_f32_32x32x16_bf16 v[112:127], v[152:155], v[224:227], v[112:127]
    v_cvt_pk_bf16_f32 v9, v9, 0
    v_cndmask_b32 v8, v9, v8, vcc
    ds_write_b32 v201, v8
    v_mul_f32 v6, 0xbfb8aa3b, v92
    v_exp_f32 v6, v6
    v_mfma_f32_32x32x16_bf16 v[64:79], v[212:215], v[224:227], v[64:79]
    v_add_f32 v7, 1.0, v6
    v_rcp_f32 v7, v7
    s_nop 0
    v_sub_f32 v6, 1.0, v7
    s_andn2_b64 exec, vcc, s[12:13]
    ds_write2st64_b32 v202, v7, v6 offset0:0 offset1:2
    s_mov_b64 exec, -1
    v_mov_b32 v6, 162120
    v_mov_b32 v7, 1
    s_mov_b64 exec, 1
    ds_add_u32 v6, v7
    s_mov_b64 exec, -1
    s_mov_b32 s77, 0
    v_cvt_pk_bf16_f32 v8, v96, v97
    v_cvt_pk_bf16_f32 v9, v98, v99
    v_cvt_pk_bf16_f32 v10, v100, v101
    v_cvt_pk_bf16_f32 v11, v102, v103
    ds_write2_b64 v203, v[8:9], v[10:11] offset0:0 offset1:2
    v_cvt_pk_bf16_f32 v12, v104, v105
    v_cvt_pk_bf16_f32 v13, v106, v107
    v_cvt_pk_bf16_f32 v14, v108, v109
    v_cvt_pk_bf16_f32 v15, v110, v111
    ds_write2_b64 v203, v[12:13], v[14:15] offset0:4 offset1:6
    v_cvt_pk_bf16_f32 v16, v92, v93
    v_cvt_pk_bf16_f32 v17, v94, v95
    v_mov_b32 v18, 0x3f80
    v_cndmask_b32 v16, v16, v18, vcc
    v_cndmask_b32 v17, v17, 0, vcc
    ds_write_b64 v203, v[16:17] offset:64
    s_cmp_eq_u32 s11, 1
    s_cbranch_scc1 L_lo11
    buffer_load_dwordx3 v[104:106], v31, s[60:63], s83 offen sc1
    buffer_load_dwordx3 v[108:110], v31, s[60:63], s43 offen sc1
L_lo11:
    v_max3_f32 v20, v112, v113, v114
    v_min3_f32 v22, v112, v113, v114
    v_max3_f32 v20, v20, v115, v116
    v_min3_f32 v22, v22, v115, v116
    v_max3_f32 v20, v20, v117, v118
    v_min3_f32 v22, v22, v117, v118
    v_max3_f32 v20, v20, v119, v120
    v_min3_f32 v22, v22, v119, v120
    v_max3_f32 v20, v20, v121, v122
    v_min3_f32 v22, v22, v121, v122
    v_max3_f32 v20, v20, v123, v124
    v_min3_f32 v22, v22, v123, v124
    v_max3_f32 v20, v20, v125, v126
    v_min3_f32 v22, v22, v125, v126
    v_max3_f32 v20, v20, v127, v64
    v_min3_f32 v22, v22, v127, v64
    v_max_f32 v20, v20, v65
    v_min_f32 v22, v22, v65
    v_mul_f32 v20, 0xbfb8aa3b, v20
    v_mul_f32 v22, 0x3fb8aa3b, v22
    v_pk_fma_f32 v[68:69], v[112:113], s[86:87], v[20:21] op_sel_hi:[1,1,0]
    v_pk_fma_f32 v[86:87], v[112:113], s[86:87], v[22:23] op_sel_hi:[1,1,0] neg_lo:[1,0,0] neg_hi:[1,0,0]
    v_pk_fma_f32 v[70:71], v[114:115], s[86:87], v[20:21] op_sel_hi:[1,1,0]
    v_pk_fma_f32 v[88:89], v[114:115], s[86:87], v[22:23] op_sel_hi:[1,1,0] neg_lo:[1,0,0] neg_hi:[1,0,0]
    v_pk_fma_f32 v[72:73], v[116:117], s[86:87], v[20:21] op_sel_hi:[1,1,0]
    v_pk_fma_f32 v[90:91], v[116:117], s[86:87], v[22:23] op_sel_hi:[1,1,0] neg_lo:[1,0,0] neg_hi:[1,0,0]
    v_pk_fma_f32 v[74:75], v[118:119], s[86:87], v[20:21] op_sel_hi:[1,1,0]
    v_pk_fma_f32 v[92:93], v[118:119], s[86:87], v[22:23] op_sel_hi:[1,1,0] neg_lo:[1,0,0] neg_hi:[1,0,0]
    v_pk_fma_f32 v[76:77], v[120:121], s[86:87], v[20:21] op_sel_hi:[1,1,0]
    v_pk_fma_f32 v[94:95], v[120:121], s[86:87], v[22:23] op_sel_hi:[1,1,0] neg_lo:[1,0,0] neg_hi:[1,0,0]
    v_pk_fma_f32 v[78:79], v[122:123], s[86:87], v[20:21] op_sel_hi:[1,1,0]
    v_pk_fma_f32 v[96:97], v[122:123], s[86:87], v[22:23] op_sel_hi:[1,1,0] neg_lo:[1,0,0] neg_hi:[1,0,0]
    v_pk_fma_f32 v[80:81], v[124:125], s[86:87], v[20:21] op_sel_hi:[1,1,0]
    v_pk_fma_f32 v[98:99], v[124:125], s[86:87], v[22:23] op_sel_hi:[1,1,0] neg_lo:[1,0,0] neg_hi:[1,0,0]
    v_pk_fma_f32 v[82:83], v[126:127], s[86:87], v[20:21] op_sel_hi:[1,1,0]
    v_pk_fma_f32 v[100:101], v[126:127], s[86:87], v[22:23] op_sel_hi:[1,1,0] neg_lo:[1,0,0] neg_hi:[1,0,0]
    v_pk_fma_f32 v[84:85], v[64:65], s[86:87], v[20:21] op_sel_hi:[1,1,0]
    v_pk_fma_f32 v[102:103], v[64:65], s[86:87], v[22:23] op_sel_hi:[1,1,0] neg_lo:[1,0,0] neg_hi:[1,0,0]
    v_exp_f32 v68, v68
    v_exp_f32 v69, v69
    v_exp_f32 v70, v70
    v_exp_f32 v71, v71
    v_exp_f32 v72, v72
    v_exp_f32 v73, v73
    v_exp_f32 v74, v74
    v_exp_f32 v75, v75
    v_exp_f32 v76, v76
    v_exp_f32 v77, v77
    v_exp_f32 v78, v78
    v_exp_f32 v79, v79
    v_exp_f32 v80, v80
    v_exp_f32 v81, v81
    v_exp_f32 v82, v82
    v_exp_f32 v83, v83
    v_exp_f32 v84, v84
    v_exp_f32 v85, v85
    v_exp_f32 v86, v86
    v_exp_f32 v87, v87
    v_exp_f32 v88, v88
    v_exp_f32 v89, v89
    v_exp_f32 v90, v90
    v_exp_f32 v91, v91
    v_exp_f32 v92, v92
    v_exp_f32 v93, v93
    v_exp_f32 v94, v94
    v_exp_f32 v95, v95
    v_exp_f32 v96, v96
    v_exp_f32 v97, v97
    v_exp_f32 v98, v98
    v_exp_f32 v99, v99
    v_exp_f32 v100, v100
    v_exp_f32 v101, v101
    v_exp_f32 v102, v102
    v_exp_f32 v103, v103
    s_cmp_eq_u32 s11, 1
    s_cbranch_scc1 L_fl12
    s_mov_b32 s14, 0x00030003
    s_mov_b32 s15, 0x00000003
    s_waitcnt vmcnt(0)
    v_xor_b32 v4, s9, v104
    v_bitop3_b32 v4, v4, s9, v106 bitop3:0xf6
    v_bitop3_b32 v4, v4, s9, v108 bitop3:0xf6
    v_bitop3_b32 v4, v4, s9, v110 bitop3:0xf6
    v_cmp_ne_u32 vcc, 0, v4
    s_nop 0
    s_and_b64 s[12:13], vcc, s[14:15]
    s_cbranch_scc1 L_fl13
    s_lshl_b32 s12, s4, 12
    s_add_u32 s55, s12, 163840
    s_add_u32 s53, s12, 65536
    s_add_u32 s54, s78, 131072
    buffer_load_dword v160, v246, s[60:63], s54 offen offset:0 sc1
    buffer_load_dwordx4 v[128:131], v245, s[60:63], s53 offen offset:0 sc1
    buffer_load_dwordx4 v[132:135], v245, s[60:63], s53 offen offset:512 sc1
    buffer_load_dwordx4 v[168:171], v247, s[60:63], s55 offen offset:0 sc1
    buffer_load_dwordx4 v[172:175], v247, s[60:63], s55 offen offset:256 sc1
    buffer_load_dwordx4 v[176:179], v247, s[60:63], s55 offen offset:512 sc1
    buffer_load_dwordx4 v[180:183], v247, s[60:63], s55 offen offset:768 sc1
    buffer_load_dword v162, v246, s[60:63], s54 offen offset:256 sc1
    buffer_load_dwordx4 v[136:139], v245, s[60:63], s53 offen offset:1024 sc1
    buffer_load_dwordx4 v[140:143], v245, s[60:63], s53 offen offset:1536 sc1
    buffer_load_dwordx4 v[184:187], v247, s[60:63], s55 offen offset:1024 sc1
    buffer_load_dwordx4 v[188:191], v247, s[60:63], s55 offen offset:1280 sc1
    buffer_load_dwordx4 v[192:195], v247, s[60:63], s55 offen offset:1536 sc1
    buffer_load_dwordx4 v[196:199], v247, s[60:63], s55 offen offset:1792 sc1
    buffer_load_dword v164, v246, s[60:63], s54 offen offset:512 sc1
    buffer_load_dwordx4 v[144:147], v245, s[60:63], s53 offen offset:2048 sc1
    buffer_load_dwordx4 v[148:151], v245, s[60:63], s53 offen offset:2560 sc1
    s_mov_b32 s77, 1
    s_branch L_fl12
L_fl13:
    buffer_load_dwordx3 v[104:106], v31, s[60:63], s83 offen sc1
    buffer_load_dwordx3 v[108:110], v31, s[60:63], s43 offen sc1
L_fl12:
    v_pk_add_f32 v[24:25], v[68:69], v[70:71]
    v_pk_add_f32 v[26:27], v[86:87], v[88:89]
    v_pk_add_f32 v[24:25], v[24:25], v[72:73]
    v_pk_add_f32 v[26:27], v[26:27], v[90:91]
    v_pk_add_f32 v[24:25], v[24:25], v[74:75]
    v_pk_add_f32 v[26:27], v[26:27], v[92:93]
    v_pk_add_f32 v[24:25], v[24:25], v[76:77]
    v_pk_add_f32 v[26:27], v[26:27], v[94:95]
    v_pk_add_f32 v[24:25], v[24:25], v[78:79]
    v_pk_add_f32 v[26:27], v[26:27], v[96:97]
    v_pk_add_f32 v[24:25], v[24:25], v[80:81]
    v_pk_add_f32 v[26:27], v[26:27], v[98:99]
    v_pk_add_f32 v[24:25], v[24:25], v[82:83]
    v_pk_add_f32 v[26:27], v[26:27], v[100:101]
    v_pk_add_f32 v[24:25], v[24:25], v[84:85]
    v_pk_add_f32 v[26:27], v[26:27], v[102:103]
    v_add_f32 v24, v24, v25
    v_add_f32 v26, v26, v27
    v_rcp_f32 v24, v24
    v_rcp_f32 v26, v26
    v_mov_b32 v50, 0
    v_mov_b32 v51, 0
    v_pk_mul_f32 v[68:69], v[68:69], v[24:25] op_sel_hi:[1,0]
    v_cvt_pk_bf16_f32 v32, v68, v69
    v_pk_mul_f32 v[70:71], v[70:71], v[24:25] op_sel_hi:[1,0]
    v_cvt_pk_bf16_f32 v33, v70, v71
    v_pk_mul_f32 v[72:73], v[72:73], v[24:25] op_sel_hi:[1,0]
    v_cvt_pk_bf16_f32 v34, v72, v73
    v_pk_mul_f32 v[74:75], v[74:75], v[24:25] op_sel_hi:[1,0]
    v_cvt_pk_bf16_f32 v35, v74, v75
    ds_write_b128 v204, v[32:35] offset:0
    v_pk_mul_f32 v[76:77], v[76:77], v[24:25] op_sel_hi:[1,0]
    v_cvt_pk_bf16_f32 v36, v76, v77
    v_pk_mul_f32 v[78:79], v[78:79], v[24:25] op_sel_hi:[1,0]
    v_cvt_pk_bf16_f32 v37, v78, v79
    v_pk_mul_f32 v[80:81], v[80:81], v[24:25] op_sel_hi:[1,0]
    v_cvt_pk_bf16_f32 v38, v80, v81
    v_pk_mul_f32 v[82:83], v[82:83], v[24:25] op_sel_hi:[1,0]
    v_cvt_pk_bf16_f32 v39, v82, v83
    ds_write_b128 v204, v[36:39] offset:16
    v_pk_mul_f32 v[84:85], v[84:85], v[24:25] op_sel_hi:[1,0]
    v_cvt_pk_bf16_f32 v40, v84, v85
    v_pk_mul_f32 v[86:87], v[86:87], v[26:27] op_sel_hi:[1,0]
    v_cvt_pk_bf16_f32 v41, v86, v87
    v_pk_mul_f32 v[88:89], v[88:89], v[26:27] op_sel_hi:[1,0]
    v_cvt_pk_bf16_f32 v42, v88, v89
    v_pk_mul_f32 v[90:91], v[90:91], v[26:27] op_sel_hi:[1,0]
    v_cvt_pk_bf16_f32 v43, v90, v91
    ds_write_b128 v204, v[40:43] offset:32
    v_pk_mul_f32 v[92:93], v[92:93], v[26:27] op_sel_hi:[1,0]
    v_cvt_pk_bf16_f32 v44, v92, v93
    v_pk_mul_f32 v[94:95], v[94:95], v[26:27] op_sel_hi:[1,0]
    v_cvt_pk_bf16_f32 v45, v94, v95
    v_pk_mul_f32 v[96:97], v[96:97], v[26:27] op_sel_hi:[1,0]
    v_cvt_pk_bf16_f32 v46, v96, v97
    v_pk_mul_f32 v[98:99], v[98:99], v[26:27] op_sel_hi:[1,0]
    v_cvt_pk_bf16_f32 v47, v98, v99
    ds_write_b128 v204, v[44:47] offset:48
    v_pk_mul_f32 v[100:101], v[100:101], v[26:27] op_sel_hi:[1,0]
    v_cvt_pk_bf16_f32 v48, v100, v101
    v_pk_mul_f32 v[102:103], v[102:103], v[26:27] op_sel_hi:[1,0]
    v_cvt_pk_bf16_f32 v49, v102, v103
    ds_write_b128 v204, v[48:51] offset:64
    v_mov_b32 v4, 162064
    v_mov_b32 v5, 1
    s_mov_b64 exec, 1
    ds_add_u32 v4, v5
    s_mov_b64 exec, -1
    s_cmp_lt_u32 s4, 4
    s_cbranch_scc1 L_leadkv
    v_mov_b32 v2, 162064
    s_mov_b32 s82, 262144
L_ls14:
    ds_read_b32 v3, v2
    s_waitcnt lgkmcnt(0)
    v_readfirstlane_b32 s12, v3
    s_nop 0
    s_cmp_ge_u32 s12, 8
    s_cbranch_scc1 L_lo15
    s_sleep 1
    s_sub_u32 s82, s82, 1
    s_cbranch_scc0 L_ls14
L_lo15:
    ds_read_b64_tr_b16 v[128:129], v206 offset:0
    ds_read_b64_tr_b16 v[130:131], v206 offset:80
    ds_read_b64_tr_b16 v[132:133], v205 offset:0
    ds_read_b64_tr_b16 v[134:135], v205 offset:80
    ds_read_b64_tr_b16 v[136:137], v205 offset:64
    ds_read_b64_tr_b16 v[138:139], v205 offset:144
    ds_read_b64_tr_b16 v[140:141], v206 offset:1280
    ds_read_b64_tr_b16 v[142:143], v206 offset:1360
    ds_read_b64_tr_b16 v[144:145], v205 offset:1280
    ds_read_b64_tr_b16 v[146:147], v205 offset:1360
    ds_read_b64_tr_b16 v[148:149], v205 offset:1344
    ds_read_b64_tr_b16 v[150:151], v205 offset:1424
    s_lshl_b32 s12, s6, 4
    s_add_u32 s12, s12, s5
    s_lshl_b32 s12, s12, 2
    s_add_u32 s12, s12, s10
    s_lshl_b32 s12, s12, 5
    s_add_u32 s12, s12, 16384
    s_mov_b64 exec, 1
    v_mov_b32 v2, s12
    v_mov_b32 v3, s9
    s_waitcnt vmcnt(0)
    buffer_store_dword v3, v2, s[60:63], 0 offen sc1
    s_mov_b64 exec, -1
    s_waitcnt lgkmcnt(6)
    ds_read_b64_tr_b16 v[152:153], v206 offset:2560
    ds_read_b64_tr_b16 v[154:155], v206 offset:2640
    ds_read_b64_tr_b16 v[156:157], v205 offset:2560
    ds_read_b64_tr_b16 v[158:159], v205 offset:2640
    ds_read_b64_tr_b16 v[160:161], v205 offset:2624
    ds_read_b64_tr_b16 v[162:163], v205 offset:2704
    v_mfma_f32_32x32x16_bf16 v[64:79], v[132:135], v[128:131], 0
    v_mfma_f32_32x32x16_bf16 v[80:95], v[136:139], v[128:131], 0
    s_waitcnt lgkmcnt(6)
    ds_read_b64_tr_b16 v[164:165], v206 offset:3840
    ds_read_b64_tr_b16 v[166:167], v206 offset:3920
    ds_read_b64_tr_b16 v[168:169], v205 offset:3840
    ds_read_b64_tr_b16 v[170:171], v205 offset:3920
    ds_read_b64_tr_b16 v[172:173], v205 offset:3904
    ds_read_b64_tr_b16 v[174:175], v205 offset:3984
    v_mfma_f32_32x32x16_bf16 v[64:79], v[144:147], v[140:143], v[64:79]
    v_mfma_f32_32x32x16_bf16 v[80:95], v[148:151], v[140:143], v[80:95]
    s_waitcnt lgkmcnt(6)
    ds_read_b64_tr_b16 v[128:129], v206 offset:5120
    ds_read_b64_tr_b16 v[130:131], v206 offset:5200
    ds_read_b64_tr_b16 v[132:133], v205 offset:5120
    ds_read_b64_tr_b16 v[134:135], v205 offset:5200
    ds_read_b64_tr_b16 v[136:137], v205 offset:5184
    ds_read_b64_tr_b16 v[138:139], v205 offset:5264
    v_mfma_f32_32x32x16_bf16 v[64:79], v[156:159], v[152:155], v[64:79]
    v_mfma_f32_32x32x16_bf16 v[80:95], v[160:163], v[152:155], v[80:95]
    s_waitcnt lgkmcnt(6)
    ds_read_b64_tr_b16 v[140:141], v206 offset:6400
    ds_read_b64_tr_b16 v[142:143], v206 offset:6480
    ds_read_b64_tr_b16 v[144:145], v205 offset:6400
    ds_read_b64_tr_b16 v[146:147], v205 offset:6480
    ds_read_b64_tr_b16 v[148:149], v205 offset:6464
    ds_read_b64_tr_b16 v[150:151], v205 offset:6544
    v_mfma_f32_32x32x16_bf16 v[64:79], v[168:171], v[164:167], v[64:79]
    v_mfma_f32_32x32x16_bf16 v[80:95], v[172:175], v[164:167], v[80:95]
    s_waitcnt lgkmcnt(6)
    ds_read_b64_tr_b16 v[152:153], v206 offset:7680
    ds_read_b64_tr_b16 v[154:155], v206 offset:7760
    ds_read_b64_tr_b16 v[156:157], v205 offset:7680
    ds_read_b64_tr_b16 v[158:159], v205 offset:7760
    ds_read_b64_tr_b16 v[160:161], v205 offset:7744
    ds_read_b64_tr_b16 v[162:163], v205 offset:7824
    v_mfma_f32_32x32x16_bf16 v[64:79], v[132:135], v[128:131], v[64:79]
    v_mfma_f32_32x32x16_bf16 v[80:95], v[136:139], v[128:131], v[80:95]
    s_waitcnt lgkmcnt(6)
    ds_read_b64_tr_b16 v[164:165], v206 offset:8960
    ds_read_b64_tr_b16 v[166:167], v206 offset:9040
    ds_read_b64_tr_b16 v[168:169], v205 offset:8960
    ds_read_b64_tr_b16 v[170:171], v205 offset:9040
    ds_read_b64_tr_b16 v[172:173], v205 offset:9024
    ds_read_b64_tr_b16 v[174:175], v205 offset:9104
    v_mfma_f32_32x32x16_bf16 v[64:79], v[144:147], v[140:143], v[64:79]
    v_mfma_f32_32x32x16_bf16 v[80:95], v[148:151], v[140:143], v[80:95]
    s_waitcnt lgkmcnt(6)
    v_mfma_f32_32x32x16_bf16 v[64:79], v[156:159], v[152:155], v[64:79]
    v_mfma_f32_32x32x16_bf16 v[80:95], v[160:163], v[152:155], v[80:95]
    s_waitcnt lgkmcnt(0)
    v_mfma_f32_32x32x16_bf16 v[64:79], v[168:171], v[164:167], v[64:79]
    v_mfma_f32_32x32x16_bf16 v[80:95], v[172:175], v[164:167], v[80:95]
    v_mov_b32 v2, 162052
    v_mov_b32 v3, 1
    s_mov_b64 exec, 1
    ds_add_u32 v2, v3
    s_mov_b64 exec, -1
    s_lshl_b32 s12, s6, 4
    s_add_u32 s12, s12, s5
    s_mul_i32 s13, s12, 20480
    s_mul_i32 s14, s10, 5120
    s_add_u32 s13, s13, s14
    s_add_u32 s13, s13, 393216
    s_add_u32 s14, s13, 4096
    v_mov_b32 v4, 0xfff
    v_bfi_b32 v64, v4, s9, v64
    buffer_store_dwordx4 v[64:67], v253, s[60:63], s13 offen offset:0 sc1
    v_bfi_b32 v68, v4, s9, v68
    buffer_store_dwordx4 v[68:71], v253, s[60:63], s13 offen offset:1024 sc1
    v_bfi_b32 v72, v4, s9, v72
    buffer_store_dwordx4 v[72:75], v253, s[60:63], s13 offen offset:2048 sc1
    v_bfi_b32 v76, v4, s9, v76
    buffer_store_dwordx4 v[76:79], v253, s[60:63], s13 offen offset:3072 sc1
    v_bfi_b32 v80, v4, s9, v80
    v_bfi_b32 v84, v4, s9, v84
    s_mov_b32 exec_hi, 0
    buffer_store_dwordx4 v[80:83], v253, s[60:63], s14 offen offset:0 sc1
    buffer_store_dwordx4 v[84:87], v253, s[60:63], s14 offen offset:512 sc1
    s_mov_b64 exec, -1
    s_lshl_b32 s15, s10, 4
    s_add_u32 s15, s15, s5
    s_cmp_ge_u32 s15, 20
    s_cbranch_scc1 L_rj16
    v_mov_b32 v2, 162060
    s_mov_b32 s82, 262144
L_ls17:
    ds_read_b32 v3, v2
    s_waitcnt lgkmcnt(0)
    v_readfirstlane_b32 s12, v3
    s_nop 0
    s_cmp_ge_u32 s12, 4
    s_cbranch_scc1 L_lo18
    s_sleep 2
    s_sub_u32 s82, s82, 1
    s_cbranch_scc0 L_ls17
L_lo18:
    s_mov_b32 exec_lo, 0xffffff
    s_mov_b32 exec_hi, 0xffffff
    s_and_b32 s3, s9, 0xfff
    s_mov_b32 s82, 262144
L_rs19:
    s_mov_b32 s13, s81
    buffer_load_dwordx4 v[32:35], v242, s[60:63], s13 offen sc1
    s_add_u32 s13, s13, 20480
    buffer_load_dwordx4 v[36:39], v242, s[60:63], s13 offen sc1
    s_add_u32 s13, s13, 20480
    buffer_load_dwordx4 v[40:43], v242, s[60:63], s13 offen sc1
    s_add_u32 s13, s13, 20480
    buffer_load_dwordx4 v[44:47], v242, s[60:63], s13 offen sc1
    s_add_u32 s13, s13, 20480
    buffer_load_dwordx4 v[48:51], v242, s[60:63], s13 offen sc1
    s_add_u32 s13, s13, 20480
    buffer_load_dwordx4 v[52:55], v242, s[60:63], s13 offen sc1
    s_add_u32 s13, s13, 20480
    buffer_load_dwordx4 v[56:59], v242, s[60:63], s13 offen sc1
    s_add_u32 s13, s13, 20480
    buffer_load_dwordx4 v[60:63], v242, s[60:63], s13 offen sc1
    s_add_u32 s13, s13, 20480
    buffer_load_dwordx4 v[64:67], v242, s[60:63], s13 offen sc1
    s_add_u32 s13, s13, 20480
    buffer_load_dwordx4 v[68:71], v242, s[60:63], s13 offen sc1
    s_add_u32 s13, s13, 20480
    buffer_load_dwordx4 v[72:75], v242, s[60:63], s13 offen sc1
    s_add_u32 s13, s13, 20480
    buffer_load_dwordx4 v[76:79], v242, s[60:63], s13 offen sc1
    s_add_u32 s13, s13, 20480
    buffer_load_dwordx4 v[80:83], v242, s[60:63], s13 offen sc1
    s_add_u32 s13, s13, 20480
    buffer_load_dwordx4 v[84:87], v242, s[60:63], s13 offen sc1
    s_add_u32 s13, s13, 20480
    buffer_load_dwordx4 v[88:91], v242, s[60:63], s13 offen sc1
    s_add_u32 s13, s13, 20480
    buffer_load_dwordx4 v[92:95], v242, s[60:63], s13 offen sc1
    s_waitcnt vmcnt(15)
    v_xor_b32 v32, s3, v32
    s_waitcnt vmcnt(14)
    v_xor_b32 v36, s3, v36
    v_or3_b32 v7, v32, v36, 0
    s_waitcnt vmcnt(13)
    v_xor_b32 v40, s3, v40
    s_waitcnt vmcnt(12)
    v_xor_b32 v44, s3, v44
    v_or3_b32 v7, v40, v44, v7
    s_waitcnt vmcnt(11)
    v_xor_b32 v48, s3, v48
    s_waitcnt vmcnt(10)
    v_xor_b32 v52, s3, v52
    v_or3_b32 v7, v48, v52, v7
    s_waitcnt vmcnt(9)
    v_xor_b32 v56, s3, v56
    s_waitcnt vmcnt(8)
    v_xor_b32 v60, s3, v60
    v_or3_b32 v7, v56, v60, v7
    s_waitcnt vmcnt(7)
    v_xor_b32 v64, s3, v64
    s_waitcnt vmcnt(6)
    v_xor_b32 v68, s3, v68
    v_or3_b32 v7, v64, v68, v7
    s_waitcnt vmcnt(5)
    v_xor_b32 v72, s3, v72
    s_waitcnt vmcnt(4)
    v_xor_b32 v76, s3, v76
    v_or3_b32 v7, v72, v76, v7
    s_waitcnt vmcnt(3)
    v_xor_b32 v80, s3, v80
    s_waitcnt vmcnt(2)
    v_xor_b32 v84, s3, v84
    v_or3_b32 v7, v80, v84, v7
    s_waitcnt vmcnt(1)
    v_xor_b32 v88, s3, v88
    s_waitcnt vmcnt(0)
    v_xor_b32 v92, s3, v92
    v_or3_b32 v7, v88, v92, v7
    v_and_b32 v7, 0xfff, v7
    v_cmp_ne_u32 vcc, 0, v7
    s_cbranch_vccz L_ro20
    s_sleep 4
    s_sub_u32 s82, s82, 1
    s_cbranch_scc0 L_rs19
L_ro20:
    s_mov_b64 exec, -1
    s_mul_i32 s13, s6, 20
    s_add_u32 s13, s13, s15
    s_lshl_b32 s13, s13, 9
    s_add_u32 s13, s13, 262144
    v_add_f32 v32, v32, v64
    v_add_f32 v33, v33, v65
    v_add_f32 v34, v34, v66
    v_add_f32 v35, v35, v67
    v_add_f32 v36, v36, v68
    v_add_f32 v37, v37, v69
    v_add_f32 v38, v38, v70
    v_add_f32 v39, v39, v71
    v_add_f32 v40, v40, v72
    v_add_f32 v41, v41, v73
    v_add_f32 v42, v42, v74
    v_add_f32 v43, v43, v75
    v_add_f32 v44, v44, v76
    v_add_f32 v45, v45, v77
    v_add_f32 v46, v46, v78
    v_add_f32 v47, v47, v79
    v_add_f32 v48, v48, v80
    v_add_f32 v49, v49, v81
    v_add_f32 v50, v50, v82
    v_add_f32 v51, v51, v83
    v_add_f32 v52, v52, v84
    v_add_f32 v53, v53, v85
    v_add_f32 v54, v54, v86
    v_add_f32 v55, v55, v87
    v_add_f32 v56, v56, v88
    v_add_f32 v57, v57, v89
    v_add_f32 v58, v58, v90
    v_add_f32 v59, v59, v91
    v_add_f32 v60, v60, v92
    v_add_f32 v61, v61, v93
    v_add_f32 v62, v62, v94
    v_add_f32 v63, v63, v95
    v_add_f32 v32, v32, v48
    v_add_f32 v33, v33, v49
    v_add_f32 v34, v34, v50
    v_add_f32 v35, v35, v51
    v_add_f32 v36, v36, v52
    v_add_f32 v37, v37, v53
    v_add_f32 v38, v38, v54
    v_add_f32 v39, v39, v55
    v_add_f32 v40, v40, v56
    v_add_f32 v41, v41, v57
    v_add_f32 v42, v42, v58
    v_add_f32 v43, v43, v59
    v_add_f32 v44, v44, v60
    v_add_f32 v45, v45, v61
    v_add_f32 v46, v46, v62
    v_add_f32 v47, v47, v63
    v_add_f32 v32, v32, v40
    v_add_f32 v33, v33, v41
    v_add_f32 v34, v34, v42
    v_add_f32 v35, v35, v43
    v_add_f32 v36, v36, v44
    v_add_f32 v37, v37, v45
    v_add_f32 v38, v38, v46
    v_add_f32 v39, v39, v47
    v_add_f32 v32, v32, v36
    v_add_f32 v33, v33, v37
    v_add_f32 v34, v34, v38
    v_add_f32 v35, v35, v39
    v_cvt_pk_bf16_f32 v32, v32, v33
    v_cvt_pk_bf16_f32 v33, v34, v35
    s_nop 0
    v_permlane32_swap_b32 v32, v34
    v_permlane32_swap_b32 v33, v35
    s_mov_b32 exec_lo, 0xffffff
    s_mov_b32 exec_hi, 0
    buffer_store_dwordx4 v[32:35], v253, s[60:63], s13 offen sc1
    s_mov_b64 exec, -1
    v_mov_b32 v2, 162136
    v_mov_b32 v3, 1
    s_mov_b64 exec, 1
    ds_add_u32 v2, v3
    s_mov_b64 exec, -1
L_rj16:
    v_mov_b32 v2, 162136
    s_mov_b32 s82, 262144
L_ls21:
    ds_read_b32 v3, v2
    s_waitcnt lgkmcnt(0)
    v_readfirstlane_b32 s12, v3
    s_nop 0
    s_cmp_ge_u32 s12, 1
    s_cbranch_scc1 L_lo22
    s_sleep 6
    s_sub_u32 s82, s82, 1
    s_cbranch_scc0 L_ls21
L_lo22:
    s_branch L_folkv
L_front1:
    s_lshl_b32 s12, s5, 2
    s_add_u32 s12, s12, s10
    s_lshl_b32 s13, s6, 15
    s_lshl_b32 s14, s12, 9
    s_add_u32 s13, s13, s14
    s_add_u32 s13, s13, 65536
    s_lshl_b32 s14, s12, 7
    s_add_u32 s14, s14, 131072
    s_cmp_eq_u32 s6, 2
    s_cselect_b32 s81, s14, s13
    s_cselect_b32 s15, 8, 32
    s_cmp_lt_u32 s6, 6
    s_cselect_b32 s3, s11, 0
    s_mul_i32 s15, s15, s3
    v_cmp_gt_u32 vcc, s15, v1
    v_mov_b32 v20, 2147483648
    v_mov_b32 v128, -1
    v_cndmask_b32 v21, v20, v253, vcc
    v_mov_b32 v129, -1
    v_mov_b32 v130, -1
    v_mov_b32 v131, -1
    buffer_store_dwordx4 v[128:131], v21, s[60:63], s81 offen sc1
    s_lshl_b32 s12, s6, 4
    s_add_u32 s12, s12, s5
    s_mul_i32 s12, s12, 64
    s_add_u32 s12, s12, 49160
    s_cmp_eq_u32 s10, 0
    s_cselect_b32 s3, s3, 0
    v_cmp_gt_u32 vcc, s3, v1
    v_mov_b32 v19, s12
    s_cmp_eq_u32 s11, 0
    v_cndmask_b32 v19, v20, v19, vcc
    v_mov_b32 v20, s9
    s_cbranch_scc1 L_kmp
    s_setprio 1
L_kmp:
    s_waitcnt vmcnt(5)
    s_barrier
    ds_read_b128 v[44:47], v6 offset:0
    ds_read_b64_tr_b16 v[32:33], v10 offset:0
    ds_read_b64_tr_b16 v[34:35], v10 offset:144
    ds_read_b64_tr_b16 v[36:37], v11 offset:0
    ds_read_b64_tr_b16 v[38:39], v12 offset:0
    ds_read_b128 v[60:63], v7 offset:0
    ds_read_b64_tr_b16 v[48:49], v10 offset:2304
    ds_read_b64_tr_b16 v[50:51], v10 offset:2448
    ds_read_b64_tr_b16 v[52:53], v13 offset:0
    s_lshl_b32 s68, s72, 7
    s_add_u32 m0, s79, 32768
    s_add_u32 s68, s68, s73
    buffer_load_dwordx4 v3, s[44:47], s68 offen lds
    ds_read_b64_tr_b16 v[54:55], v14 offset:0
    ds_read_b128 v[124:127], v8 offset:0
    ds_read_b64_tr_b16 v[112:113], v10 offset:4608
    ds_read_b64_tr_b16 v[114:115], v10 offset:4752
    ds_read_b64_tr_b16 v[116:117], v15 offset:0
    ds_read_b64_tr_b16 v[118:119], v16 offset:0
    s_add_u32 m0, s79, 33792
    s_mul_i32 s69, s72, 221184
    buffer_load_dwordx4 v2, s[44:47], s68 offen lds
    s_waitcnt lgkmcnt(12)
    v_mfma_f32_32x32x16_bf16 v[64:79], v[32:35], v[44:47], v[64:79]
    ds_read_b128 v[228:231], v9 offset:0
    ds_read_b64_tr_b16 v[216:217], v10 offset:6912
    ds_read_b64_tr_b16 v[218:219], v10 offset:7056
    s_waitcnt lgkmcnt(13)
    v_mfma_f32_32x32x16_bf16 v[80:95], v[36:39], v[44:47], v[80:95]
    ds_read_b64_tr_b16 v[220:221], v17 offset:0
    ds_read_b64_tr_b16 v[222:223], v18 offset:0
    s_add_u32 m0, s78, 98464
    s_add_u32 s69, s69, s74
    buffer_load_dwordx4 v4, s[48:51], s69 offen lds
    s_waitcnt lgkmcnt(12)
    v_mfma_f32_32x32x16_bf16 v[64:79], v[48:51], v[60:63], v[64:79]
    s_mul_i32 s14, s72, s76
    s_add_u32 m0, s77, 49312
    s_add_u32 s14, s14, s75
    buffer_load_dwordx4 v5, s[52:55], s14 offen lds
    s_add_u32 s72, s72, 1
    s_cmp_ge_u32 s72, 9
    s_cselect_b32 s72, 0, s72
    s_waitcnt lgkmcnt(10)
    v_mfma_f32_32x32x16_bf16 v[80:95], v[52:55], v[60:63], v[80:95]
    s_waitcnt vmcnt(5) lgkmcnt(0)
    s_barrier
    v_mfma_f32_32x32x16_bf16 v[64:79], v[112:115], v[124:127], v[64:79]
    ds_read_b128 v[44:47], v6 offset:16384
    ds_read_b64_tr_b16 v[32:33], v10 offset:24656
    ds_read_b64_tr_b16 v[34:35], v10 offset:24800
    ds_read_b64_tr_b16 v[36:37], v11 offset:24656
    ds_read_b64_tr_b16 v[38:39], v12 offset:24656
    v_mfma_f32_32x32x16_bf16 v[80:95], v[116:119], v[124:127], v[80:95]
    ds_read_b128 v[60:63], v7 offset:16384
    ds_read_b64_tr_b16 v[48:49], v10 offset:26960
    ds_read_b64_tr_b16 v[50:51], v10 offset:27104
    ds_read_b64_tr_b16 v[52:53], v13 offset:24656
    s_lshl_b32 s68, s72, 7
    s_add_u32 m0, s79, 0
    s_add_u32 s68, s68, s73
    buffer_load_dwordx4 v3, s[44:47], s68 offen lds
    v_mfma_f32_32x32x16_bf16 v[64:79], v[216:219], v[228:231], v[64:79]
    ds_read_b64_tr_b16 v[54:55], v14 offset:24656
    ds_read_b128 v[124:127], v8 offset:16384
    ds_read_b64_tr_b16 v[112:113], v10 offset:29264
    v_mfma_f32_32x32x16_bf16 v[80:95], v[220:223], v[228:231], v[80:95]
    ds_read_b64_tr_b16 v[114:115], v10 offset:29408
    ds_read_b64_tr_b16 v[116:117], v15 offset:24656
    ds_read_b64_tr_b16 v[118:119], v16 offset:24656
    s_add_u32 m0, s79, 1024
    s_mul_i32 s69, s72, 221184
    buffer_load_dwordx4 v2, s[44:47], s68 offen lds
    s_waitcnt lgkmcnt(12)
    v_mfma_f32_32x32x16_bf16 v[64:79], v[32:35], v[44:47], v[64:79]
    ds_read_b128 v[228:231], v9 offset:16384
    ds_read_b64_tr_b16 v[216:217], v10 offset:31568
    ds_read_b64_tr_b16 v[218:219], v10 offset:31712
    s_waitcnt lgkmcnt(13)
    v_mfma_f32_32x32x16_bf16 v[80:95], v[36:39], v[44:47], v[80:95]
    ds_read_b64_tr_b16 v[220:221], v17 offset:24656
    ds_read_b64_tr_b16 v[222:223], v18 offset:24656
    s_add_u32 m0, s78, 49152
    s_add_u32 s69, s69, s74
    buffer_load_dwordx4 v4, s[48:51], s69 offen lds
    s_waitcnt lgkmcnt(12)
    v_mfma_f32_32x32x16_bf16 v[64:79], v[48:51], v[60:63], v[64:79]
    s_mul_i32 s14, s72, s76
    s_add_u32 m0, s77, 0
    s_add_u32 s14, s14, s75
    buffer_load_dwordx4 v5, s[52:55], s14 offen lds
    s_add_u32 s72, s72, 1
    s_cmp_ge_u32 s72, 9
    s_cselect_b32 s72, 0, s72
    s_waitcnt lgkmcnt(10)
    v_mfma_f32_32x32x16_bf16 v[80:95], v[52:55], v[60:63], v[80:95]
    s_waitcnt vmcnt(4) lgkmcnt(0)
    s_barrier
    v_mfma_f32_32x32x16_bf16 v[64:79], v[112:115], v[124:127], v[64:79]
    ds_read_b128 v[44:47], v6 offset:32768
    ds_read_b64_tr_b16 v[32:33], v10 offset:49312
    ds_read_b64_tr_b16 v[34:35], v10 offset:49456
    ds_read_b64_tr_b16 v[36:37], v11 offset:49312
    ds_read_b64_tr_b16 v[38:39], v12 offset:49312
    v_mfma_f32_32x32x16_bf16 v[80:95], v[116:119], v[124:127], v[80:95]
    ds_read_b128 v[60:63], v7 offset:32768
    ds_read_b64_tr_b16 v[48:49], v10 offset:51616
    ds_read_b64_tr_b16 v[50:51], v10 offset:51760
    ds_read_b64_tr_b16 v[52:53], v13 offset:49312
    s_lshl_b32 s68, s72, 7
    s_add_u32 m0, s79, 16384
    s_add_u32 s68, s68, s73
    buffer_load_dwordx4 v3, s[44:47], s68 offen lds
    v_mfma_f32_32x32x16_bf16 v[64:79], v[216:219], v[228:231], v[64:79]
    ds_read_b64_tr_b16 v[54:55], v14 offset:49312
    ds_read_b128 v[124:127], v8 offset:32768
    ds_read_b64_tr_b16 v[112:113], v10 offset:53920
    v_mfma_f32_32x32x16_bf16 v[80:95], v[220:223], v[228:231], v[80:95]
    ds_read_b64_tr_b16 v[114:115], v10 offset:54064
    ds_read_b64_tr_b16 v[116:117], v15 offset:49312
    ds_read_b64_tr_b16 v[118:119], v16 offset:49312
    s_add_u32 m0, s79, 17408
    s_mul_i32 s69, s72, 221184
    buffer_load_dwordx4 v2, s[44:47], s68 offen lds
    s_waitcnt lgkmcnt(12)
    v_mfma_f32_32x32x16_bf16 v[64:79], v[32:35], v[44:47], v[64:79]
    ds_read_b128 v[228:231], v9 offset:32768
    ds_read_b64_tr_b16 v[216:217], v10 offset:56224
    ds_read_b64_tr_b16 v[218:219], v10 offset:56368
    s_waitcnt lgkmcnt(13)
    v_mfma_f32_32x32x16_bf16 v[80:95], v[36:39], v[44:47], v[80:95]
    ds_read_b64_tr_b16 v[220:221], v17 offset:49312
    ds_read_b64_tr_b16 v[222:223], v18 offset:49312
    s_add_u32 m0, s78, 73808
    s_add_u32 s69, s69, s74
    buffer_load_dwordx4 v4, s[48:51], s69 offen lds
    s_waitcnt lgkmcnt(12)
    v_mfma_f32_32x32x16_bf16 v[64:79], v[48:51], v[60:63], v[64:79]
    s_mul_i32 s14, s72, s76
    s_add_u32 m0, s77, 24656
    s_add_u32 s14, s14, s75
    buffer_load_dwordx4 v5, s[52:55], s14 offen lds
    s_add_u32 s72, s72, 1
    s_cmp_ge_u32 s72, 9
    s_cselect_b32 s72, 0, s72
    s_waitcnt lgkmcnt(10)
    v_mfma_f32_32x32x16_bf16 v[80:95], v[52:55], v[60:63], v[80:95]
    buffer_store_dword v20, v19, s[60:63], 0 offen sc1
    s_waitcnt vmcnt(5) lgkmcnt(0)
    s_barrier
    v_mfma_f32_32x32x16_bf16 v[64:79], v[112:115], v[124:127], v[64:79]
    ds_read_b128 v[44:47], v6 offset:0
    ds_read_b64_tr_b16 v[32:33], v10 offset:0
    ds_read_b64_tr_b16 v[34:35], v10 offset:144
    ds_read_b64_tr_b16 v[36:37], v11 offset:0
    ds_read_b64_tr_b16 v[38:39], v12 offset:0
    v_mfma_f32_32x32x16_bf16 v[80:95], v[116:119], v[124:127], v[80:95]
    ds_read_b128 v[60:63], v7 offset:0
    ds_read_b64_tr_b16 v[48:49], v10 offset:2304
    ds_read_b64_tr_b16 v[50:51], v10 offset:2448
    ds_read_b64_tr_b16 v[52:53], v13 offset:0
    s_lshl_b32 s68, s72, 7
    s_add_u32 m0, s79, 32768
    s_add_u32 s68, s68, s73
    buffer_load_dwordx4 v3, s[44:47], s68 offen lds
    v_mfma_f32_32x32x16_bf16 v[64:79], v[216:219], v[228:231], v[64:79]
    ds_read_b64_tr_b16 v[54:55], v14 offset:0
    ds_read_b128 v[124:127], v8 offset:0
    ds_read_b64_tr_b16 v[112:113], v10 offset:4608
    v_mfma_f32_32x32x16_bf16 v[80:95], v[220:223], v[228:231], v[80:95]
    ds_read_b64_tr_b16 v[114:115], v10 offset:4752
    ds_read_b64_tr_b16 v[116:117], v15 offset:0
    ds_read_b64_tr_b16 v[118:119], v16 offset:0
    s_add_u32 m0, s79, 33792
    s_mul_i32 s69, s72, 221184
    buffer_load_dwordx4 v2, s[44:47], s68 offen lds
    s_waitcnt lgkmcnt(12)
    v_mfma_f32_32x32x16_bf16 v[64:79], v[32:35], v[44:47], v[64:79]
    ds_read_b128 v[228:231], v9 offset:0
    ds_read_b64_tr_b16 v[216:217], v10 offset:6912
    ds_read_b64_tr_b16 v[218:219], v10 offset:7056
    s_waitcnt lgkmcnt(13)
    v_mfma_f32_32x32x16_bf16 v[80:95], v[36:39], v[44:47], v[80:95]
    ds_read_b64_tr_b16 v[220:221], v17 offset:0
    ds_read_b64_tr_b16 v[222:223], v18 offset:0
    s_add_u32 m0, s78, 98464
    s_add_u32 s69, s69, s74
    buffer_load_dwordx4 v4, s[48:51], s69 offen lds
    s_waitcnt lgkmcnt(12)
    v_mfma_f32_32x32x16_bf16 v[64:79], v[48:51], v[60:63], v[64:79]
    s_mul_i32 s14, s72, s76
    s_add_u32 m0, s77, 49312
    s_add_u32 s14, s14, s75
    buffer_load_dwordx4 v5, s[52:55], s14 offen lds
    s_add_u32 s72, s72, 1
    s_cmp_ge_u32 s72, 9
    s_cselect_b32 s72, 0, s72
    s_waitcnt lgkmcnt(10)
    v_mfma_f32_32x32x16_bf16 v[80:95], v[52:55], v[60:63], v[80:95]
    s_waitcnt vmcnt(5) lgkmcnt(0)
    s_barrier
    v_mfma_f32_32x32x16_bf16 v[64:79], v[112:115], v[124:127], v[64:79]
    ds_read_b128 v[44:47], v6 offset:16384
    ds_read_b64_tr_b16 v[32:33], v10 offset:24656
    ds_read_b64_tr_b16 v[34:35], v10 offset:24800
    ds_read_b64_tr_b16 v[36:37], v11 offset:24656
    ds_read_b64_tr_b16 v[38:39], v12 offset:24656
    v_mfma_f32_32x32x16_bf16 v[80:95], v[116:119], v[124:127], v[80:95]
    ds_read_b128 v[60:63], v7 offset:16384
    ds_read_b64_tr_b16 v[48:49], v10 offset:26960
    ds_read_b64_tr_b16 v[50:51], v10 offset:27104
    ds_read_b64_tr_b16 v[52:53], v13 offset:24656
    s_lshl_b32 s68, s72, 7
    s_add_u32 m0, s79, 0
    s_add_u32 s68, s68, s73
    buffer_load_dwordx4 v3, s[44:47], s68 offen lds
    v_mfma_f32_32x32x16_bf16 v[64:79], v[216:219], v[228:231], v[64:79]
    ds_read_b64_tr_b16 v[54:55], v14 offset:24656
    ds_read_b128 v[124:127], v8 offset:16384
    ds_read_b64_tr_b16 v[112:113], v10 offset:29264
    v_mfma_f32_32x32x16_bf16 v[80:95], v[220:223], v[228:231], v[80:95]
    ds_read_b64_tr_b16 v[114:115], v10 offset:29408
    ds_read_b64_tr_b16 v[116:117], v15 offset:24656
    ds_read_b64_tr_b16 v[118:119], v16 offset:24656
    s_add_u32 m0, s79, 1024
    s_mul_i32 s69, s72, 221184
    buffer_load_dwordx4 v2, s[44:47], s68 offen lds
    s_waitcnt lgkmcnt(12)
    v_mfma_f32_32x32x16_bf16 v[64:79], v[32:35], v[44:47], v[64:79]
    ds_read_b128 v[228:231], v9 offset:16384
    ds_read_b64_tr_b16 v[216:217], v10 offset:31568
    ds_read_b64_tr_b16 v[218:219], v10 offset:31712
    s_waitcnt lgkmcnt(13)
    v_mfma_f32_32x32x16_bf16 v[80:95], v[36:39], v[44:47], v[80:95]
    ds_read_b64_tr_b16 v[220:221], v17 offset:24656
    ds_read_b64_tr_b16 v[222:223], v18 offset:24656
    s_add_u32 m0, s78, 49152
    s_add_u32 s69, s69, s74
    buffer_load_dwordx4 v4, s[48:51], s69 offen lds
    s_waitcnt lgkmcnt(12)
    v_mfma_f32_32x32x16_bf16 v[64:79], v[48:51], v[60:63], v[64:79]
    s_mul_i32 s14, s72, s76
    s_add_u32 m0, s77, 0
    s_add_u32 s14, s14, s75
    buffer_load_dwordx4 v5, s[52:55], s14 offen lds
    s_add_u32 s72, s72, 1
    s_cmp_ge_u32 s72, 9
    s_cselect_b32 s72, 0, s72
    s_waitcnt lgkmcnt(10)
    v_mfma_f32_32x32x16_bf16 v[80:95], v[52:55], v[60:63], v[80:95]
    s_waitcnt lgkmcnt(11)
    ds_read_b64_tr_b16 v[144:145], v22 offset:0
    ds_read_b64_tr_b16 v[156:157], v22 offset:32
    ds_read_b64_tr_b16 v[146:147], v23 offset:0
    ds_read_b64_tr_b16 v[158:159], v23 offset:32
    s_waitcnt vmcnt(4) lgkmcnt(0)
    s_barrier
    v_mfma_f32_32x32x16_bf16 v[64:79], v[112:115], v[124:127], v[64:79]
    ds_read_b128 v[44:47], v6 offset:32768
    ds_read_b64_tr_b16 v[32:33], v10 offset:49312
    ds_read_b64_tr_b16 v[34:35], v10 offset:49456
    ds_read_b64_tr_b16 v[36:37], v11 offset:49312
    ds_read_b64_tr_b16 v[38:39], v12 offset:49312
    v_mfma_f32_32x32x16_bf16 v[80:95], v[116:119], v[124:127], v[80:95]
    ds_read_b128 v[60:63], v7 offset:32768
    ds_read_b64_tr_b16 v[48:49], v10 offset:51616
    ds_read_b64_tr_b16 v[50:51], v10 offset:51760
    ds_read_b64_tr_b16 v[52:53], v13 offset:49312
    s_lshl_b32 s68, s72, 7
    s_add_u32 m0, s79, 16384
    s_add_u32 s68, s68, s73
    buffer_load_dwordx4 v3, s[44:47], s68 offen lds
    v_mfma_f32_32x32x16_bf16 v[64:79], v[216:219], v[228:231], v[64:79]
    ds_read_b64_tr_b16 v[54:55], v14 offset:49312
    ds_read_b128 v[124:127], v8 offset:32768
    ds_read_b64_tr_b16 v[112:113], v10 offset:53920
    v_mfma_f32_32x32x16_bf16 v[80:95], v[220:223], v[228:231], v[80:95]
    ds_read_b64_tr_b16 v[114:115], v10 offset:54064
    ds_read_b64_tr_b16 v[116:117], v15 offset:49312
    ds_read_b64_tr_b16 v[118:119], v16 offset:49312
    s_add_u32 m0, s79, 17408
    s_mul_i32 s69, s72, 221184
    buffer_load_dwordx4 v2, s[44:47], s68 offen lds
    s_waitcnt lgkmcnt(12)
    v_mfma_f32_32x32x16_bf16 v[64:79], v[32:35], v[44:47], v[64:79]
    ds_read_b128 v[228:231], v9 offset:32768
    ds_read_b64_tr_b16 v[216:217], v10 offset:56224
    ds_read_b64_tr_b16 v[218:219], v10 offset:56368
    s_waitcnt lgkmcnt(13)
    v_mfma_f32_32x32x16_bf16 v[80:95], v[36:39], v[44:47], v[80:95]
    ds_read_b64_tr_b16 v[220:221], v17 offset:49312
    ds_read_b64_tr_b16 v[222:223], v18 offset:49312
    s_add_u32 m0, s78, 73808
    s_add_u32 s69, s69, s74
    buffer_load_dwordx4 v4, s[48:51], s69 offen lds
    s_waitcnt lgkmcnt(12)
    v_mfma_f32_32x32x16_bf16 v[64:79], v[48:51], v[60:63], v[64:79]
    s_mul_i32 s14, s72, s76
    s_add_u32 m0, s77, 24656
    s_add_u32 s14, s14, s75
    buffer_load_dwordx4 v5, s[52:55], s14 offen lds
    s_add_u32 s72, s72, 1
    s_cmp_ge_u32 s72, 9
    s_cselect_b32 s72, 0, s72
    s_waitcnt lgkmcnt(10)
    v_mfma_f32_32x32x16_bf16 v[80:95], v[52:55], v[60:63], v[80:95]
    s_waitcnt lgkmcnt(11)
    ds_read_b64_tr_b16 v[148:149], v24 offset:0
    ds_read_b64_tr_b16 v[208:209], v24 offset:32
    ds_read_b64_tr_b16 v[150:151], v25 offset:0
    ds_read_b64_tr_b16 v[210:211], v25 offset:32
    s_waitcnt vmcnt(4) lgkmcnt(0)
    s_barrier
    v_mfma_f32_32x32x16_bf16 v[64:79], v[112:115], v[124:127], v[64:79]
    ds_read_b128 v[44:47], v6 offset:0
    ds_read_b64_tr_b16 v[32:33], v10 offset:0
    ds_read_b64_tr_b16 v[34:35], v10 offset:144
    ds_read_b64_tr_b16 v[36:37], v11 offset:0
    ds_read_b64_tr_b16 v[38:39], v12 offset:0
    v_mfma_f32_32x32x16_bf16 v[80:95], v[116:119], v[124:127], v[80:95]
    ds_read_b128 v[60:63], v7 offset:0
    ds_read_b64_tr_b16 v[48:49], v10 offset:2304
    ds_read_b64_tr_b16 v[50:51], v10 offset:2448
    ds_read_b64_tr_b16 v[52:53], v13 offset:0
    s_lshl_b32 s68, s72, 7
    s_add_u32 m0, s79, 32768
    s_add_u32 s68, s68, s73
    buffer_load_dwordx4 v3, s[44:47], s68 offen lds
    v_mfma_f32_32x32x16_bf16 v[64:79], v[216:219], v[228:231], v[64:79]
    ds_read_b64_tr_b16 v[54:55], v14 offset:0
    ds_read_b128 v[124:127], v8 offset:0
    ds_read_b64_tr_b16 v[112:113], v10 offset:4608
    v_mfma_f32_32x32x16_bf16 v[80:95], v[220:223], v[228:231], v[80:95]
    ds_read_b64_tr_b16 v[114:115], v10 offset:4752
    ds_read_b64_tr_b16 v[116:117], v15 offset:0
    ds_read_b64_tr_b16 v[118:119], v16 offset:0
    s_add_u32 m0, s79, 33792
    s_mul_i32 s69, s72, 221184
    buffer_load_dwordx4 v2, s[44:47], s68 offen lds
    s_waitcnt lgkmcnt(12)
    v_mfma_f32_32x32x16_bf16 v[64:79], v[32:35], v[44:47], v[64:79]
    ds_read_b128 v[228:231], v9 offset:0
    ds_read_b64_tr_b16 v[216:217], v10 offset:6912
    ds_read_b64_tr_b16 v[218:219], v10 offset:7056
    s_waitcnt lgkmcnt(13)
    v_mfma_f32_32x32x16_bf16 v[80:95], v[36:39], v[44:47], v[80:95]
    ds_read_b64_tr_b16 v[220:221], v17 offset:0
    ds_read_b64_tr_b16 v[222:223], v18 offset:0
    s_add_u32 m0, s78, 98464
    s_add_u32 s69, s69, s74
    buffer_load_dwordx4 v4, s[48:51], s69 offen lds
    s_waitcnt lgkmcnt(12)
    v_mfma_f32_32x32x16_bf16 v[64:79], v[48:51], v[60:63], v[64:79]
    s_mul_i32 s14, s72, s76
    s_add_u32 m0, s77, 49312
    s_add_u32 s14, s14, s75
    buffer_load_dwordx4 v5, s[52:55], s14 offen lds
    s_add_u32 s72, s72, 1
    s_cmp_ge_u32 s72, 9
    s_cselect_b32 s72, 0, s72
    s_waitcnt lgkmcnt(10)
    v_mfma_f32_32x32x16_bf16 v[80:95], v[52:55], v[60:63], v[80:95]
    s_waitcnt lgkmcnt(11)
    ds_read_b64_tr_b16 v[152:153], v26 offset:0
    ds_read_b64_tr_b16 v[212:213], v26 offset:32
    ds_read_b64_tr_b16 v[154:155], v27 offset:0
    ds_read_b64_tr_b16 v[214:215], v27 offset:32
    s_waitcnt vmcnt(4) lgkmcnt(0)
    s_barrier
    v_mfma_f32_32x32x16_bf16 v[64:79], v[112:115], v[124:127], v[64:79]
    ds_read_b128 v[44:47], v6 offset:16384
    ds_read_b64_tr_b16 v[32:33], v10 offset:24656
    ds_read_b64_tr_b16 v[34:35], v10 offset:24800
    ds_read_b64_tr_b16 v[36:37], v11 offset:24656
    ds_read_b64_tr_b16 v[38:39], v12 offset:24656
    v_mfma_f32_32x32x16_bf16 v[80:95], v[116:119], v[124:127], v[80:95]
    ds_read_b128 v[60:63], v7 offset:16384
    ds_read_b64_tr_b16 v[48:49], v10 offset:26960
    ds_read_b64_tr_b16 v[50:51], v10 offset:27104
    ds_read_b64_tr_b16 v[52:53], v13 offset:24656
    v_mfma_f32_32x32x16_bf16 v[64:79], v[216:219], v[228:231], v[64:79]
    ds_read_b64_tr_b16 v[54:55], v14 offset:24656
    ds_read_b128 v[124:127], v8 offset:16384
    ds_read_b64_tr_b16 v[112:113], v10 offset:29264
    v_mfma_f32_32x32x16_bf16 v[80:95], v[220:223], v[228:231], v[80:95]
    ds_read_b64_tr_b16 v[114:115], v10 offset:29408
    ds_read_b64_tr_b16 v[116:117], v15 offset:24656
    ds_read_b64_tr_b16 v[118:119], v16 offset:24656
    s_waitcnt lgkmcnt(12)
    v_mfma_f32_32x32x16_bf16 v[64:79], v[32:35], v[44:47], v[64:79]
    ds_read_b128 v[228:231], v9 offset:16384
    ds_read_b64_tr_b16 v[216:217], v10 offset:31568
    ds_read_b64_tr_b16 v[218:219], v10 offset:31712
    s_waitcnt lgkmcnt(13)
    v_mfma_f32_32x32x16_bf16 v[80:95], v[36:39], v[44:47], v[80:95]
    ds_read_b64_tr_b16 v[220:221], v17 offset:24656
    ds_read_b64_tr_b16 v[222:223], v18 offset:24656
    s_waitcnt lgkmcnt(12)
    v_mfma_f32_32x32x16_bf16 v[64:79], v[48:51], v[60:63], v[64:79]
    s_waitcnt lgkmcnt(10)
    v_mfma_f32_32x32x16_bf16 v[80:95], v[52:55], v[60:63], v[80:95]
    s_waitcnt vmcnt(0) lgkmcnt(0)
    s_barrier
    v_mfma_f32_32x32x16_bf16 v[64:79], v[112:115], v[124:127], v[64:79]
    ds_read_b128 v[44:47], v6 offset:32768
    ds_read_b64_tr_b16 v[32:33], v10 offset:49312
    ds_read_b64_tr_b16 v[34:35], v10 offset:49456
    ds_read_b64_tr_b16 v[36:37], v11 offset:49312
    ds_read_b64_tr_b16 v[38:39], v12 offset:49312
    v_mfma_f32_32x32x16_bf16 v[80:95], v[116:119], v[124:127], v[80:95]
    ds_read_b128 v[60:63], v7 offset:32768
    ds_read_b64_tr_b16 v[48:49], v10 offset:51616
    ds_read_b64_tr_b16 v[50:51], v10 offset:51760
    ds_read_b64_tr_b16 v[52:53], v13 offset:49312
    v_mfma_f32_32x32x16_bf16 v[64:79], v[216:219], v[228:231], v[64:79]
    ds_read_b64_tr_b16 v[54:55], v14 offset:49312
    ds_read_b128 v[124:127], v8 offset:32768
    ds_read_b64_tr_b16 v[112:113], v10 offset:53920
    v_mfma_f32_32x32x16_bf16 v[80:95], v[220:223], v[228:231], v[80:95]
    ds_read_b64_tr_b16 v[114:115], v10 offset:54064
    ds_read_b64_tr_b16 v[116:117], v15 offset:49312
    ds_read_b64_tr_b16 v[118:119], v16 offset:49312
    s_waitcnt lgkmcnt(12)
    v_mfma_f32_32x32x16_bf16 v[64:79], v[32:35], v[44:47], v[64:79]
    ds_read_b128 v[228:231], v9 offset:32768
    ds_read_b64_tr_b16 v[216:217], v10 offset:56224
    ds_read_b64_tr_b16 v[218:219], v10 offset:56368
    s_waitcnt lgkmcnt(13)
    v_mfma_f32_32x32x16_bf16 v[80:95], v[36:39], v[44:47], v[80:95]
    ds_read_b64_tr_b16 v[220:221], v17 offset:49312
    ds_read_b64_tr_b16 v[222:223], v18 offset:49312
    s_waitcnt lgkmcnt(12)
    v_mfma_f32_32x32x16_bf16 v[64:79], v[48:51], v[60:63], v[64:79]
    s_waitcnt lgkmcnt(10)
    v_mfma_f32_32x32x16_bf16 v[80:95], v[52:55], v[60:63], v[80:95]
    s_waitcnt lgkmcnt(0)
    v_mfma_f32_32x32x16_bf16 v[80:95], v[116:119], v[124:127], v[80:95]
    v_mfma_f32_32x32x16_bf16 v[80:95], v[220:223], v[228:231], v[80:95]
    s_cmp_eq_u32 s11, 0
    s_cbranch_scc1 L_ke23
    s_cmp_ge_u32 s6, 6
    s_cbranch_scc1 L_ke23
    s_lshl_b32 s12, s6, 4
    s_add_u32 s12, s12, s5
    s_mul_i32 s12, s12, 64
    s_add_u32 s12, s12, 49152
    v_mov_b32 v19, s12
    v_mov_b32 v21, 0
    v_and_b32 v138, 31, v1
    v_lshrrev_b32 v139, 5, v1
    v_lshl_add_u32 v138, v138, 1, v139
    v_lshlrev_b32 v138, 3, v138
    s_cmp_ge_u32 s6, 3
    s_cbranch_scc1 L_kv24
    v_mul_f32 v128, 0x3eae1a93, v92
    v_mul_f32 v129, 0x3eae1a93, v93
    v_mul_f32 v130, 0x3eae1a93, v94
    v_mul_f32 v131, 0x3eae1a93, v95
    v_cvt_pk_bf16_f32 v132, v128, v129
    v_cvt_pk_bf16_f32 v133, v130, v131
    v_mul_f32 v21, v128, v128
    v_fmac_f32 v21, v129, v129
    s_cmp_eq_u32 s6, 2
    s_cbranch_scc1 L_kv24x
    buffer_store_dwordx2 v[132:133], v138, s[60:63], s81 offen sc1
    v_fmac_f32 v21, v130, v130
    v_fmac_f32 v21, v131, v131
    v_mov_b32 v139, v21
    s_nop 1
    v_permlane32_swap_b32 v21, v139
    v_add_f32 v21, v21, v139
    s_branch L_kv24y
L_kv24x:
    s_mov_b32 exec_hi, 0
    buffer_store_dword v132, v246, s[60:63], s81 offen sc1
    s_mov_b64 exec, -1
L_kv24y:
    s_branch L_kv24z
L_kv24:
    s_lshl_b32 s12, s10, 9
    s_add_u32 s12, s12, 74752
    v_add_u32 v138, s12, v138
    v_cvt_pk_bf16_f32 v132, v92, v93
    v_cvt_pk_bf16_f32 v133, v94, v95
    ds_write_b64 v138, v[132:133]
    v_bfe_u32 v138, v1, 4, 1
    v_bfe_u32 v139, v1, 1, 1
    v_lshl_add_u32 v138, v138, 1, v139
    v_bfe_u32 v139, v1, 2, 2
    v_lshl_add_u32 v138, v138, 3, v139
    v_and_b32 v139, 1, v1
    v_lshl_add_u32 v138, v138, 1, v139
    v_lshl_add_u32 v138, v138, 3, s12
    ds_read_b64_tr_b16 v[128:129], v138
    ds_read_b64_tr_b16 v[130:131], v138 offset:64
    s_cmp_eq_u32 s6, 5
    s_cselect_b32 s3, 2, 8
    v_and_b32 v139, 7, v1
    v_cmp_eq_u32 vcc, s3, v139
    v_mov_b32 v139, 0x3f803f80
    s_waitcnt lgkmcnt(0)
    v_cndmask_b32 v128, v128, v139, vcc
    v_cndmask_b32 v129, v129, v139, vcc
    v_cndmask_b32 v130, v130, v139, vcc
    v_cndmask_b32 v131, v131, v139, vcc
    s_mov_b32 exec_hi, 0
    buffer_store_dwordx4 v[128:131], v253, s[60:63], s81 offen sc1
L_kv24z:
    s_mov_b32 exec_hi, 0
    v_mov_b32 v138, 162128
    v_mov_b32 v139, 1
    ds_max_f32 v138, v21
    s_mov_b64 exec, 1
    ds_add_rtn_u32 v139, v138, v139 offset:4
    ds_read_b32 v21, v138
    s_waitcnt lgkmcnt(0)
    v_readfirstlane_b32 s12, v139
    s_nop 0
    s_cmp_lg_u32 s12, 3
    s_cbranch_scc1 L_kv24w
    buffer_store_dwordx2 v[20:21], v19, s[60:63], 0 offen sc1
L_kv24w:
    s_mov_b64 exec, -1
L_ke23:
    v_and_b32 v140, 15, v1
    v_lshrrev_b32 v141, 4, v1
    v_mul_u32_u24 v249, 1152, v140
    v_lshl_add_u32 v249, v141, 3, v249
    v_lshlrev_b32 v142, 3, v140
    v_lshl_add_u32 v251, v141, 8, v142
    v_and_b32 v143, 1, v141
    v_lshl_add_u32 v248, v143, 2, v142
    v_lshrrev_b32 v244, 5, v1
    v_lshl_add_u32 v244, v143, 1, v244
    v_lshlrev_b32 v244, 4, v244
    v_add_lshl_u32 v244, v244, v140, 4
    v_and_b32 v142, 7, v1
    v_lshl_add_u32 v141, v141, 3, v142
    s_mul_i32 s12, s11, 74752
    v_lshl_add_u32 v240, v141, 4, s12
    v_add_u32 v252, s12, v253
    v_add_u32 v250, 147456, v253
    v_and_b32 v140, 31, v1
    v_lshrrev_b32 v141, 5, v1
    v_mul_u32_u24 v234, 48, v140
    v_add_u32 v234, 61440, v234
    v_lshl_add_u32 v233, v141, 4, v234
    v_add_u32 v234, 32, v234
    s_mul_i32 s12, s10, 2560
    s_add_u32 s12, s12, 79872
    v_lshl_add_u32 v235, v1, 3, s12
    s_lshl_b32 s12, s10, 2
    s_add_u32 s12, s12, 162304
    v_mov_b32 v236, s12
    v_mov_b32 v232, 0xdddddddd
    s_mul_i32 s12, s11, 162124
    v_mov_b32 v238, s12
    v_mov_b32 v239, s11
    s_lshl_b32 s12, s10, 5
    v_add_u32 v140, s12, v140
    v_lshlrev_b32 v202, 2, v140
    v_add_u32 v202, 73728, v202
    v_mul_u32_u24 v142, 80, v140
    s_mul_i32 s12, s11, 10240
    s_add_u32 s13, s12, 40960
    v_lshl_add_u32 v203, v141, 3, v142
    v_add_u32 v203, s13, v203
    s_lshl_b32 s12, s12, 1
    v_mul_u32_u24 v204, 10240, v141
    v_add3_u32 v204, v204, s12, v142
    v_and_b32 v142, 0x70, v140
    v_add_u32 v142, v142, v140
    v_mul_u32_u24 v142, 48, v142
    s_mul_i32 s12, s11, 768
    s_add_u32 s12, s12, 61440
    v_add_u32 v142, s12, v142
    s_lshl_b32 s12, s11, 2
    v_lshl_add_u32 v200, v141, 3, v142
    v_add_u32 v200, s12, v200
    s_lshl_b32 s12, s11, 5
    s_add_u32 s12, s12, 4
    v_mul_u32_u24 v143, s12, v141
    v_sub_u32 v143, 36, v143
    v_add_u32 v201, v142, v143
    v_bfe_u32 v140, v1, 2, 2
    v_lshl_add_u32 v140, v140, 1, v141
    v_mul_u32_u24 v140, 160, v140
    v_bfe_u32 v141, v1, 4, 1
    v_and_b32 v142, 3, v1
    v_lshl_add_u32 v141, v141, 2, v142
    v_and_b32 v142, 1, v141
    v_bfe_u32 v143, v141, 1, 1
    v_lshl_or_b32 v142, v142, 1, v143
    v_and_b32 v143, 4, v141
    v_or_b32 v142, v142, v143
    s_mul_i32 s12, s10, 10240
    v_lshl_add_u32 v205, v142, 3, v140
    v_add_u32 v205, s12, v205
    s_and_b32 s13, s10, 1
    s_lshl_b32 s14, s13, 2
    v_cmp_eq_u32 vcc, 5, v141
    v_add_u32 v206, s14, v141
    s_lshr_b32 s12, s10, 1
    s_mul_i32 s12, s12, 10240
    s_add_u32 s12, s12, 40960
    v_cndmask_b32 v206, v206, 9, vcc
    v_lshl_add_u32 v206, v206, 3, v140
    v_add_u32 v206, s12, v206
    s_barrier
    v_mfma_f32_32x32x16_bf16 v[64:79], v[112:115], v[124:127], v[64:79]
    v_mfma_f32_32x32x16_bf16 v[64:79], v[216:219], v[228:231], v[64:79]
    s_setprio 3
    s_cmp_eq_u32 s11, 0
    s_cbranch_scc1 L_pr25
    s_setprio 2
L_pr25:
    s_mov_b32 vcc_lo, 0
    s_mov_b32 vcc_hi, -1
    s_nop 6
    v_cvt_pk_bf16_f32 v216, v64, v65
    v_cvt_pk_bf16_f32 v217, v66, v67
    v_cvt_pk_bf16_f32 v218, v68, v69
    v_cvt_pk_bf16_f32 v219, v70, v71
    v_cvt_pk_bf16_f32 v220, v72, v73
    v_cvt_pk_bf16_f32 v221, v74, v75
    v_cvt_pk_bf16_f32 v222, v76, v77
    v_cvt_pk_bf16_f32 v223, v78, v79
    v_cvt_pk_bf16_f32 v224, v80, v81
    v_cvt_pk_bf16_f32 v225, v82, v83
    v_cvt_pk_bf16_f32 v226, v84, v85
    v_cvt_pk_bf16_f32 v227, v86, v87
    v_cvt_pk_bf16_f32 v228, v88, v89
    v_cvt_pk_bf16_f32 v229, v90, v91
    ds_write2_b32 v200, v226, v227 offset0:0 offset1:1
    ds_write2_b32 v200, v228, v229 offset0:4 offset1:5
    v_mfma_f32_32x32x16_bf16 v[112:127], v[144:147], v[216:219], 0
    s_cmp_eq_u32 s11, 1
    s_cselect_b64 s[12:13], -1, 0
    v_cndmask_b32 v6, v80, v82, s[12:13]
    v_cndmask_b32 v7, v81, v83, s[12:13]
    v_cndmask_b32 v8, v224, v225, s[12:13]
    v_mul_f32 v9, v6, v6
    v_fmac_f32 v9, v7, v7
    v_mfma_f32_32x32x16_bf16 v[64:79], v[156:159], v[216:219], 0
    v_cndmask_b32 v9, 0, v9, vcc
    v_fmac_f32 v9, v84, v84
    v_fmac_f32 v9, v85, v85
    v_fmac_f32 v9, v86, v86
    v_fmac_f32 v9, v87, v87
    v_fmac_f32 v9, v88, v88
    v_mfma_f32_32x32x16_bf16 v[112:127], v[148:151], v[220:223], v[112:127]
    v_fmac_f32 v9, v89, v89
    v_fmac_f32 v9, v90, v90
    v_fmac_f32 v9, v91, v91
    v_mov_b32 v10, v9
    v_mfma_f32_32x32x16_bf16 v[64:79], v[208:211], v[220:223], v[64:79]
    s_nop 0
    v_permlane32_swap_b32 v9, v10
    v_add_f32 v9, v9, v10
    v_sqrt_f32 v9, v9
    s_nop 0
    v_mul_f32 v9, 0xbf8147ae, v9
    v_mfma_f32_32x32x16_bf16 v[112:127], v[152:155], v[224:227], v[112:127]
    v_cvt_pk_bf16_f32 v9, v9, 0
    v_cndmask_b32 v8, v9, v8, vcc
    ds_write_b32 v201, v8
    v_mul_f32 v6, 0xbfb8aa3b, v92
    v_exp_f32 v6, v6
    v_mfma_f32_32x32x16_bf16 v[64:79], v[212:215], v[224:227], v[64:79]
    v_add_f32 v7, 1.0, v6
    v_rcp_f32 v7, v7
    s_nop 0
    v_sub_f32 v6, 1.0, v7
    s_andn2_b64 exec, vcc, s[12:13]
    ds_write2st64_b32 v202, v7, v6 offset0:0 offset1:2
    s_mov_b64 exec, -1
    v_mov_b32 v6, 162120
    v_mov_b32 v7, 1
    s_mov_b64 exec, 1
    ds_add_u32 v6, v7
    s_mov_b64 exec, -1
    s_mov_b32 s77, 0
    s_cmp_eq_u32 s11, 1
    s_cbranch_scc1 L_lo26
    buffer_load_dwordx3 v[104:106], v31, s[60:63], s83 offen sc1
    buffer_load_dwordx3 v[108:110], v31, s[60:63], s43 offen sc1
L_lo26:
    v_max3_f32 v20, v112, v113, v114
    v_min3_f32 v22, v112, v113, v114
    v_max3_f32 v20, v20, v115, v116
    v_min3_f32 v22, v22, v115, v116
    v_max3_f32 v20, v20, v117, v118
    v_min3_f32 v22, v22, v117, v118
    v_max3_f32 v20, v20, v119, v120
    v_min3_f32 v22, v22, v119, v120
    v_max3_f32 v20, v20, v121, v122
    v_min3_f32 v22, v22, v121, v122
    v_max3_f32 v20, v20, v123, v124
    v_min3_f32 v22, v22, v123, v124
    v_max3_f32 v20, v20, v125, v126
    v_min3_f32 v22, v22, v125, v126
    v_max3_f32 v20, v20, v127, v64
    v_min3_f32 v22, v22, v127, v64
    v_max_f32 v20, v20, v65
    v_min_f32 v22, v22, v65
    v_mul_f32 v20, 0xbfb8aa3b, v20
    v_mul_f32 v22, 0x3fb8aa3b, v22
    v_pk_fma_f32 v[68:69], v[112:113], s[86:87], v[20:21] op_sel_hi:[1,1,0]
    v_pk_fma_f32 v[86:87], v[112:113], s[86:87], v[22:23] op_sel_hi:[1,1,0] neg_lo:[1,0,0] neg_hi:[1,0,0]
    v_pk_fma_f32 v[70:71], v[114:115], s[86:87], v[20:21] op_sel_hi:[1,1,0]
    v_pk_fma_f32 v[88:89], v[114:115], s[86:87], v[22:23] op_sel_hi:[1,1,0] neg_lo:[1,0,0] neg_hi:[1,0,0]
    v_pk_fma_f32 v[72:73], v[116:117], s[86:87], v[20:21] op_sel_hi:[1,1,0]
    v_pk_fma_f32 v[90:91], v[116:117], s[86:87], v[22:23] op_sel_hi:[1,1,0] neg_lo:[1,0,0] neg_hi:[1,0,0]
    v_pk_fma_f32 v[74:75], v[118:119], s[86:87], v[20:21] op_sel_hi:[1,1,0]
    v_pk_fma_f32 v[92:93], v[118:119], s[86:87], v[22:23] op_sel_hi:[1,1,0] neg_lo:[1,0,0] neg_hi:[1,0,0]
    v_pk_fma_f32 v[76:77], v[120:121], s[86:87], v[20:21] op_sel_hi:[1,1,0]
    v_pk_fma_f32 v[94:95], v[120:121], s[86:87], v[22:23] op_sel_hi:[1,1,0] neg_lo:[1,0,0] neg_hi:[1,0,0]
    v_pk_fma_f32 v[78:79], v[122:123], s[86:87], v[20:21] op_sel_hi:[1,1,0]
    v_pk_fma_f32 v[96:97], v[122:123], s[86:87], v[22:23] op_sel_hi:[1,1,0] neg_lo:[1,0,0] neg_hi:[1,0,0]
    v_pk_fma_f32 v[80:81], v[124:125], s[86:87], v[20:21] op_sel_hi:[1,1,0]
    v_pk_fma_f32 v[98:99], v[124:125], s[86:87], v[22:23] op_sel_hi:[1,1,0] neg_lo:[1,0,0] neg_hi:[1,0,0]
    v_pk_fma_f32 v[82:83], v[126:127], s[86:87], v[20:21] op_sel_hi:[1,1,0]
    v_pk_fma_f32 v[100:101], v[126:127], s[86:87], v[22:23] op_sel_hi:[1,1,0] neg_lo:[1,0,0] neg_hi:[1,0,0]
    v_pk_fma_f32 v[84:85], v[64:65], s[86:87], v[20:21] op_sel_hi:[1,1,0]
    v_pk_fma_f32 v[102:103], v[64:65], s[86:87], v[22:23] op_sel_hi:[1,1,0] neg_lo:[1,0,0] neg_hi:[1,0,0]
    v_exp_f32 v68, v68
    v_exp_f32 v69, v69
    v_exp_f32 v70, v70
    v_exp_f32 v71, v71
    v_exp_f32 v72, v72
    v_exp_f32 v73, v73
    v_exp_f32 v74, v74
    v_exp_f32 v75, v75
    v_exp_f32 v76, v76
    v_exp_f32 v77, v77
    v_exp_f32 v78, v78
    v_exp_f32 v79, v79
    v_exp_f32 v80, v80
    v_exp_f32 v81, v81
    v_exp_f32 v82, v82
    v_exp_f32 v83, v83
    v_exp_f32 v84, v84
    v_exp_f32 v85, v85
    v_exp_f32 v86, v86
    v_exp_f32 v87, v87
    v_exp_f32 v88, v88
    v_exp_f32 v89, v89
    v_exp_f32 v90, v90
    v_exp_f32 v91, v91
    v_exp_f32 v92, v92
    v_exp_f32 v93, v93
    v_exp_f32 v94, v94
    v_exp_f32 v95, v95
    v_exp_f32 v96, v96
    v_exp_f32 v97, v97
    v_exp_f32 v98, v98
    v_exp_f32 v99, v99
    v_exp_f32 v100, v100
    v_exp_f32 v101, v101
    v_exp_f32 v102, v102
    v_exp_f32 v103, v103
    s_cmp_eq_u32 s11, 1
    s_cbranch_scc1 L_fl27
    s_mov_b32 s14, 0x00030003
    s_mov_b32 s15, 0x00000003
    s_waitcnt vmcnt(0)
    v_xor_b32 v4, s9, v104
    v_bitop3_b32 v4, v4, s9, v106 bitop3:0xf6
    v_bitop3_b32 v4, v4, s9, v108 bitop3:0xf6
    v_bitop3_b32 v4, v4, s9, v110 bitop3:0xf6
    v_cmp_ne_u32 vcc, 0, v4
    s_nop 0
    s_and_b64 s[12:13], vcc, s[14:15]
    s_cbranch_scc1 L_fl28
    s_lshl_b32 s12, s4, 12
    s_add_u32 s55, s12, 163840
    s_add_u32 s53, s12, 65536
    s_add_u32 s54, s78, 131072
    buffer_load_dword v160, v246, s[60:63], s54 offen offset:0 sc1
    buffer_load_dwordx4 v[128:131], v245, s[60:63], s53 offen offset:0 sc1
    buffer_load_dwordx4 v[132:135], v245, s[60:63], s53 offen offset:512 sc1
    buffer_load_dwordx4 v[168:171], v247, s[60:63], s55 offen offset:0 sc1
    buffer_load_dwordx4 v[172:175], v247, s[60:63], s55 offen offset:256 sc1
    buffer_load_dwordx4 v[176:179], v247, s[60:63], s55 offen offset:512 sc1
    buffer_load_dwordx4 v[180:183], v247, s[60:63], s55 offen offset:768 sc1
    buffer_load_dword v162, v246, s[60:63], s54 offen offset:256 sc1
    buffer_load_dwordx4 v[136:139], v245, s[60:63], s53 offen offset:1024 sc1
    buffer_load_dwordx4 v[140:143], v245, s[60:63], s53 offen offset:1536 sc1
    buffer_load_dwordx4 v[184:187], v247, s[60:63], s55 offen offset:1024 sc1
    buffer_load_dwordx4 v[188:191], v247, s[60:63], s55 offen offset:1280 sc1
    buffer_load_dwordx4 v[192:195], v247, s[60:63], s55 offen offset:1536 sc1
    buffer_load_dwordx4 v[196:199], v247, s[60:63], s55 offen offset:1792 sc1
    buffer_load_dword v164, v246, s[60:63], s54 offen offset:512 sc1
    buffer_load_dwordx4 v[144:147], v245, s[60:63], s53 offen offset:2048 sc1
    buffer_load_dwordx4 v[148:151], v245, s[60:63], s53 offen offset:2560 sc1
    s_mov_b32 s77, 1
    s_branch L_fl27
L_fl28:
    buffer_load_dwordx3 v[104:106], v31, s[60:63], s83 offen sc1
    buffer_load_dwordx3 v[108:110], v31, s[60:63], s43 offen sc1
L_fl27:
    v_pk_add_f32 v[24:25], v[68:69], v[70:71]
    v_pk_add_f32 v[26:27], v[86:87], v[88:89]
    v_pk_add_f32 v[24:25], v[24:25], v[72:73]
    v_pk_add_f32 v[26:27], v[26:27], v[90:91]
    v_pk_add_f32 v[24:25], v[24:25], v[74:75]
    v_pk_add_f32 v[26:27], v[26:27], v[92:93]
    v_pk_add_f32 v[24:25], v[24:25], v[76:77]
    v_pk_add_f32 v[26:27], v[26:27], v[94:95]
    v_pk_add_f32 v[24:25], v[24:25], v[78:79]
    v_pk_add_f32 v[26:27], v[26:27], v[96:97]
    v_pk_add_f32 v[24:25], v[24:25], v[80:81]
    v_pk_add_f32 v[26:27], v[26:27], v[98:99]
    v_pk_add_f32 v[24:25], v[24:25], v[82:83]
    v_pk_add_f32 v[26:27], v[26:27], v[100:101]
    v_pk_add_f32 v[24:25], v[24:25], v[84:85]
    v_pk_add_f32 v[26:27], v[26:27], v[102:103]
    v_add_f32 v24, v24, v25
    v_add_f32 v26, v26, v27
    v_rcp_f32 v24, v24
    v_rcp_f32 v26, v26
    v_mov_b32 v50, 0
    v_mov_b32 v51, 0
    v_pk_mul_f32 v[68:69], v[68:69], v[24:25] op_sel_hi:[1,0]
    v_cvt_pk_bf16_f32 v32, v68, v69
    v_pk_mul_f32 v[70:71], v[70:71], v[24:25] op_sel_hi:[1,0]
    v_cvt_pk_bf16_f32 v33, v70, v71
    v_pk_mul_f32 v[72:73], v[72:73], v[24:25] op_sel_hi:[1,0]
    v_cvt_pk_bf16_f32 v34, v72, v73
    v_pk_mul_f32 v[74:75], v[74:75], v[24:25] op_sel_hi:[1,0]
    v_cvt_pk_bf16_f32 v35, v74, v75
    ds_write_b128 v204, v[32:35] offset:0
    v_pk_mul_f32 v[76:77], v[76:77], v[24:25] op_sel_hi:[1,0]
    v_cvt_pk_bf16_f32 v36, v76, v77
    v_pk_mul_f32 v[78:79], v[78:79], v[24:25] op_sel_hi:[1,0]
    v_cvt_pk_bf16_f32 v37, v78, v79
    v_pk_mul_f32 v[80:81], v[80:81], v[24:25] op_sel_hi:[1,0]
    v_cvt_pk_bf16_f32 v38, v80, v81
    v_pk_mul_f32 v[82:83], v[82:83], v[24:25] op_sel_hi:[1,0]
    v_cvt_pk_bf16_f32 v39, v82, v83
    ds_write_b128 v204, v[36:39] offset:16
    v_pk_mul_f32 v[84:85], v[84:85], v[24:25] op_sel_hi:[1,0]
    v_cvt_pk_bf16_f32 v40, v84, v85
    v_pk_mul_f32 v[86:87], v[86:87], v[26:27] op_sel_hi:[1,0]
    v_cvt_pk_bf16_f32 v41, v86, v87
    v_pk_mul_f32 v[88:89], v[88:89], v[26:27] op_sel_hi:[1,0]
    v_cvt_pk_bf16_f32 v42, v88, v89
    v_pk_mul_f32 v[90:91], v[90:91], v[26:27] op_sel_hi:[1,0]
    v_cvt_pk_bf16_f32 v43, v90, v91
    ds_write_b128 v204, v[40:43] offset:32
    v_pk_mul_f32 v[92:93], v[92:93], v[26:27] op_sel_hi:[1,0]
    v_cvt_pk_bf16_f32 v44, v92, v93
    v_pk_mul_f32 v[94:95], v[94:95], v[26:27] op_sel_hi:[1,0]
    v_cvt_pk_bf16_f32 v45, v94, v95
    v_pk_mul_f32 v[96:97], v[96:97], v[26:27] op_sel_hi:[1,0]
    v_cvt_pk_bf16_f32 v46, v96, v97
    v_pk_mul_f32 v[98:99], v[98:99], v[26:27] op_sel_hi:[1,0]
    v_cvt_pk_bf16_f32 v47, v98, v99
    ds_write_b128 v204, v[44:47] offset:48
    v_pk_mul_f32 v[100:101], v[100:101], v[26:27] op_sel_hi:[1,0]
    v_cvt_pk_bf16_f32 v48, v100, v101
    v_pk_mul_f32 v[102:103], v[102:103], v[26:27] op_sel_hi:[1,0]
    v_cvt_pk_bf16_f32 v49, v102, v103
    ds_write_b128 v204, v[48:51] offset:64
    v_mov_b32 v4, 162064
    v_mov_b32 v5, 1
    s_mov_b64 exec, 1
    ds_add_u32 v4, v5
    s_mov_b64 exec, -1
    s_cmp_lt_u32 s4, 4
    s_cbranch_scc1 L_leadkv
    s_cmp_eq_u32 s11, 0
    s_cbranch_scc1 L_ps29
    s_lshl_b32 s12, s5, 3
    s_add_u32 s12, s12, s10
    s_mul_i32 s15, s12, 36864
    s_add_u32 s15, s15, 3164160
    s_lshl_b32 s14, s8, 10
    s_add_u32 s14, s14, s15
    s_lshl_b32 s13, s8, 7
    s_add_u32 s13, s13, s15
    s_add_u32 s13, s13, 16384
    v_mov_b32 v128, -1
    v_mov_b32 v129, -1
    v_mov_b32 v130, -1
    v_mov_b32 v131, -1
    buffer_store_dwordx4 v[128:131], v253, s[60:63], s14 offen sc1
    s_add_u32 s14, s14, 147456
    s_nop 0
    buffer_store_dwordx4 v[128:131], v253, s[60:63], s14 offen sc1
    s_mov_b64 exec, 0xff
    buffer_store_dwordx4 v[128:131], v253, s[60:63], s13 offen sc1
    s_add_u32 s13, s13, 147456
    s_nop 0
    buffer_store_dwordx4 v[128:131], v253, s[60:63], s13 offen sc1
L_ps29:
    s_mov_b64 exec, -1
L_oaset:
    v_mov_b32 v2, 162120
    s_mov_b32 s82, 262144
L_ls30:
    ds_read_b32 v3, v2
    s_waitcnt lgkmcnt(0)
    v_readfirstlane_b32 s12, v3
    s_nop 0
    s_cmp_ge_u32 s12, 8
    s_cbranch_scc1 L_lo31
    s_sleep 1
    s_sub_u32 s82, s82, 1
    s_cbranch_scc0 L_ls30
L_lo31:
    v_and_b32 v4, 3, v1
    v_bfe_u32 v5, v1, 2, 1
    v_lshl_or_b32 v4, v5, 3, v4
    v_bfe_u32 v5, v1, 3, 1
    v_lshl_or_b32 v4, v5, 2, v4
    v_and_b32 v5, 31, v1
    v_cmp_gt_u32 vcc, 16, v5
    v_lshrrev_b32 v7, 5, v1
    s_mul_i32 s68, s6, 10240
    v_cndmask_b32 v4, v5, v4, vcc
    v_cmp_gt_u32 vcc, 18, v5
    v_add_u32 v6, 2, v4
    s_add_u32 s68, s68, 262144
    v_cndmask_b32 v4, 20, v4, vcc
    v_cndmask_b32 v6, 20, v6, vcc
    v_lshlrev_b32 v4, 4, v4
    v_lshlrev_b32 v6, 4, v6
    v_lshl_add_u32 v15, v7, 31, v4
    v_lshl_add_u32 v11, v7, 31, v6
    v_lshl_add_u32 v4, v7, 9, v4
    v_lshl_add_u32 v14, v7, 9, v6
    s_lshl_b32 s12, s10, 5
    v_add_u32 v5, s12, v5
    v_mul_u32_u24 v6, 80, v5
    v_lshl_add_u32 v6, v7, 4, v6
    v_lshlrev_b32 v8, 2, v5
    v_add_u32 v8, 73728, v8
    ds_read_b32 v8, v8
    v_lshrrev_b32 v9, 4, v5
    v_mul_u32_u24 v9, 36864, v9
    v_and_b32 v10, 15, v5
    v_lshl_add_u32 v9, v10, 4, v9
    v_lshl_add_u32 v10, v7, 8, v9
    s_mul_i32 s12, s5, 294912
    s_add_u32 s12, s12, 3145728
    s_lshl_b32 s69, s6, 11
    s_add_u32 s69, s69, s12
    s_lshl_b32 s70, s6, 8
    s_add_u32 s70, s70, s12
    s_add_u32 s70, s70, 16384
    s_lshl_b32 s71, s5, 3
    s_add_u32 s71, s71, s6
    s_lshl_b32 s71, s71, 7
    s_add_u32 s71, s71, 32768
    s_cmp_eq_u32 s11, 0
    s_cbranch_scc1 L_oalead
    s_waitcnt vmcnt(0)
    v_mov_b32 v2, 162064
    v_mov_b32 v3, 1
    s_mov_b64 exec, 1
    ds_add_u32 v2, v3
    s_mov_b64 exec, -1
L_folkv:
    v_mov_b32 v2, 162060
    s_mov_b32 s82, 262144
L_ls32:
    ds_read_b32 v3, v2
    s_waitcnt lgkmcnt(0)
    v_readfirstlane_b32 s12, v3
    s_nop 0
    s_cmp_ge_u32 s12, 4
    s_cbranch_scc1 L_lo33
    s_sleep 4
    s_sub_u32 s82, s82, 1
    s_cbranch_scc0 L_ls32
L_lo33:
    s_mov_b32 s42, 0
    s_cmp_eq_u32 s7, 1
    s_cbranch_scc1 L_wt34
    s_lshl_b32 s12, s4, 4
    s_add_u32 s12, s12, s5
    s_cmp_lt_u32 s12, 92
    s_cbranch_scc1 L_wt35
    v_mov_b32 v2, 162052
    s_mov_b32 s82, 262144
L_ls36:
    ds_read_b32 v3, v2
    s_waitcnt lgkmcnt(0)
    v_readfirstlane_b32 s12, v3
    s_nop 0
    s_cmp_ge_u32 s12, 4
    s_cbranch_scc1 L_lo37
    s_sleep 1
    s_sub_u32 s82, s82, 1
    s_cbranch_scc0 L_ls36
L_lo37:
    s_and_b32 s70, s4, 1
    s_lshl_b32 s71, s10, 13
    s_and_b32 s13, s5, 1
    s_add_u32 s13, s13, 16
    s_bfe_u32 s14, s5, 0x10001
    s_cmp_eq_u32 s4, 5
    s_cselect_b32 s15, s13, s5
    s_cselect_b32 s70, s14, s70
    s_lshl_b32 s12, s6, 1
    s_add_u32 s70, s70, s12
    s_mov_b32 s58, 663552
    s_mov_b32 s59, 0x00020000
    s_cmp_ge_u32 s15, 9
    s_cselect_b32 s56, s32, s22
    s_cselect_b32 s57, s33, s23
    s_cselect_b32 s13, 9, 0
    s_sub_u32 s13, s15, s13
    s_mul_i32 s12, s13, 82944
    s_cmp_eq_u32 s13, 8
    s_cselect_b32 s12, 18432, s12
    s_cselect_b32 s13, 16, 0
    s_cselect_b32 s14, 73728, 0
    s_cselect_b32 s3, 71424, 0
    s_add_u32 s14, s14, 9216
    s_add_u32 s3, s3, 11520
    s_min_u32 s69, s70, 8
    s_lshl_b32 s69, s69, 4
    s_lshl_b32 s68, s70, 6
    s_add_u32 s68, s68, s69
    s_add_u32 s12, s12, s68
    v_lshrrev_b32 v16, 3, v1
    v_lshrrev_b32 v17, 4, v1
    v_mad_u32_u24 v16, v17, s13, v16
    v_mul_u32_u24 v16, 1152, v16
    v_and_b32 v18, 7, v1
    v_lshlrev_b32 v18, 4, v18
    v_add_u32 v16, v16, v18
    s_mov_b32 exec_lo, 0x1f1f1f1f
    s_mov_b32 exec_hi, 0x1f1f1f1f
    s_add_u32 m0, s71, 0
    s_nop 0
    buffer_load_dwordx4 v16, s[56:59], s12 offen lds
    s_add_u32 s12, s12, s14
    s_add_u32 m0, s71, 1024
    s_nop 0
    buffer_load_dwordx4 v16, s[56:59], s12 offen lds
    s_add_u32 s12, s12, s3
    s_add_u32 m0, s71, 2048
    s_nop 0
    buffer_load_dwordx4 v16, s[56:59], s12 offen lds
    s_add_u32 s12, s12, s14
    s_add_u32 m0, s71, 3072
    s_nop 0
    buffer_load_dwordx4 v16, s[56:59], s12 offen lds
    s_add_u32 s12, s12, s3
    s_add_u32 m0, s71, 4096
    s_nop 0
    buffer_load_dwordx4 v16, s[56:59], s12 offen lds
    s_add_u32 s12, s12, s14
    s_add_u32 m0, s71, 5120
    s_nop 0
    buffer_load_dwordx4 v16, s[56:59], s12 offen lds
    s_add_u32 s12, s12, s3
    s_add_u32 m0, s71, 6144
    s_nop 0
    buffer_load_dwordx4 v16, s[56:59], s12 offen lds
    s_add_u32 s12, s12, s14
    s_add_u32 m0, s71, 7168
    s_nop 0
    buffer_load_dwordx4 v16, s[56:59], s12 offen lds
    s_mov_b64 exec, -1
    v_bfe_u32 v18, v1, 2, 2
    v_lshl_add_u32 v17, v17, 3, v18
    v_and_b32 v18, 3, v1
    v_lshlrev_b32 v18, 3, v18
    v_lshl_add_u32 v17, v17, 7, v18
    v_add_u32 v17, s71, v17
    s_cmp_lt_u32 s70, 8
    s_cselect_b32 s12, 32, 0
    v_cmp_gt_u32 vcc, s12, v254
    v_mov_b32 v16, 2147483648
    v_subrev_u32 v18, 74752, v240
    v_cndmask_b32 v16, v16, v18, vcc
    s_mul_i32 s13, s70, 18
    s_add_u32 s13, s13, s15
    s_lshl_b32 s12, s70, 5
    s_add_u32 s12, s12, s15
    s_lshl_b32 s12, s12, 4
    s_add_u32 s42, s12, 4096
    s_mul_i32 s13, s13, 5120
    s_add_u32 s13, s13, 8912896
    s_add_u32 s14, s13, 4096
    s_waitcnt vmcnt(0)
    ds_read_b64_tr_b16 v[32:33], v17 offset:0
    ds_read_b64_tr_b16 v[34:35], v17 offset:512
    ds_read_b64_tr_b16 v[36:37], v17 offset:32
    ds_read_b64_tr_b16 v[38:39], v17 offset:544
    ds_read_b64_tr_b16 v[40:41], v17 offset:64
    ds_read_b64_tr_b16 v[42:43], v17 offset:576
    ds_read_b64_tr_b16 v[44:45], v17 offset:4096
    ds_read_b64_tr_b16 v[46:47], v17 offset:4608
    ds_read_b64_tr_b16 v[48:49], v17 offset:4128
    ds_read_b64_tr_b16 v[50:51], v17 offset:4640
    ds_read_b64_tr_b16 v[52:53], v17 offset:4160
    ds_read_b64_tr_b16 v[54:55], v17 offset:4672
    s_waitcnt lgkmcnt(0)
    buffer_store_dwordx4 v[32:35], v253, s[60:63], s13 offen offset:0 sc1
    buffer_store_dwordx4 v[36:39], v253, s[60:63], s13 offen offset:1024 sc1
    buffer_store_dwordx4 v[40:43], v16, s[60:63], s14 offen offset:0 sc1
    buffer_store_dwordx4 v[44:47], v253, s[60:63], s13 offen offset:2048 sc1
    buffer_store_dwordx4 v[48:51], v253, s[60:63], s13 offen offset:3072 sc1
    buffer_store_dwordx4 v[52:55], v16, s[60:63], s14 offen offset:512 sc1
L_wt35:
    v_mov_b32 v2, 162140
    v_mov_b32 v3, 1
    s_mov_b64 exec, 1
    ds_add_u32 v2, v3
    s_mov_b64 exec, -1
L_wt34:
    buffer_load_dwordx3 v[104:106], v31, s[60:63], s83 offen sc1
    buffer_load_dwordx3 v[108:110], v31, s[60:63], s43 offen sc1
L_leadkv:
    s_cmp_eq_u32 s77, 1
    s_cbranch_scc1 L_kvdone
    s_mov_b32 s82, 262144
    s_mov_b32 s14, 0x00030003
    s_mov_b32 s15, 0x00000003
L_sp38:
    s_waitcnt vmcnt(0)
    v_xor_b32 v3, s9, v104
    v_bitop3_b32 v3, v3, s9, v106 bitop3:0xf6
    v_bitop3_b32 v3, v3, s9, v108 bitop3:0xf6
    v_bitop3_b32 v3, v3, s9, v110 bitop3:0xf6
    v_cmp_ne_u32 vcc, 0, v3
    s_nop 0
    s_and_b64 s[12:13], vcc, s[14:15]
    s_cbranch_scc0 L_ok39
    s_sub_u32 s82, s82, 1
    s_cbranch_scc1 L_ok39
    s_sleep 1
    buffer_load_dwordx3 v[104:106], v31, s[60:63], s83 offen sc1
    buffer_load_dwordx3 v[108:110], v31, s[60:63], s43 offen sc1
    s_branch L_sp38
L_ok39:
    s_lshl_b32 s12, s4, 12
    s_add_u32 s55, s12, 163840
    s_add_u32 s53, s12, 65536
    s_add_u32 s54, s78, 131072
    buffer_load_dword v160, v246, s[60:63], s54 offen offset:0 sc1
    buffer_load_dwordx4 v[128:131], v245, s[60:63], s53 offen offset:0 sc1
    buffer_load_dwordx4 v[132:135], v245, s[60:63], s53 offen offset:512 sc1
    buffer_load_dwordx4 v[168:171], v247, s[60:63], s55 offen offset:0 sc1
    buffer_load_dwordx4 v[172:175], v247, s[60:63], s55 offen offset:256 sc1
    buffer_load_dwordx4 v[176:179], v247, s[60:63], s55 offen offset:512 sc1
    buffer_load_dwordx4 v[180:183], v247, s[60:63], s55 offen offset:768 sc1
    buffer_load_dword v162, v246, s[60:63], s54 offen offset:256 sc1
    buffer_load_dwordx4 v[136:139], v245, s[60:63], s53 offen offset:1024 sc1
    buffer_load_dwordx4 v[140:143], v245, s[60:63], s53 offen offset:1536 sc1
    buffer_load_dwordx4 v[184:187], v247, s[60:63], s55 offen offset:1024 sc1
    buffer_load_dwordx4 v[188:191], v247, s[60:63], s55 offen offset:1280 sc1
    buffer_load_dwordx4 v[192:195], v247, s[60:63], s55 offen offset:1536 sc1
    buffer_load_dwordx4 v[196:199], v247, s[60:63], s55 offen offset:1792 sc1
    buffer_load_dword v164, v246, s[60:63], s54 offen offset:512 sc1
    buffer_load_dwordx4 v[144:147], v245, s[60:63], s53 offen offset:2048 sc1
    buffer_load_dwordx4 v[148:151], v245, s[60:63], s53 offen offset:2560 sc1
L_kvdone:
    s_cmp_lg_u32 s4, 0
    s_cbranch_scc1 L_nm40
    v_mov_b32 v2, 162112
    s_mov_b32 s82, 262144
L_kn41:
    v_cmp_ne_u32 vcc, s9, v104
    s_cbranch_vccz L_kn41x
    s_sub_u32 s82, s82, 1
    s_cbranch_scc1 L_kn41x
    s_sleep 1
    buffer_load_dwordx2 v[104:105], v31, s[60:63], s83 offen sc1
    s_waitcnt vmcnt(0)
    s_branch L_kn41
L_kn41x:
    v_max_f32_dpp v105, v105, v105 row_ror:8 row_mask:0xf bank_mask:0xf
    s_nop 1
    v_max_f32_dpp v105, v105, v105 row_ror:4 row_mask:0xf bank_mask:0xf
    s_nop 1
    v_max_f32_dpp v105, v105, v105 row_ror:2 row_mask:0xf bank_mask:0xf
    s_nop 1
    v_max_f32_dpp v105, v105, v105 row_ror:1 row_mask:0xf bank_mask:0xf
    s_nop 0
    v_readlane_b32 s12, v105, 0
    v_readlane_b32 s13, v105, 16
    v_readlane_b32 s14, v105, 32
    v_mov_b32 v105, s12
    v_add_f32 v105, s13, v105
    v_add_f32 v105, s14, v105
    v_sqrt_f32 v105, v105
    s_nop 0
    v_mul_f32 v105, 0x3f8147ae, v105
    v_cvt_pk_bf16_f32 v105, v105, 1.0
    ds_write_b32 v2, v105 offset:4
L_nm40:
    buffer_load_dwordx4 v[200:203], v247, s[60:63], s55 offen offset:2048 sc1
    buffer_load_dwordx4 v[204:207], v247, s[60:63], s55 offen offset:2304 sc1
    buffer_load_dwordx4 v[208:211], v247, s[60:63], s55 offen offset:2560 sc1
    buffer_load_dwordx4 v[212:215], v247, s[60:63], s55 offen offset:2816 sc1
    buffer_load_dword v166, v246, s[60:63], s54 offen offset:768 sc1
    buffer_load_dwordx4 v[152:155], v245, s[60:63], s53 offen offset:3072 sc1
    buffer_load_dwordx4 v[156:159], v245, s[60:63], s53 offen offset:3584 sc1
    buffer_load_dwordx4 v[216:219], v247, s[60:63], s55 offen offset:3072 sc1
    buffer_load_dwordx4 v[220:223], v247, s[60:63], s55 offen offset:3328 sc1
    buffer_load_dwordx4 v[224:227], v247, s[60:63], s55 offen offset:3584 sc1
    buffer_load_dwordx4 v[228:231], v247, s[60:63], s55 offen offset:3840 sc1
    s_cmp_eq_u32 s11, 1
    s_cbranch_scc1 L_kl42
    v_mov_b32 v2, 162060
    v_mov_b32 v3, 1
    s_mov_b64 exec, 1
    ds_add_u32 v2, v3
    s_mov_b64 exec, -1
L_kl42:
    v_mov_b32 v2, 162120
    s_mov_b32 s82, 262144
L_ls43:
    ds_read_b32 v3, v2
    s_waitcnt lgkmcnt(0)
    v_readfirstlane_b32 s12, v3
    s_nop 0
    s_cmp_ge_u32 s12, 8
    s_cbranch_scc1 L_lo44
    s_sleep 1
    s_sub_u32 s82, s82, 1
    s_cbranch_scc0 L_ls43
L_lo44:
    v_mov_b32 v2, 162112
    s_cmp_lg_u32 s4, 0
    s_cbranch_scc1 L_sp45x
L_sp45x:
    s_mov_b32 s82, 262144
L_sp45:
    ds_read_b32 v161, v2 offset:4
    s_waitcnt lgkmcnt(0)
    v_cmp_eq_u32 vcc, 0, v161
    s_cbranch_vccz L_ok46
    s_sub_u32 s82, s82, 1
    s_cbranch_scc0 L_sp45
L_ok46:
    v_mov_b32 v163, v161
    v_mov_b32 v165, v161
    v_mov_b32 v167, v161
    ds_read_b128 v[112:115], v233
    ds_read2st64_b64 v[116:119], v234 offset0:0 offset1:3
    s_cmp_eq_u32 s11, 1
    s_cbranch_scc1 L_afol
    v_mfma_f32_32x32x8_bf16 v[80:95], v[238:239], v[238:239], 0
    s_mov_b32 s3, 262144
L_kcl0:
    s_waitcnt vmcnt(25)
    v_max3_u32 v125, v160, v131, v135
    v_cmp_eq_u32 vcc, -1, v125
    s_cbranch_vccnz L_krl0
L_kgl0:
    s_setprio 1
    s_waitcnt lgkmcnt(0)
    v_mfma_f32_32x32x4_2b_bf16 v[16:47], v[160:161], v[116:117], 0
    s_nop 15
    s_nop 1
    v_mfma_f32_32x32x16_bf16 v[16:31], v[128:131], v[112:115], v[16:31]
    v_mfma_f32_32x32x16_bf16 v[32:47], v[132:135], v[112:115], v[32:47]
    s_nop 11
    v_exp_f32 v16, v16
    v_exp_f32 v17, v17
    v_exp_f32 v18, v18
    v_exp_f32 v19, v19
L_kcl1:
    s_waitcnt vmcnt(18)
    v_max3_u32 v125, v171, v175, v179
    v_max3_u32 v125, v125, v183, v162
    v_max3_u32 v125, v125, v139, v143
    v_cmp_eq_u32 vcc, -1, v125
    s_cbranch_vccnz L_krl1
L_kgl1:
    v_exp_f32 v20, v20
    v_exp_f32 v21, v21
    v_mfma_f32_32x32x4_2b_bf16 v[48:79], v[162:163], v[116:117], 0
    v_exp_f32 v22, v22
    v_exp_f32 v23, v23
    v_exp_f32 v24, v24
    v_exp_f32 v25, v25
    v_exp_f32 v26, v26
    v_exp_f32 v27, v27
    v_exp_f32 v28, v28
    v_exp_f32 v29, v29
    v_smfmac_f32_32x32x32_bf16 v[80:95], v[168:171], v[16:23], v232
    v_exp_f32 v30, v30
    v_exp_f32 v31, v31
    v_exp_f32 v32, v32
    v_exp_f32 v33, v33
    v_smfmac_f32_32x32x32_bf16 v[80:95], v[172:175], v[24:31], v232
    v_exp_f32 v34, v34
    v_exp_f32 v35, v35
    v_exp_f32 v36, v36
    v_exp_f32 v37, v37
    v_mfma_f32_32x32x16_bf16 v[48:63], v[136:139], v[112:115], v[48:63]
    v_exp_f32 v38, v38
    v_exp_f32 v39, v39
    v_exp_f32 v40, v40
    v_exp_f32 v41, v41
    v_smfmac_f32_32x32x32_bf16 v[80:95], v[176:179], v[32:39], v232
    v_exp_f32 v42, v42
    v_exp_f32 v43, v43
    v_exp_f32 v44, v44
    v_exp_f32 v45, v45
    v_mfma_f32_32x32x16_bf16 v[64:79], v[140:143], v[112:115], v[64:79]
    v_exp_f32 v46, v46
    v_exp_f32 v47, v47
    v_exp_f32 v48, v48
    v_exp_f32 v49, v49
    v_smfmac_f32_32x32x32_bf16 v[80:95], v[180:183], v[40:47], v232
    v_exp_f32 v50, v50
    v_exp_f32 v51, v51
L_kcl2:
    s_waitcnt vmcnt(11)
    v_max3_u32 v125, v187, v191, v195
    v_max3_u32 v125, v125, v199, v164
    v_max3_u32 v125, v125, v147, v151
    v_cmp_eq_u32 vcc, -1, v125
    s_cbranch_vccnz L_krl2
L_kgl2:
    v_exp_f32 v52, v52
    v_exp_f32 v53, v53
    v_mfma_f32_32x32x4_2b_bf16 v[16:47], v[164:165], v[116:117], 0
    v_exp_f32 v54, v54
    v_exp_f32 v55, v55
    v_exp_f32 v56, v56
    v_exp_f32 v57, v57
    v_exp_f32 v58, v58
    v_exp_f32 v59, v59
    v_exp_f32 v60, v60
    v_exp_f32 v61, v61
    v_smfmac_f32_32x32x32_bf16 v[80:95], v[184:187], v[48:55], v232
    v_exp_f32 v62, v62
    v_exp_f32 v63, v63
    v_mfma_f32_32x32x8_bf16 v[96:111], v[238:239], v[238:239], 0
    v_exp_f32 v64, v64
    v_exp_f32 v65, v65
    v_smfmac_f32_32x32x32_bf16 v[80:95], v[188:191], v[56:63], v232
    v_exp_f32 v66, v66
    v_exp_f32 v67, v67
    v_exp_f32 v68, v68
    v_exp_f32 v69, v69
    v_mfma_f32_32x32x16_bf16 v[16:31], v[144:147], v[112:115], v[16:31]
    v_exp_f32 v70, v70
    v_exp_f32 v71, v71
    v_exp_f32 v72, v72
    v_exp_f32 v73, v73
    v_smfmac_f32_32x32x32_bf16 v[80:95], v[192:195], v[64:71], v232
    v_exp_f32 v74, v74
    v_exp_f32 v75, v75
    v_exp_f32 v76, v76
    v_exp_f32 v77, v77
    v_mfma_f32_32x32x16_bf16 v[32:47], v[148:151], v[112:115], v[32:47]
    v_exp_f32 v78, v78
    v_exp_f32 v79, v79
    v_exp_f32 v16, v16
    v_exp_f32 v17, v17
    v_smfmac_f32_32x32x32_bf16 v[80:95], v[196:199], v[72:79], v232
    v_exp_f32 v18, v18
    v_exp_f32 v19, v19
L_kcl3:
    s_waitcnt vmcnt(4)
    v_max3_u32 v125, v203, v207, v211
    v_max3_u32 v125, v125, v215, v166
    v_max3_u32 v125, v125, v155, v159
    v_cmp_eq_u32 vcc, -1, v125
    s_cbranch_vccnz L_krl3
L_kgl3:
    v_exp_f32 v20, v20
    v_exp_f32 v21, v21
    v_mfma_f32_32x32x4_2b_bf16 v[48:79], v[166:167], v[116:117], 0
    v_exp_f32 v22, v22
    v_exp_f32 v23, v23
    v_exp_f32 v24, v24
    v_exp_f32 v25, v25
    v_exp_f32 v26, v26
    v_exp_f32 v27, v27
    v_exp_f32 v28, v28
    v_exp_f32 v29, v29
    v_smfmac_f32_32x32x32_bf16 v[80:95], v[200:203], v[16:23], v232
    v_exp_f32 v30, v30
    v_exp_f32 v31, v31
    v_exp_f32 v32, v32
    v_exp_f32 v33, v33
    v_smfmac_f32_32x32x32_bf16 v[80:95], v[204:207], v[24:31], v232
    v_exp_f32 v34, v34
    v_exp_f32 v35, v35
    v_exp_f32 v36, v36
    v_exp_f32 v37, v37
    v_mfma_f32_32x32x16_bf16 v[48:63], v[152:155], v[112:115], v[48:63]
    v_exp_f32 v38, v38
    v_exp_f32 v39, v39
    v_exp_f32 v40, v40
    v_exp_f32 v41, v41
    v_smfmac_f32_32x32x32_bf16 v[80:95], v[208:211], v[32:39], v232
    v_exp_f32 v42, v42
    v_exp_f32 v43, v43
    v_exp_f32 v44, v44
    v_exp_f32 v45, v45
    v_mfma_f32_32x32x16_bf16 v[64:79], v[156:159], v[112:115], v[64:79]
    ds_read_b128 v[112:115], v233 offset:1536
    v_exp_f32 v46, v46
    v_exp_f32 v47, v47
    v_exp_f32 v48, v48
    v_exp_f32 v49, v49
    v_smfmac_f32_32x32x32_bf16 v[80:95], v[212:215], v[40:47], v232
    v_exp_f32 v50, v50
    v_exp_f32 v51, v51
L_kcl4:
    s_waitcnt vmcnt(0)
    v_max3_u32 v125, v219, v223, v227
    v_max3_u32 v125, v125, v231, v219
    v_cmp_eq_u32 vcc, -1, v125
    s_cbranch_vccnz L_krl4
L_kgl4:
    v_exp_f32 v52, v52
    v_exp_f32 v53, v53
    v_mfma_f32_32x32x4_2b_bf16 v[16:47], v[160:161], v[118:119], 0
    v_exp_f32 v54, v54
    v_exp_f32 v55, v55
    v_exp_f32 v56, v56
    v_exp_f32 v57, v57
    v_exp_f32 v58, v58
    v_exp_f32 v59, v59
    v_exp_f32 v60, v60
    v_exp_f32 v61, v61
    v_smfmac_f32_32x32x32_bf16 v[80:95], v[216:219], v[48:55], v232
    v_exp_f32 v62, v62
    v_exp_f32 v63, v63
    v_exp_f32 v64, v64
    v_exp_f32 v65, v65
    v_smfmac_f32_32x32x32_bf16 v[80:95], v[220:223], v[56:63], v232
    s_waitcnt lgkmcnt(0)
    v_exp_f32 v66, v66
    v_exp_f32 v67, v67
    v_exp_f32 v68, v68
    v_exp_f32 v69, v69
    v_mfma_f32_32x32x16_bf16 v[16:31], v[128:131], v[112:115], v[16:31]
    v_exp_f32 v70, v70
    v_exp_f32 v71, v71
    v_exp_f32 v72, v72
    v_exp_f32 v73, v73
    v_smfmac_f32_32x32x32_bf16 v[80:95], v[224:227], v[64:71], v232
    v_exp_f32 v74, v74
    v_exp_f32 v75, v75
    v_exp_f32 v76, v76
    v_exp_f32 v77, v77
    v_mfma_f32_32x32x16_bf16 v[32:47], v[132:135], v[112:115], v[32:47]
    v_exp_f32 v78, v78
    v_exp_f32 v79, v79
    v_exp_f32 v16, v16
    v_exp_f32 v17, v17
    v_smfmac_f32_32x32x32_bf16 v[80:95], v[228:231], v[72:79], v232
    v_exp_f32 v18, v18
    v_exp_f32 v19, v19
    v_exp_f32 v20, v20
    v_exp_f32 v21, v21
    v_mfma_f32_32x32x4_2b_bf16 v[48:79], v[162:163], v[118:119], 0
    v_exp_f32 v22, v22
    v_exp_f32 v23, v23
    v_exp_f32 v24, v24
    v_exp_f32 v25, v25
    v_exp_f32 v26, v26
    v_exp_f32 v27, v27
    v_exp_f32 v28, v28
    v_exp_f32 v29, v29
    v_smfmac_f32_32x32x32_bf16 v[96:111], v[168:171], v[16:23], v232
    ds_write2st64_b64 v235, v[80:81], v[82:83] offset0:0 offset1:1
    v_exp_f32 v30, v30
    v_exp_f32 v31, v31
    v_exp_f32 v32, v32
    v_exp_f32 v33, v33
    v_smfmac_f32_32x32x32_bf16 v[96:111], v[172:175], v[24:31], v232
    ds_write2st64_b64 v235, v[84:85], v[86:87] offset0:2 offset1:3
    v_exp_f32 v34, v34
    v_exp_f32 v35, v35
    v_exp_f32 v36, v36
    v_exp_f32 v37, v37
    v_mfma_f32_32x32x16_bf16 v[48:63], v[136:139], v[112:115], v[48:63]
    ds_write_b64 v235, v[88:89] offset:2048
    v_exp_f32 v38, v38
    v_exp_f32 v39, v39
    v_exp_f32 v40, v40
    v_exp_f32 v41, v41
    v_smfmac_f32_32x32x32_bf16 v[96:111], v[176:179], v[32:39], v232
    v_exp_f32 v42, v42
    v_exp_f32 v43, v43
    v_exp_f32 v44, v44
    v_exp_f32 v45, v45
    v_mfma_f32_32x32x16_bf16 v[64:79], v[140:143], v[112:115], v[64:79]
    v_exp_f32 v46, v46
    v_exp_f32 v47, v47
    v_exp_f32 v48, v48
    v_exp_f32 v49, v49
    v_smfmac_f32_32x32x32_bf16 v[96:111], v[180:183], v[40:47], v232
    v_exp_f32 v50, v50
    v_exp_f32 v51, v51
    v_exp_f32 v52, v52
    v_exp_f32 v53, v53
    v_mfma_f32_32x32x4_2b_bf16 v[16:47], v[164:165], v[118:119], 0
    v_exp_f32 v54, v54
    v_exp_f32 v55, v55
    v_exp_f32 v56, v56
    v_exp_f32 v57, v57
    v_exp_f32 v58, v58
    v_exp_f32 v59, v59
    v_exp_f32 v60, v60
    v_exp_f32 v61, v61
    v_smfmac_f32_32x32x32_bf16 v[96:111], v[184:187], v[48:55], v232
    v_exp_f32 v62, v62
    v_exp_f32 v63, v63
    v_mfma_f32_32x32x8_bf16 v[80:95], v[238:239], v[238:239], 0
    v_exp_f32 v64, v64
    v_exp_f32 v65, v65
    v_smfmac_f32_32x32x32_bf16 v[96:111], v[188:191], v[56:63], v232
    v_exp_f32 v66, v66
    v_exp_f32 v67, v67
    v_exp_f32 v68, v68
    v_exp_f32 v69, v69
    v_mfma_f32_32x32x16_bf16 v[16:31], v[144:147], v[112:115], v[16:31]
    v_exp_f32 v70, v70
    v_exp_f32 v71, v71
    v_exp_f32 v72, v72
    v_exp_f32 v73, v73
    v_smfmac_f32_32x32x32_bf16 v[96:111], v[192:195], v[64:71], v232
    v_exp_f32 v74, v74
    v_exp_f32 v75, v75
    v_exp_f32 v76, v76
    v_exp_f32 v77, v77
    v_mfma_f32_32x32x16_bf16 v[32:47], v[148:151], v[112:115], v[32:47]
    v_exp_f32 v78, v78
    v_exp_f32 v79, v79
    v_exp_f32 v16, v16
    v_exp_f32 v17, v17
    v_smfmac_f32_32x32x32_bf16 v[96:111], v[196:199], v[72:79], v232
    v_exp_f32 v18, v18
    v_exp_f32 v19, v19
    v_exp_f32 v20, v20
    v_exp_f32 v21, v21
    v_mfma_f32_32x32x4_2b_bf16 v[48:79], v[166:167], v[118:119], 0
    v_exp_f32 v22, v22
    v_exp_f32 v23, v23
    v_exp_f32 v24, v24
    v_exp_f32 v25, v25
    v_exp_f32 v26, v26
    v_exp_f32 v27, v27
    v_exp_f32 v28, v28
    v_exp_f32 v29, v29
    v_smfmac_f32_32x32x32_bf16 v[96:111], v[200:203], v[16:23], v232
    ds_read2st64_b64 v[116:119], v234 offset0:6 offset1:9
    v_exp_f32 v30, v30
    v_exp_f32 v31, v31
    v_exp_f32 v32, v32
    v_exp_f32 v33, v33
    v_smfmac_f32_32x32x32_bf16 v[96:111], v[204:207], v[24:31], v232
    v_exp_f32 v34, v34
    v_exp_f32 v35, v35
    v_exp_f32 v36, v36
    v_exp_f32 v37, v37
    v_mfma_f32_32x32x16_bf16 v[48:63], v[152:155], v[112:115], v[48:63]
    v_exp_f32 v38, v38
    v_exp_f32 v39, v39
    v_exp_f32 v40, v40
    v_exp_f32 v41, v41
    v_smfmac_f32_32x32x32_bf16 v[96:111], v[208:211], v[32:39], v232
    v_exp_f32 v42, v42
    v_exp_f32 v43, v43
    v_exp_f32 v44, v44
    v_exp_f32 v45, v45
    v_mfma_f32_32x32x16_bf16 v[64:79], v[156:159], v[112:115], v[64:79]
    ds_read_b128 v[112:115], v233 offset:3072
    v_exp_f32 v46, v46
    v_exp_f32 v47, v47
    v_exp_f32 v48, v48
    v_exp_f32 v49, v49
    v_smfmac_f32_32x32x32_bf16 v[96:111], v[212:215], v[40:47], v232
    s_waitcnt lgkmcnt(1)
    v_exp_f32 v50, v50
    v_exp_f32 v51, v51
    v_exp_f32 v52, v52
    v_exp_f32 v53, v53
    v_mfma_f32_32x32x4_2b_bf16 v[16:47], v[160:161], v[116:117], 0
    v_exp_f32 v54, v54
    v_exp_f32 v55, v55
    v_exp_f32 v56, v56
    v_exp_f32 v57, v57
    v_exp_f32 v58, v58
    v_exp_f32 v59, v59
    v_exp_f32 v60, v60
    v_exp_f32 v61, v61
    v_smfmac_f32_32x32x32_bf16 v[96:111], v[216:219], v[48:55], v232
    v_exp_f32 v62, v62
    v_exp_f32 v63, v63
    v_exp_f32 v64, v64
    v_exp_f32 v65, v65
    v_smfmac_f32_32x32x32_bf16 v[96:111], v[220:223], v[56:63], v232
    s_waitcnt lgkmcnt(0)
    v_exp_f32 v66, v66
    v_exp_f32 v67, v67
    v_exp_f32 v68, v68
    v_exp_f32 v69, v69
    v_mfma_f32_32x32x16_bf16 v[16:31], v[128:131], v[112:115], v[16:31]
    v_exp_f32 v70, v70
    v_exp_f32 v71, v71
    v_exp_f32 v72, v72
    v_exp_f32 v73, v73
    v_smfmac_f32_32x32x32_bf16 v[96:111], v[224:227], v[64:71], v232
    v_exp_f32 v74, v74
    v_exp_f32 v75, v75
    v_exp_f32 v76, v76
    v_exp_f32 v77, v77
    v_mfma_f32_32x32x16_bf16 v[32:47], v[132:135], v[112:115], v[32:47]
    v_exp_f32 v78, v78
    v_exp_f32 v79, v79
    v_exp_f32 v16, v16
    v_exp_f32 v17, v17
    v_smfmac_f32_32x32x32_bf16 v[96:111], v[228:231], v[72:79], v232
    v_exp_f32 v18, v18
    v_exp_f32 v19, v19
    v_exp_f32 v20, v20
    v_exp_f32 v21, v21
    v_mfma_f32_32x32x4_2b_bf16 v[48:79], v[162:163], v[116:117], 0
    v_exp_f32 v22, v22
    v_exp_f32 v23, v23
    v_exp_f32 v24, v24
    v_exp_f32 v25, v25
    v_exp_f32 v26, v26
    v_exp_f32 v27, v27
    v_exp_f32 v28, v28
    v_exp_f32 v29, v29
    v_smfmac_f32_32x32x32_bf16 v[80:95], v[168:171], v[16:23], v232
    ds_write2st64_b64 v235, v[96:97], v[98:99] offset0:20 offset1:21
    v_exp_f32 v30, v30
    v_exp_f32 v31, v31
    v_exp_f32 v32, v32
    v_exp_f32 v33, v33
    v_smfmac_f32_32x32x32_bf16 v[80:95], v[172:175], v[24:31], v232
    ds_write2st64_b64 v235, v[100:101], v[102:103] offset0:22 offset1:23
    v_exp_f32 v34, v34
    v_exp_f32 v35, v35
    v_exp_f32 v36, v36
    v_exp_f32 v37, v37
    v_mfma_f32_32x32x16_bf16 v[48:63], v[136:139], v[112:115], v[48:63]
    ds_write_b64 v235, v[104:105] offset:12288
    v_exp_f32 v38, v38
    v_exp_f32 v39, v39
    v_exp_f32 v40, v40
    v_exp_f32 v41, v41
    v_smfmac_f32_32x32x32_bf16 v[80:95], v[176:179], v[32:39], v232
    v_exp_f32 v42, v42
    v_exp_f32 v43, v43
    v_exp_f32 v44, v44
    v_exp_f32 v45, v45
    v_mfma_f32_32x32x16_bf16 v[64:79], v[140:143], v[112:115], v[64:79]
    v_exp_f32 v46, v46
    v_exp_f32 v47, v47
    v_exp_f32 v48, v48
    v_exp_f32 v49, v49
    v_smfmac_f32_32x32x32_bf16 v[80:95], v[180:183], v[40:47], v232
    v_exp_f32 v50, v50
    v_exp_f32 v51, v51
    v_exp_f32 v52, v52
    v_exp_f32 v53, v53
    v_mfma_f32_32x32x4_2b_bf16 v[16:47], v[164:165], v[116:117], 0
    v_exp_f32 v54, v54
    v_exp_f32 v55, v55
    v_exp_f32 v56, v56
    v_exp_f32 v57, v57
    v_exp_f32 v58, v58
    v_exp_f32 v59, v59
    v_exp_f32 v60, v60
    v_exp_f32 v61, v61
    v_smfmac_f32_32x32x32_bf16 v[80:95], v[184:187], v[48:55], v232
    v_exp_f32 v62, v62
    v_exp_f32 v63, v63
    v_mfma_f32_32x32x8_bf16 v[96:111], v[238:239], v[238:239], 0
    v_exp_f32 v64, v64
    v_exp_f32 v65, v65
    v_smfmac_f32_32x32x32_bf16 v[80:95], v[188:191], v[56:63], v232
    v_exp_f32 v66, v66
    v_exp_f32 v67, v67
    v_exp_f32 v68, v68
    v_exp_f32 v69, v69
    v_mfma_f32_32x32x16_bf16 v[16:31], v[144:147], v[112:115], v[16:31]
    v_exp_f32 v70, v70
    v_exp_f32 v71, v71
    v_exp_f32 v72, v72
    v_exp_f32 v73, v73
    v_smfmac_f32_32x32x32_bf16 v[80:95], v[192:195], v[64:71], v232
    v_exp_f32 v74, v74
    v_exp_f32 v75, v75
    v_exp_f32 v76, v76
    v_exp_f32 v77, v77
    v_mfma_f32_32x32x16_bf16 v[32:47], v[148:151], v[112:115], v[32:47]
    v_exp_f32 v78, v78
    v_exp_f32 v79, v79
    v_exp_f32 v16, v16
    v_exp_f32 v17, v17
    v_smfmac_f32_32x32x32_bf16 v[80:95], v[196:199], v[72:79], v232
    v_exp_f32 v18, v18
    v_exp_f32 v19, v19
    v_exp_f32 v20, v20
    v_exp_f32 v21, v21
    v_mfma_f32_32x32x4_2b_bf16 v[48:79], v[166:167], v[116:117], 0
    v_exp_f32 v22, v22
    v_exp_f32 v23, v23
    v_exp_f32 v24, v24
    v_exp_f32 v25, v25
    v_exp_f32 v26, v26
    v_exp_f32 v27, v27
    v_exp_f32 v28, v28
    v_exp_f32 v29, v29
    v_smfmac_f32_32x32x32_bf16 v[80:95], v[200:203], v[16:23], v232
    v_exp_f32 v30, v30
    v_exp_f32 v31, v31
    v_exp_f32 v32, v32
    v_exp_f32 v33, v33
    v_smfmac_f32_32x32x32_bf16 v[80:95], v[204:207], v[24:31], v232
    v_exp_f32 v34, v34
    v_exp_f32 v35, v35
    v_exp_f32 v36, v36
    v_exp_f32 v37, v37
    v_mfma_f32_32x32x16_bf16 v[48:63], v[152:155], v[112:115], v[48:63]
    v_exp_f32 v38, v38
    v_exp_f32 v39, v39
    v_exp_f32 v40, v40
    v_exp_f32 v41, v41
    v_smfmac_f32_32x32x32_bf16 v[80:95], v[208:211], v[32:39], v232
    v_exp_f32 v42, v42
    v_exp_f32 v43, v43
    v_exp_f32 v44, v44
    v_exp_f32 v45, v45
    v_mfma_f32_32x32x16_bf16 v[64:79], v[156:159], v[112:115], v[64:79]
    ds_read_b128 v[112:115], v233 offset:4608
    v_exp_f32 v46, v46
    v_exp_f32 v47, v47
    v_exp_f32 v48, v48
    v_exp_f32 v49, v49
    v_smfmac_f32_32x32x32_bf16 v[80:95], v[212:215], v[40:47], v232
    v_exp_f32 v50, v50
    v_exp_f32 v51, v51
    v_exp_f32 v52, v52
    v_exp_f32 v53, v53
    v_mfma_f32_32x32x4_2b_bf16 v[16:47], v[160:161], v[118:119], 0
    v_exp_f32 v54, v54
    v_exp_f32 v55, v55
    v_exp_f32 v56, v56
    v_exp_f32 v57, v57
    v_exp_f32 v58, v58
    v_exp_f32 v59, v59
    v_exp_f32 v60, v60
    v_exp_f32 v61, v61
    v_smfmac_f32_32x32x32_bf16 v[80:95], v[216:219], v[48:55], v232
    v_exp_f32 v62, v62
    v_exp_f32 v63, v63
    v_exp_f32 v64, v64
    v_exp_f32 v65, v65
    v_smfmac_f32_32x32x32_bf16 v[80:95], v[220:223], v[56:63], v232
    s_waitcnt lgkmcnt(0)
    v_exp_f32 v66, v66
    v_exp_f32 v67, v67
    v_exp_f32 v68, v68
    v_exp_f32 v69, v69
    v_mfma_f32_32x32x16_bf16 v[16:31], v[128:131], v[112:115], v[16:31]
    v_exp_f32 v70, v70
    v_exp_f32 v71, v71
    v_exp_f32 v72, v72
    v_exp_f32 v73, v73
    v_smfmac_f32_32x32x32_bf16 v[80:95], v[224:227], v[64:71], v232
    v_exp_f32 v74, v74
    v_exp_f32 v75, v75
    v_exp_f32 v76, v76
    v_exp_f32 v77, v77
    v_mfma_f32_32x32x16_bf16 v[32:47], v[132:135], v[112:115], v[32:47]
    v_exp_f32 v78, v78
    v_exp_f32 v79, v79
    v_exp_f32 v16, v16
    v_exp_f32 v17, v17
    v_smfmac_f32_32x32x32_bf16 v[80:95], v[228:231], v[72:79], v232
    v_exp_f32 v18, v18
    v_exp_f32 v19, v19
    v_exp_f32 v20, v20
    v_exp_f32 v21, v21
    v_mfma_f32_32x32x4_2b_bf16 v[48:79], v[162:163], v[118:119], 0
    v_exp_f32 v22, v22
    v_exp_f32 v23, v23
    v_exp_f32 v24, v24
    v_exp_f32 v25, v25
    v_exp_f32 v26, v26
    v_exp_f32 v27, v27
    v_exp_f32 v28, v28
    v_exp_f32 v29, v29
    v_smfmac_f32_32x32x32_bf16 v[96:111], v[168:171], v[16:23], v232
    ds_write2st64_b64 v235, v[80:81], v[82:83] offset0:40 offset1:41
    v_exp_f32 v30, v30
    v_exp_f32 v31, v31
    v_exp_f32 v32, v32
    v_exp_f32 v33, v33
    v_smfmac_f32_32x32x32_bf16 v[96:111], v[172:175], v[24:31], v232
    ds_write2st64_b64 v235, v[84:85], v[86:87] offset0:42 offset1:43
    v_exp_f32 v34, v34
    v_exp_f32 v35, v35
    v_exp_f32 v36, v36
    v_exp_f32 v37, v37
    v_mfma_f32_32x32x16_bf16 v[48:63], v[136:139], v[112:115], v[48:63]
    ds_write_b64 v235, v[88:89] offset:22528
    v_exp_f32 v38, v38
    v_exp_f32 v39, v39
    v_exp_f32 v40, v40
    v_exp_f32 v41, v41
    v_smfmac_f32_32x32x32_bf16 v[96:111], v[176:179], v[32:39], v232
    v_exp_f32 v42, v42
    v_exp_f32 v43, v43
    v_exp_f32 v44, v44
    v_exp_f32 v45, v45
    v_mfma_f32_32x32x16_bf16 v[64:79], v[140:143], v[112:115], v[64:79]
    v_exp_f32 v46, v46
    v_exp_f32 v47, v47
    v_exp_f32 v48, v48
    v_exp_f32 v49, v49
    v_smfmac_f32_32x32x32_bf16 v[96:111], v[180:183], v[40:47], v232
    v_exp_f32 v50, v50
    v_exp_f32 v51, v51
    v_exp_f32 v52, v52
    v_exp_f32 v53, v53
    v_mfma_f32_32x32x4_2b_bf16 v[16:47], v[164:165], v[118:119], 0
    v_exp_f32 v54, v54
    v_exp_f32 v55, v55
    v_exp_f32 v56, v56
    v_exp_f32 v57, v57
    v_exp_f32 v58, v58
    v_exp_f32 v59, v59
    v_exp_f32 v60, v60
    v_exp_f32 v61, v61
    v_smfmac_f32_32x32x32_bf16 v[96:111], v[184:187], v[48:55], v232
    v_exp_f32 v62, v62
    v_exp_f32 v63, v63
    v_mfma_f32_32x32x8_bf16 v[80:95], v[238:239], v[238:239], 0
    v_exp_f32 v64, v64
    v_exp_f32 v65, v65
    v_smfmac_f32_32x32x32_bf16 v[96:111], v[188:191], v[56:63], v232
    v_exp_f32 v66, v66
    v_exp_f32 v67, v67
    v_exp_f32 v68, v68
    v_exp_f32 v69, v69
    v_mfma_f32_32x32x16_bf16 v[16:31], v[144:147], v[112:115], v[16:31]
    v_exp_f32 v70, v70
    v_exp_f32 v71, v71
    v_exp_f32 v72, v72
    v_exp_f32 v73, v73
    v_smfmac_f32_32x32x32_bf16 v[96:111], v[192:195], v[64:71], v232
    v_exp_f32 v74, v74
    v_exp_f32 v75, v75
    v_exp_f32 v76, v76
    v_exp_f32 v77, v77
    v_mfma_f32_32x32x16_bf16 v[32:47], v[148:151], v[112:115], v[32:47]
    v_exp_f32 v78, v78
    v_exp_f32 v79, v79
    v_exp_f32 v16, v16
    v_exp_f32 v17, v17
    v_smfmac_f32_32x32x32_bf16 v[96:111], v[196:199], v[72:79], v232
    v_exp_f32 v18, v18
    v_exp_f32 v19, v19
    v_exp_f32 v20, v20
    v_exp_f32 v21, v21
    v_mfma_f32_32x32x4_2b_bf16 v[48:79], v[166:167], v[118:119], 0
    v_exp_f32 v22, v22
    v_exp_f32 v23, v23
    v_exp_f32 v24, v24
    v_exp_f32 v25, v25
    v_exp_f32 v26, v26
    v_exp_f32 v27, v27
    v_exp_f32 v28, v28
    v_exp_f32 v29, v29
    v_smfmac_f32_32x32x32_bf16 v[96:111], v[200:203], v[16:23], v232
    ds_read2st64_b64 v[116:119], v234 offset0:12 offset1:15
    v_exp_f32 v30, v30
    v_exp_f32 v31, v31
    v_exp_f32 v32, v32
    v_exp_f32 v33, v33
    v_smfmac_f32_32x32x32_bf16 v[96:111], v[204:207], v[24:31], v232
    v_exp_f32 v34, v34
    v_exp_f32 v35, v35
    v_exp_f32 v36, v36
    v_exp_f32 v37, v37
    v_mfma_f32_32x32x16_bf16 v[48:63], v[152:155], v[112:115], v[48:63]
    v_exp_f32 v38, v38
    v_exp_f32 v39, v39
    v_exp_f32 v40, v40
    v_exp_f32 v41, v41
    v_smfmac_f32_32x32x32_bf16 v[96:111], v[208:211], v[32:39], v232
    v_exp_f32 v42, v42
    v_exp_f32 v43, v43
    v_exp_f32 v44, v44
    v_exp_f32 v45, v45
    v_mfma_f32_32x32x16_bf16 v[64:79], v[156:159], v[112:115], v[64:79]
    ds_read_b128 v[112:115], v233 offset:6144
    v_exp_f32 v46, v46
    v_exp_f32 v47, v47
    v_exp_f32 v48, v48
    v_exp_f32 v49, v49
    v_smfmac_f32_32x32x32_bf16 v[96:111], v[212:215], v[40:47], v232
    s_waitcnt lgkmcnt(1)
    v_exp_f32 v50, v50
    v_exp_f32 v51, v51
    v_exp_f32 v52, v52
    v_exp_f32 v53, v53
    v_mfma_f32_32x32x4_2b_bf16 v[16:47], v[160:161], v[116:117], 0
    v_exp_f32 v54, v54
    v_exp_f32 v55, v55
    v_exp_f32 v56, v56
    v_exp_f32 v57, v57
    v_exp_f32 v58, v58
    v_exp_f32 v59, v59
    v_exp_f32 v60, v60
    v_exp_f32 v61, v61
    v_smfmac_f32_32x32x32_bf16 v[96:111], v[216:219], v[48:55], v232
    v_exp_f32 v62, v62
    v_exp_f32 v63, v63
    v_exp_f32 v64, v64
    v_exp_f32 v65, v65
    v_smfmac_f32_32x32x32_bf16 v[96:111], v[220:223], v[56:63], v232
    s_waitcnt lgkmcnt(0)
    v_exp_f32 v66, v66
    v_exp_f32 v67, v67
    v_exp_f32 v68, v68
    v_exp_f32 v69, v69
    v_mfma_f32_32x32x16_bf16 v[16:31], v[128:131], v[112:115], v[16:31]
    v_exp_f32 v70, v70
    v_exp_f32 v71, v71
    v_exp_f32 v72, v72
    v_exp_f32 v73, v73
    v_smfmac_f32_32x32x32_bf16 v[96:111], v[224:227], v[64:71], v232
    v_exp_f32 v74, v74
    v_exp_f32 v75, v75
    v_exp_f32 v76, v76
    v_exp_f32 v77, v77
    v_mfma_f32_32x32x16_bf16 v[32:47], v[132:135], v[112:115], v[32:47]
    v_exp_f32 v78, v78
    v_exp_f32 v79, v79
    v_exp_f32 v16, v16
    v_exp_f32 v17, v17
    v_smfmac_f32_32x32x32_bf16 v[96:111], v[228:231], v[72:79], v232
    v_exp_f32 v18, v18
    v_exp_f32 v19, v19
    v_exp_f32 v20, v20
    v_exp_f32 v21, v21
    v_mfma_f32_32x32x4_2b_bf16 v[48:79], v[162:163], v[116:117], 0
    v_exp_f32 v22, v22
    v_exp_f32 v23, v23
    v_exp_f32 v24, v24
    v_exp_f32 v25, v25
    v_exp_f32 v26, v26
    v_exp_f32 v27, v27
    v_exp_f32 v28, v28
    v_exp_f32 v29, v29
    v_smfmac_f32_32x32x32_bf16 v[80:95], v[168:171], v[16:23], v232
    ds_write2st64_b64 v235, v[96:97], v[98:99] offset0:60 offset1:61
    v_exp_f32 v30, v30
    v_exp_f32 v31, v31
    v_exp_f32 v32, v32
    v_exp_f32 v33, v33
    v_smfmac_f32_32x32x32_bf16 v[80:95], v[172:175], v[24:31], v232
    ds_write2st64_b64 v235, v[100:101], v[102:103] offset0:62 offset1:63
    v_exp_f32 v34, v34
    v_exp_f32 v35, v35
    v_exp_f32 v36, v36
    v_exp_f32 v37, v37
    v_mfma_f32_32x32x16_bf16 v[48:63], v[136:139], v[112:115], v[48:63]
    ds_write_b64 v235, v[104:105] offset:32768
    v_exp_f32 v38, v38
    v_exp_f32 v39, v39
    v_exp_f32 v40, v40
    v_exp_f32 v41, v41
    v_smfmac_f32_32x32x32_bf16 v[80:95], v[176:179], v[32:39], v232
    ds_write_b32 v236, v232 offset:96
    v_exp_f32 v42, v42
    v_exp_f32 v43, v43
    v_exp_f32 v44, v44
    v_exp_f32 v45, v45
    v_mfma_f32_32x32x16_bf16 v[64:79], v[140:143], v[112:115], v[64:79]
    v_exp_f32 v46, v46
    v_exp_f32 v47, v47
    v_exp_f32 v48, v48
    v_exp_f32 v49, v49
    v_smfmac_f32_32x32x32_bf16 v[80:95], v[180:183], v[40:47], v232
    v_exp_f32 v50, v50
    v_exp_f32 v51, v51
    v_exp_f32 v52, v52
    v_exp_f32 v53, v53
    v_mfma_f32_32x32x4_2b_bf16 v[16:47], v[164:165], v[116:117], 0
    v_exp_f32 v54, v54
    v_exp_f32 v55, v55
    v_exp_f32 v56, v56
    v_exp_f32 v57, v57
    v_exp_f32 v58, v58
    v_exp_f32 v59, v59
    v_exp_f32 v60, v60
    v_exp_f32 v61, v61
    v_smfmac_f32_32x32x32_bf16 v[80:95], v[184:187], v[48:55], v232
    v_exp_f32 v62, v62
    v_exp_f32 v63, v63
    v_mfma_f32_32x32x8_bf16 v[96:111], v[238:239], v[238:239], 0
    v_exp_f32 v64, v64
    v_exp_f32 v65, v65
    v_smfmac_f32_32x32x32_bf16 v[80:95], v[188:191], v[56:63], v232
    v_exp_f32 v66, v66
    v_exp_f32 v67, v67
    v_exp_f32 v68, v68
    v_exp_f32 v69, v69
    v_mfma_f32_32x32x16_bf16 v[16:31], v[144:147], v[112:115], v[16:31]
    v_exp_f32 v70, v70
    v_exp_f32 v71, v71
    v_exp_f32 v72, v72
    v_exp_f32 v73, v73
    v_smfmac_f32_32x32x32_bf16 v[80:95], v[192:195], v[64:71], v232
    v_exp_f32 v74, v74
    v_exp_f32 v75, v75
    v_exp_f32 v76, v76
    v_exp_f32 v77, v77
    v_mfma_f32_32x32x16_bf16 v[32:47], v[148:151], v[112:115], v[32:47]
    v_exp_f32 v78, v78
    v_exp_f32 v79, v79
    v_exp_f32 v16, v16
    v_exp_f32 v17, v17
    v_smfmac_f32_32x32x32_bf16 v[80:95], v[196:199], v[72:79], v232
    v_exp_f32 v18, v18
    v_exp_f32 v19, v19
    v_exp_f32 v20, v20
    v_exp_f32 v21, v21
    v_mfma_f32_32x32x4_2b_bf16 v[48:79], v[166:167], v[116:117], 0
    v_exp_f32 v22, v22
    v_exp_f32 v23, v23
    v_exp_f32 v24, v24
    v_exp_f32 v25, v25
    v_exp_f32 v26, v26
    v_exp_f32 v27, v27
    v_exp_f32 v28, v28
    v_exp_f32 v29, v29
    v_smfmac_f32_32x32x32_bf16 v[80:95], v[200:203], v[16:23], v232
    v_exp_f32 v30, v30
    v_exp_f32 v31, v31
    v_exp_f32 v32, v32
    v_exp_f32 v33, v33
    v_smfmac_f32_32x32x32_bf16 v[80:95], v[204:207], v[24:31], v232
    v_exp_f32 v34, v34
    v_exp_f32 v35, v35
    v_exp_f32 v36, v36
    v_exp_f32 v37, v37
    v_mfma_f32_32x32x16_bf16 v[48:63], v[152:155], v[112:115], v[48:63]
    v_exp_f32 v38, v38
    v_exp_f32 v39, v39
    v_exp_f32 v40, v40
    v_exp_f32 v41, v41
    v_smfmac_f32_32x32x32_bf16 v[80:95], v[208:211], v[32:39], v232
    v_exp_f32 v42, v42
    v_exp_f32 v43, v43
    v_exp_f32 v44, v44
    v_exp_f32 v45, v45
    v_mfma_f32_32x32x16_bf16 v[64:79], v[156:159], v[112:115], v[64:79]
    ds_read_b128 v[112:115], v233 offset:7680
    v_exp_f32 v46, v46
    v_exp_f32 v47, v47
    v_exp_f32 v48, v48
    v_exp_f32 v49, v49
    v_smfmac_f32_32x32x32_bf16 v[80:95], v[212:215], v[40:47], v232
    v_exp_f32 v50, v50
    v_exp_f32 v51, v51
    v_exp_f32 v52, v52
    v_exp_f32 v53, v53
    v_mfma_f32_32x32x4_2b_bf16 v[16:47], v[160:161], v[118:119], 0
    v_exp_f32 v54, v54
    v_exp_f32 v55, v55
    v_exp_f32 v56, v56
    v_exp_f32 v57, v57
    v_exp_f32 v58, v58
    v_exp_f32 v59, v59
    v_exp_f32 v60, v60
    v_exp_f32 v61, v61
    v_smfmac_f32_32x32x32_bf16 v[80:95], v[216:219], v[48:55], v232
    v_exp_f32 v62, v62
    v_exp_f32 v63, v63
    v_exp_f32 v64, v64
    v_exp_f32 v65, v65
    v_smfmac_f32_32x32x32_bf16 v[80:95], v[220:223], v[56:63], v232
    s_waitcnt lgkmcnt(0)
    v_exp_f32 v66, v66
    v_exp_f32 v67, v67
    v_exp_f32 v68, v68
    v_exp_f32 v69, v69
    v_mfma_f32_32x32x16_bf16 v[16:31], v[128:131], v[112:115], v[16:31]
    v_exp_f32 v70, v70
    v_exp_f32 v71, v71
    v_exp_f32 v72, v72
    v_exp_f32 v73, v73
    v_smfmac_f32_32x32x32_bf16 v[80:95], v[224:227], v[64:71], v232
    v_exp_f32 v74, v74
    v_exp_f32 v75, v75
    v_exp_f32 v76, v76
    v_exp_f32 v77, v77
    v_mfma_f32_32x32x16_bf16 v[32:47], v[132:135], v[112:115], v[32:47]
    v_exp_f32 v78, v78
    v_exp_f32 v79, v79
    v_exp_f32 v16, v16
    v_exp_f32 v17, v17
    v_smfmac_f32_32x32x32_bf16 v[80:95], v[228:231], v[72:79], v232
    v_exp_f32 v18, v18
    v_exp_f32 v19, v19
    v_exp_f32 v20, v20
    v_exp_f32 v21, v21
    v_mfma_f32_32x32x4_2b_bf16 v[48:79], v[162:163], v[118:119], 0
    v_exp_f32 v22, v22
    v_exp_f32 v23, v23
    v_exp_f32 v24, v24
    v_exp_f32 v25, v25
    v_exp_f32 v26, v26
    v_exp_f32 v27, v27
    v_exp_f32 v28, v28
    v_exp_f32 v29, v29
    v_smfmac_f32_32x32x32_bf16 v[96:111], v[168:171], v[16:23], v232
    ds_write2st64_b64 v235, v[80:81], v[82:83] offset0:80 offset1:81
    v_exp_f32 v30, v30
    v_exp_f32 v31, v31
    v_exp_f32 v32, v32
    v_exp_f32 v33, v33
    v_smfmac_f32_32x32x32_bf16 v[96:111], v[172:175], v[24:31], v232
    ds_write2st64_b64 v235, v[84:85], v[86:87] offset0:82 offset1:83
    v_exp_f32 v34, v34
    v_exp_f32 v35, v35
    v_exp_f32 v36, v36
    v_exp_f32 v37, v37
    v_mfma_f32_32x32x16_bf16 v[48:63], v[136:139], v[112:115], v[48:63]
    ds_write_b64 v235, v[88:89] offset:43008
    v_exp_f32 v38, v38
    v_exp_f32 v39, v39
    v_exp_f32 v40, v40
    v_exp_f32 v41, v41
    v_smfmac_f32_32x32x32_bf16 v[96:111], v[176:179], v[32:39], v232
    v_exp_f32 v42, v42
    v_exp_f32 v43, v43
    v_exp_f32 v44, v44
    v_exp_f32 v45, v45
    v_mfma_f32_32x32x16_bf16 v[64:79], v[140:143], v[112:115], v[64:79]
    v_exp_f32 v46, v46
    v_exp_f32 v47, v47
    v_exp_f32 v48, v48
    v_exp_f32 v49, v49
    v_smfmac_f32_32x32x32_bf16 v[96:111], v[180:183], v[40:47], v232
    v_exp_f32 v50, v50
    v_exp_f32 v51, v51
    v_exp_f32 v52, v52
    v_exp_f32 v53, v53
    v_mfma_f32_32x32x4_2b_bf16 v[16:47], v[164:165], v[118:119], 0
    v_exp_f32 v54, v54
    v_exp_f32 v55, v55
    v_exp_f32 v56, v56
    v_exp_f32 v57, v57
    v_exp_f32 v58, v58
    v_exp_f32 v59, v59
    v_exp_f32 v60, v60
    v_exp_f32 v61, v61
    v_smfmac_f32_32x32x32_bf16 v[96:111], v[184:187], v[48:55], v232
    v_exp_f32 v62, v62
    v_exp_f32 v63, v63
    v_mfma_f32_32x32x8_bf16 v[80:95], v[238:239], v[238:239], 0
    v_exp_f32 v64, v64
    v_exp_f32 v65, v65
    v_smfmac_f32_32x32x32_bf16 v[96:111], v[188:191], v[56:63], v232
    v_exp_f32 v66, v66
    v_exp_f32 v67, v67
    v_exp_f32 v68, v68
    v_exp_f32 v69, v69
    v_mfma_f32_32x32x16_bf16 v[16:31], v[144:147], v[112:115], v[16:31]
    v_exp_f32 v70, v70
    v_exp_f32 v71, v71
    v_exp_f32 v72, v72
    v_exp_f32 v73, v73
    v_smfmac_f32_32x32x32_bf16 v[96:111], v[192:195], v[64:71], v232
    v_exp_f32 v74, v74
    v_exp_f32 v75, v75
    v_exp_f32 v76, v76
    v_exp_f32 v77, v77
    v_mfma_f32_32x32x16_bf16 v[32:47], v[148:151], v[112:115], v[32:47]
    v_exp_f32 v78, v78
    v_exp_f32 v79, v79
    v_exp_f32 v16, v16
    v_exp_f32 v17, v17
    v_smfmac_f32_32x32x32_bf16 v[96:111], v[196:199], v[72:79], v232
    v_exp_f32 v18, v18
    v_exp_f32 v19, v19
    v_exp_f32 v20, v20
    v_exp_f32 v21, v21
    v_mfma_f32_32x32x4_2b_bf16 v[48:79], v[166:167], v[118:119], 0
    v_exp_f32 v22, v22
    v_exp_f32 v23, v23
    v_exp_f32 v24, v24
    v_exp_f32 v25, v25
    v_exp_f32 v26, v26
    v_exp_f32 v27, v27
    v_exp_f32 v28, v28
    v_exp_f32 v29, v29
    v_smfmac_f32_32x32x32_bf16 v[96:111], v[200:203], v[16:23], v232
    ds_read2st64_b64 v[116:119], v234 offset0:18 offset1:21
    v_exp_f32 v30, v30
    v_exp_f32 v31, v31
    v_exp_f32 v32, v32
    v_exp_f32 v33, v33
    v_smfmac_f32_32x32x32_bf16 v[96:111], v[204:207], v[24:31], v232
    v_exp_f32 v34, v34
    v_exp_f32 v35, v35
    v_exp_f32 v36, v36
    v_exp_f32 v37, v37
    v_mfma_f32_32x32x16_bf16 v[48:63], v[152:155], v[112:115], v[48:63]
    v_exp_f32 v38, v38
    v_exp_f32 v39, v39
    v_exp_f32 v40, v40
    v_exp_f32 v41, v41
    v_smfmac_f32_32x32x32_bf16 v[96:111], v[208:211], v[32:39], v232
    v_exp_f32 v42, v42
    v_exp_f32 v43, v43
    v_exp_f32 v44, v44
    v_exp_f32 v45, v45
    v_mfma_f32_32x32x16_bf16 v[64:79], v[156:159], v[112:115], v[64:79]
    ds_read_b128 v[112:115], v233 offset:9216
    v_exp_f32 v46, v46
    v_exp_f32 v47, v47
    v_exp_f32 v48, v48
    v_exp_f32 v49, v49
    v_smfmac_f32_32x32x32_bf16 v[96:111], v[212:215], v[40:47], v232
    s_waitcnt lgkmcnt(1)
    v_exp_f32 v50, v50
    v_exp_f32 v51, v51
    v_exp_f32 v52, v52
    v_exp_f32 v53, v53
    v_mfma_f32_32x32x4_2b_bf16 v[16:47], v[160:161], v[116:117], 0
    v_exp_f32 v54, v54
    v_exp_f32 v55, v55
    v_exp_f32 v56, v56
    v_exp_f32 v57, v57
    v_exp_f32 v58, v58
    v_exp_f32 v59, v59
    v_exp_f32 v60, v60
    v_exp_f32 v61, v61
    v_smfmac_f32_32x32x32_bf16 v[96:111], v[216:219], v[48:55], v232
    v_exp_f32 v62, v62
    v_exp_f32 v63, v63
    v_exp_f32 v64, v64
    v_exp_f32 v65, v65
    v_smfmac_f32_32x32x32_bf16 v[96:111], v[220:223], v[56:63], v232
    s_waitcnt lgkmcnt(0)
    v_exp_f32 v66, v66
    v_exp_f32 v67, v67
    v_exp_f32 v68, v68
    v_exp_f32 v69, v69
    v_mfma_f32_32x32x16_bf16 v[16:31], v[128:131], v[112:115], v[16:31]
    v_exp_f32 v70, v70
    v_exp_f32 v71, v71
    v_exp_f32 v72, v72
    v_exp_f32 v73, v73
    v_smfmac_f32_32x32x32_bf16 v[96:111], v[224:227], v[64:71], v232
    v_exp_f32 v74, v74
    v_exp_f32 v75, v75
    v_exp_f32 v76, v76
    v_exp_f32 v77, v77
    v_mfma_f32_32x32x16_bf16 v[32:47], v[132:135], v[112:115], v[32:47]
    v_exp_f32 v78, v78
    v_exp_f32 v79, v79
    v_exp_f32 v16, v16
    v_exp_f32 v17, v17
    v_smfmac_f32_32x32x32_bf16 v[96:111], v[228:231], v[72:79], v232
    v_exp_f32 v18, v18
    v_exp_f32 v19, v19
    v_exp_f32 v20, v20
    v_exp_f32 v21, v21
    v_mfma_f32_32x32x4_2b_bf16 v[48:79], v[162:163], v[116:117], 0
    v_exp_f32 v22, v22
    v_exp_f32 v23, v23
    v_exp_f32 v24, v24
    v_exp_f32 v25, v25
    v_exp_f32 v26, v26
    v_exp_f32 v27, v27
    v_exp_f32 v28, v28
    v_exp_f32 v29, v29
    v_smfmac_f32_32x32x32_bf16 v[80:95], v[168:171], v[16:23], v232
    ds_write2st64_b64 v235, v[96:97], v[98:99] offset0:100 offset1:101
    v_exp_f32 v30, v30
    v_exp_f32 v31, v31
    v_exp_f32 v32, v32
    v_exp_f32 v33, v33
    v_smfmac_f32_32x32x32_bf16 v[80:95], v[172:175], v[24:31], v232
    ds_write2st64_b64 v235, v[100:101], v[102:103] offset0:102 offset1:103
    v_exp_f32 v34, v34
    v_exp_f32 v35, v35
    v_exp_f32 v36, v36
    v_exp_f32 v37, v37
    v_mfma_f32_32x32x16_bf16 v[48:63], v[136:139], v[112:115], v[48:63]
    ds_write_b64 v235, v[104:105] offset:53248
    v_exp_f32 v38, v38
    v_exp_f32 v39, v39
    v_exp_f32 v40, v40
    v_exp_f32 v41, v41
    v_smfmac_f32_32x32x32_bf16 v[80:95], v[176:179], v[32:39], v232
    ds_write_b32 v236, v232 offset:160
    v_exp_f32 v42, v42
    v_exp_f32 v43, v43
    v_exp_f32 v44, v44
    v_exp_f32 v45, v45
    v_mfma_f32_32x32x16_bf16 v[64:79], v[140:143], v[112:115], v[64:79]
    v_exp_f32 v46, v46
    v_exp_f32 v47, v47
    v_exp_f32 v48, v48
    v_exp_f32 v49, v49
    v_smfmac_f32_32x32x32_bf16 v[80:95], v[180:183], v[40:47], v232
    v_exp_f32 v50, v50
    v_exp_f32 v51, v51
    v_exp_f32 v52, v52
    v_exp_f32 v53, v53
    v_mfma_f32_32x32x4_2b_bf16 v[16:47], v[164:165], v[116:117], 0
    v_exp_f32 v54, v54
    v_exp_f32 v55, v55
    v_exp_f32 v56, v56
    v_exp_f32 v57, v57
    v_exp_f32 v58, v58
    v_exp_f32 v59, v59
    v_exp_f32 v60, v60
    v_exp_f32 v61, v61
    v_smfmac_f32_32x32x32_bf16 v[80:95], v[184:187], v[48:55], v232
    v_exp_f32 v62, v62
    v_exp_f32 v63, v63
    v_mfma_f32_32x32x8_bf16 v[96:111], v[238:239], v[238:239], 0
    v_exp_f32 v64, v64
    v_exp_f32 v65, v65
    v_smfmac_f32_32x32x32_bf16 v[80:95], v[188:191], v[56:63], v232
    v_exp_f32 v66, v66
    v_exp_f32 v67, v67
    v_exp_f32 v68, v68
    v_exp_f32 v69, v69
    v_mfma_f32_32x32x16_bf16 v[16:31], v[144:147], v[112:115], v[16:31]
    v_exp_f32 v70, v70
    v_exp_f32 v71, v71
    v_exp_f32 v72, v72
    v_exp_f32 v73, v73
    v_smfmac_f32_32x32x32_bf16 v[80:95], v[192:195], v[64:71], v232
    v_exp_f32 v74, v74
    v_exp_f32 v75, v75
    v_exp_f32 v76, v76
    v_exp_f32 v77, v77
    v_mfma_f32_32x32x16_bf16 v[32:47], v[148:151], v[112:115], v[32:47]
    v_exp_f32 v78, v78
    v_exp_f32 v79, v79
    v_exp_f32 v16, v16
    v_exp_f32 v17, v17
    v_smfmac_f32_32x32x32_bf16 v[80:95], v[196:199], v[72:79], v232
    v_exp_f32 v18, v18
    v_exp_f32 v19, v19
    v_exp_f32 v20, v20
    v_exp_f32 v21, v21
    v_mfma_f32_32x32x4_2b_bf16 v[48:79], v[166:167], v[116:117], 0
    v_exp_f32 v22, v22
    v_exp_f32 v23, v23
    v_exp_f32 v24, v24
    v_exp_f32 v25, v25
    v_exp_f32 v26, v26
    v_exp_f32 v27, v27
    v_exp_f32 v28, v28
    v_exp_f32 v29, v29
    v_smfmac_f32_32x32x32_bf16 v[80:95], v[200:203], v[16:23], v232
    v_exp_f32 v30, v30
    v_exp_f32 v31, v31
    v_exp_f32 v32, v32
    v_exp_f32 v33, v33
    v_smfmac_f32_32x32x32_bf16 v[80:95], v[204:207], v[24:31], v232
    v_exp_f32 v34, v34
    v_exp_f32 v35, v35
    v_exp_f32 v36, v36
    v_exp_f32 v37, v37
    v_mfma_f32_32x32x16_bf16 v[48:63], v[152:155], v[112:115], v[48:63]
    v_exp_f32 v38, v38
    v_exp_f32 v39, v39
    v_exp_f32 v40, v40
    v_exp_f32 v41, v41
    v_smfmac_f32_32x32x32_bf16 v[80:95], v[208:211], v[32:39], v232
    v_exp_f32 v42, v42
    v_exp_f32 v43, v43
    v_exp_f32 v44, v44
    v_exp_f32 v45, v45
    v_mfma_f32_32x32x16_bf16 v[64:79], v[156:159], v[112:115], v[64:79]
    ds_read_b128 v[112:115], v233 offset:10752
    v_exp_f32 v46, v46
    v_exp_f32 v47, v47
    v_exp_f32 v48, v48
    v_exp_f32 v49, v49
    v_smfmac_f32_32x32x32_bf16 v[80:95], v[212:215], v[40:47], v232
    v_exp_f32 v50, v50
    v_exp_f32 v51, v51
    v_exp_f32 v52, v52
    v_exp_f32 v53, v53
    v_mfma_f32_32x32x4_2b_bf16 v[16:47], v[160:161], v[118:119], 0
    v_exp_f32 v54, v54
    v_exp_f32 v55, v55
    v_exp_f32 v56, v56
    v_exp_f32 v57, v57
    v_exp_f32 v58, v58
    v_exp_f32 v59, v59
    v_exp_f32 v60, v60
    v_exp_f32 v61, v61
    v_smfmac_f32_32x32x32_bf16 v[80:95], v[216:219], v[48:55], v232
    v_exp_f32 v62, v62
    v_exp_f32 v63, v63
    v_exp_f32 v64, v64
    v_exp_f32 v65, v65
    v_smfmac_f32_32x32x32_bf16 v[80:95], v[220:223], v[56:63], v232
    s_waitcnt lgkmcnt(0)
    v_exp_f32 v66, v66
    v_exp_f32 v67, v67
    v_exp_f32 v68, v68
    v_exp_f32 v69, v69
    v_mfma_f32_32x32x16_bf16 v[16:31], v[128:131], v[112:115], v[16:31]
    v_exp_f32 v70, v70
    v_exp_f32 v71, v71
    v_exp_f32 v72, v72
    v_exp_f32 v73, v73
    v_smfmac_f32_32x32x32_bf16 v[80:95], v[224:227], v[64:71], v232
    v_exp_f32 v74, v74
    v_exp_f32 v75, v75
    v_exp_f32 v76, v76
    v_exp_f32 v77, v77
    v_mfma_f32_32x32x16_bf16 v[32:47], v[132:135], v[112:115], v[32:47]
    v_exp_f32 v78, v78
    v_exp_f32 v79, v79
    v_exp_f32 v16, v16
    v_exp_f32 v17, v17
    v_smfmac_f32_32x32x32_bf16 v[80:95], v[228:231], v[72:79], v232
    v_exp_f32 v18, v18
    v_exp_f32 v19, v19
    v_exp_f32 v20, v20
    v_exp_f32 v21, v21
    v_mfma_f32_32x32x4_2b_bf16 v[48:79], v[162:163], v[118:119], 0
    v_exp_f32 v22, v22
    v_exp_f32 v23, v23
    v_exp_f32 v24, v24
    v_exp_f32 v25, v25
    v_exp_f32 v26, v26
    v_exp_f32 v27, v27
    v_exp_f32 v28, v28
    v_exp_f32 v29, v29
    v_smfmac_f32_32x32x32_bf16 v[96:111], v[168:171], v[16:23], v232
    ds_write2st64_b64 v235, v[80:81], v[82:83] offset0:120 offset1:121
    v_exp_f32 v30, v30
    v_exp_f32 v31, v31
    v_exp_f32 v32, v32
    v_exp_f32 v33, v33
    v_smfmac_f32_32x32x32_bf16 v[96:111], v[172:175], v[24:31], v232
    ds_write2st64_b64 v235, v[84:85], v[86:87] offset0:122 offset1:123
    v_exp_f32 v34, v34
    v_exp_f32 v35, v35
    v_exp_f32 v36, v36
    v_exp_f32 v37, v37
    v_mfma_f32_32x32x16_bf16 v[48:63], v[136:139], v[112:115], v[48:63]
    ds_write_b64 v235, v[88:89] offset:63488
    v_exp_f32 v38, v38
    v_exp_f32 v39, v39
    v_exp_f32 v40, v40
    v_exp_f32 v41, v41
    v_smfmac_f32_32x32x32_bf16 v[96:111], v[176:179], v[32:39], v232
    v_exp_f32 v42, v42
    v_exp_f32 v43, v43
    v_exp_f32 v44, v44
    v_exp_f32 v45, v45
    v_mfma_f32_32x32x16_bf16 v[64:79], v[140:143], v[112:115], v[64:79]
    v_exp_f32 v46, v46
    v_exp_f32 v47, v47
    v_exp_f32 v48, v48
    v_exp_f32 v49, v49
    v_smfmac_f32_32x32x32_bf16 v[96:111], v[180:183], v[40:47], v232
    v_exp_f32 v50, v50
    v_exp_f32 v51, v51
    v_exp_f32 v52, v52
    v_exp_f32 v53, v53
    v_mfma_f32_32x32x4_2b_bf16 v[16:47], v[164:165], v[118:119], 0
    v_exp_f32 v54, v54
    v_exp_f32 v55, v55
    v_exp_f32 v56, v56
    v_exp_f32 v57, v57
    v_exp_f32 v58, v58
    v_exp_f32 v59, v59
    v_exp_f32 v60, v60
    v_exp_f32 v61, v61
    v_smfmac_f32_32x32x32_bf16 v[96:111], v[184:187], v[48:55], v232
    v_exp_f32 v62, v62
    v_exp_f32 v63, v63
    v_exp_f32 v64, v64
    v_exp_f32 v65, v65
    v_smfmac_f32_32x32x32_bf16 v[96:111], v[188:191], v[56:63], v232
    v_exp_f32 v66, v66
    v_exp_f32 v67, v67
    v_exp_f32 v68, v68
    v_exp_f32 v69, v69
    v_mfma_f32_32x32x16_bf16 v[16:31], v[144:147], v[112:115], v[16:31]
    v_exp_f32 v70, v70
    v_exp_f32 v71, v71
    v_exp_f32 v72, v72
    v_exp_f32 v73, v73
    v_smfmac_f32_32x32x32_bf16 v[96:111], v[192:195], v[64:71], v232
    v_exp_f32 v74, v74
    v_exp_f32 v75, v75
    v_exp_f32 v76, v76
    v_exp_f32 v77, v77
    v_mfma_f32_32x32x16_bf16 v[32:47], v[148:151], v[112:115], v[32:47]
    v_exp_f32 v78, v78
    v_exp_f32 v79, v79
    v_exp_f32 v16, v16
    v_exp_f32 v17, v17
    v_smfmac_f32_32x32x32_bf16 v[96:111], v[196:199], v[72:79], v232
    v_exp_f32 v18, v18
    v_exp_f32 v19, v19
    v_exp_f32 v20, v20
    v_exp_f32 v21, v21
    v_mfma_f32_32x32x4_2b_bf16 v[48:79], v[166:167], v[118:119], 0
    v_exp_f32 v22, v22
    v_exp_f32 v23, v23
    v_exp_f32 v24, v24
    v_exp_f32 v25, v25
    v_exp_f32 v26, v26
    v_exp_f32 v27, v27
    v_exp_f32 v28, v28
    v_exp_f32 v29, v29
    v_smfmac_f32_32x32x32_bf16 v[96:111], v[200:203], v[16:23], v232
    v_exp_f32 v30, v30
    v_exp_f32 v31, v31
    v_exp_f32 v32, v32
    v_exp_f32 v33, v33
    v_smfmac_f32_32x32x32_bf16 v[96:111], v[204:207], v[24:31], v232
    v_exp_f32 v34, v34
    v_exp_f32 v35, v35
    v_exp_f32 v36, v36
    v_exp_f32 v37, v37
    v_mfma_f32_32x32x16_bf16 v[48:63], v[152:155], v[112:115], v[48:63]
    v_exp_f32 v38, v38
    v_exp_f32 v39, v39
    v_exp_f32 v40, v40
    v_exp_f32 v41, v41
    v_smfmac_f32_32x32x32_bf16 v[96:111], v[208:211], v[32:39], v232
    v_exp_f32 v42, v42
    v_exp_f32 v43, v43
    v_exp_f32 v44, v44
    v_exp_f32 v45, v45
    v_mfma_f32_32x32x16_bf16 v[64:79], v[156:159], v[112:115], v[64:79]
    v_exp_f32 v46, v46
    v_exp_f32 v47, v47
    v_exp_f32 v48, v48
    v_exp_f32 v49, v49
    v_smfmac_f32_32x32x32_bf16 v[96:111], v[212:215], v[40:47], v232
    v_exp_f32 v50, v50
    v_exp_f32 v51, v51
    v_exp_f32 v52, v52
    v_exp_f32 v53, v53
    v_exp_f32 v54, v54
    v_exp_f32 v55, v55
    v_exp_f32 v56, v56
    v_exp_f32 v57, v57
    v_exp_f32 v58, v58
    v_exp_f32 v59, v59
    v_exp_f32 v60, v60
    v_exp_f32 v61, v61
    v_smfmac_f32_32x32x32_bf16 v[96:111], v[216:219], v[48:55], v232
    v_exp_f32 v62, v62
    v_exp_f32 v63, v63
    v_exp_f32 v64, v64
    v_exp_f32 v65, v65
    v_smfmac_f32_32x32x32_bf16 v[96:111], v[220:223], v[56:63], v232
    v_exp_f32 v66, v66
    v_exp_f32 v67, v67
    v_exp_f32 v68, v68
    v_exp_f32 v69, v69
    v_exp_f32 v70, v70
    v_exp_f32 v71, v71
    v_exp_f32 v72, v72
    v_exp_f32 v73, v73
    v_smfmac_f32_32x32x32_bf16 v[96:111], v[224:227], v[64:71], v232
    v_exp_f32 v74, v74
    v_exp_f32 v75, v75
    v_exp_f32 v76, v76
    v_exp_f32 v77, v77
    v_exp_f32 v78, v78
    v_exp_f32 v79, v79
    s_nop 1
    v_smfmac_f32_32x32x32_bf16 v[96:111], v[228:231], v[72:79], v232
    s_nop 11
    ds_write2st64_b64 v235, v[96:97], v[98:99] offset0:140 offset1:141
    ds_write2st64_b64 v235, v[100:101], v[102:103] offset0:142 offset1:143
    ds_write2st64_b64 v235, v[104:105], v[104:105] offset0:144 offset1:144
    ds_write_b32 v236, v232 offset:224
    s_branch L_lead
L_afol:
    s_mov_b32 s75, 7
    s_lshl_b32 s12, s5, 3
    s_add_u32 s13, s12, s75
    s_add_u32 s12, s12, s4
    s_mul_i32 s72, s12, 36864
    s_add_u32 s72, s72, 3164160
    s_mul_i32 s13, s13, 36864
    s_add_u32 s13, s13, 3164160
    s_lshl_b32 s74, s8, 7
    s_add_u32 s74, s74, s13
    s_add_u32 s74, s74, 16384
    s_lshl_b32 s73, s8, 10
    s_add_u32 s73, s73, s13
    s_mul_i32 s76, s12, 18432
    s_min_u32 s14, s24, 8
    s_lshl_b32 s14, s14, 4
    s_lshl_b32 s13, s24, 6
    s_add_u32 s13, s13, s14
    s_add_u32 s76, s76, s13
    s_mul_i32 s12, s75, 10240
    s_add_u32 s12, s12, 79872
    v_lshl_add_u32 v242, v1, 3, s12
    s_lshl_b32 s13, s75, 5
    s_add_u32 s13, s13, 162320
    v_and_b32 v243, 3, v1
    v_lshl_add_u32 v243, v243, 2, s13
    s_lshl_b32 s13, s75, 6
    s_add_u32 s13, s13, 74240
    v_add_u32 v255, s13, v254
    ds_read_b32 v255, v255
    s_mul_i32 s13, s10, 3072
    s_add_u32 s13, s13, 49152
    v_add_u32 v241, s13, v253
    s_mov_b32 s3, 262144
L_kcf0:
    s_waitcnt vmcnt(0)
    v_max3_u32 v125, v160, v131, v135
    v_max3_u32 v125, v125, v171, v175
    v_max3_u32 v125, v125, v179, v183
    v_max3_u32 v125, v125, v162, v139
    v_max3_u32 v125, v125, v143, v187
    v_max3_u32 v125, v125, v191, v195
    v_max3_u32 v125, v125, v199, v164
    v_max3_u32 v125, v125, v147, v151
    v_max3_u32 v125, v125, v203, v207
    v_max3_u32 v125, v125, v211, v215
    v_max3_u32 v125, v125, v166, v155
    v_max3_u32 v125, v125, v159, v219
    v_max3_u32 v125, v125, v223, v227
    v_max3_u32 v125, v125, v231, v160
    v_cmp_eq_u32 vcc, -1, v125
    s_cbranch_vccnz L_krf0
L_kgf0:
    s_cmp_eq_u32 s42, 0
    s_cbranch_scc1 L_wp47
    s_mov_b64 exec, 1
    v_mov_b32 v2, s42
    v_mov_b32 v3, s9
    s_waitcnt vmcnt(0)
    buffer_store_dword v3, v2, s[60:63], 0 offen sc1
    s_mov_b64 exec, -1
L_wp47:
    s_mov_b32 s77, 0
    s_cmp_eq_u32 s7, 0
    s_cbranch_scc1 L_oafast
    v_mov_b32 v2, 162064
    s_mov_b32 s82, 262144
L_ls48:
    ds_read_b32 v3, v2
    s_waitcnt lgkmcnt(0)
    v_readfirstlane_b32 s12, v3
    s_nop 0
    s_cmp_ge_u32 s12, 12
    s_cbranch_scc1 L_lo49
    s_sleep 1
    s_sub_u32 s82, s82, 1
    s_cbranch_scc0 L_ls48
L_lo49:
    ds_read_b128 v[96:99], v6 offset:0
    ds_read_b128 v[100:103], v6 offset:32
    ds_read_b128 v[104:107], v6 offset:64
    v_lshlrev_b32 v16, 5, v1
    s_lshl_b32 s13, s6, 11
    s_add_u32 s13, s13, 16384
    s_mov_b32 s82, 262144
L_pl50:
    buffer_load_dword v17, v16, s[60:63], s13 offen sc1
    s_waitcnt vmcnt(0)
    v_cmp_ne_u32 vcc, s9, v17
    s_nop 0
    s_cmp_eq_u64 vcc, 0
    s_cbranch_scc1 L_po51
    s_sleep 8
    s_sub_u32 s82, s82, 1
    s_cbranch_scc0 L_pl50
L_po51:
    s_lshl_b32 s12, s10, 2
    s_add_u32 s12, s12, 162464
    v_mov_b32 v16, s12
    v_min_u32 v19, 19, v1
    v_lshlrev_b32 v19, 9, v19
    s_mov_b32 s82, 262144
L_ot52:
    buffer_load_dword v17, v19, s[60:63], s68 offen sc1
    ds_read_b32 v18, v16
    s_waitcnt vmcnt(0) lgkmcnt(0)
    v_cmp_eq_u32 vcc, -1, v17
    s_cbranch_vccz L_og53
    v_readfirstlane_b32 s12, v18
    s_nop 0
    s_cmp_lg_u32 s12, 0
    s_cbranch_scc1 L_oaskip
    s_sleep 4
    s_sub_u32 s82, s82, 1
    s_cbranch_scc0 L_ot52
L_og53:
    s_add_u32 s13, s68, 2560
    s_add_u32 s14, s68, 5120
    s_add_u32 s12, s68, 7680
    buffer_load_dwordx4 v[16:19], v4, s[60:63], s68 offen offset:0 sc1
    buffer_load_dwordx4 v[20:23], v4, s[60:63], s68 offen offset:1024 sc1
    buffer_load_dwordx4 v[24:27], v15, s[60:63], s68 offen offset:2048 sc1
    buffer_load_dwordx4 v[28:31], v14, s[60:63], s13 offen offset:0 sc1
    buffer_load_dwordx4 v[32:35], v14, s[60:63], s13 offen offset:1024 sc1
    buffer_load_dwordx4 v[36:39], v11, s[60:63], s13 offen offset:2048 sc1
    buffer_load_dwordx4 v[40:43], v4, s[60:63], s14 offen offset:0 sc1
    buffer_load_dwordx4 v[44:47], v4, s[60:63], s14 offen offset:1024 sc1
    buffer_load_dwordx4 v[48:51], v15, s[60:63], s14 offen offset:2048 sc1
    buffer_load_dwordx4 v[52:55], v14, s[60:63], s12 offen offset:0 sc1
    buffer_load_dwordx4 v[56:59], v14, s[60:63], s12 offen offset:1024 sc1
    buffer_load_dwordx4 v[60:63], v11, s[60:63], s12 offen offset:2048 sc1
    s_lshl_b32 s12, s10, 2
    s_add_u32 s12, s12, 162096
    v_mov_b32 v2, s12
    v_mov_b32 v3, 1
    s_mov_b64 exec, 1
    ds_add_rtn_u32 v3, v2, v3
    s_mov_b64 exec, -1
    s_waitcnt lgkmcnt(0)
    v_readfirstlane_b32 s12, v3
    s_nop 0
    s_cmp_lg_u32 s12, 0
    s_cbranch_scc1 L_oaskip
L_oajob:
    s_mov_b32 s15, 262144
L_oack:
    s_waitcnt vmcnt(0)
    v_max3_u32 v13, v19, v23, v19
    v_max3_u32 v13, v27, v31, v13
    v_max3_u32 v13, v35, v39, v13
    v_max3_u32 v13, v43, v47, v13
    v_max3_u32 v13, v51, v55, v13
    v_max3_u32 v13, v59, v63, v13
    v_cmp_eq_u32 vcc, -1, v13
    s_cbranch_vccz L_oago
    s_sub_u32 s15, s15, 1
    s_cbranch_scc1 L_oago
    s_add_u32 s13, s68, 2560
    s_add_u32 s14, s68, 5120
    s_add_u32 s12, s68, 7680
    buffer_load_dwordx4 v[16:19], v4, s[60:63], s68 offen offset:0 sc1
    buffer_load_dwordx4 v[20:23], v4, s[60:63], s68 offen offset:1024 sc1
    buffer_load_dwordx4 v[24:27], v15, s[60:63], s68 offen offset:2048 sc1
    buffer_load_dwordx4 v[28:31], v14, s[60:63], s13 offen offset:0 sc1
    buffer_load_dwordx4 v[32:35], v14, s[60:63], s13 offen offset:1024 sc1
    buffer_load_dwordx4 v[36:39], v11, s[60:63], s13 offen offset:2048 sc1
    buffer_load_dwordx4 v[40:43], v4, s[60:63], s14 offen offset:0 sc1
    buffer_load_dwordx4 v[44:47], v4, s[60:63], s14 offen offset:1024 sc1
    buffer_load_dwordx4 v[48:51], v15, s[60:63], s14 offen offset:2048 sc1
    buffer_load_dwordx4 v[52:55], v14, s[60:63], s12 offen offset:0 sc1
    buffer_load_dwordx4 v[56:59], v14, s[60:63], s12 offen offset:1024 sc1
    buffer_load_dwordx4 v[60:63], v11, s[60:63], s12 offen offset:2048 sc1
    s_branch L_oack
L_oago:
    s_waitcnt lgkmcnt(0)
    v_mfma_f32_32x32x16_bf16 v[64:79], v[16:19], v[96:99], 0
    v_mfma_f32_32x32x16_bf16 v[64:79], v[20:23], v[100:103], v[64:79]
    v_mfma_f32_32x32x16_bf16 v[64:79], v[24:27], v[104:107], v[64:79]
    ds_read_b128 v[96:99], v6 offset:10240
    ds_read_b128 v[100:103], v6 offset:10272
    ds_read_b128 v[104:107], v6 offset:10304
    s_waitcnt lgkmcnt(0)
    v_mfma_f32_32x32x16_bf16 v[80:95], v[28:31], v[96:99], 0
    v_mfma_f32_32x32x16_bf16 v[80:95], v[32:35], v[100:103], v[80:95]
    v_mfma_f32_32x32x16_bf16 v[80:95], v[36:39], v[104:107], v[80:95]
    ds_read_b128 v[96:99], v6 offset:20480
    ds_read_b128 v[100:103], v6 offset:20512
    ds_read_b128 v[104:107], v6 offset:20544
    s_nop 1
    v_add_f32 v12, 0x358637bd, v74
    v_rcp_f32 v12, v12
    s_nop 0
    v_mul_f32 v12, v12, v8
    v_mul_f32 v64, v12, v64
    v_mul_f32 v65, v12, v65
    v_mul_f32 v66, v12, v66
    v_mul_f32 v67, v12, v67
    v_mul_f32 v68, v12, v68
    v_mul_f32 v69, v12, v69
    v_mul_f32 v70, v12, v70
    v_mul_f32 v71, v12, v71
    v_mul_f32 v72, v12, v72
    v_mul_f32 v73, v12, v73
    v_cvt_pk_bf16_f32 v16, v64, v65
    v_cvt_pk_bf16_f32 v17, v66, v67
    v_cvt_pk_bf16_f32 v18, v68, v69
    v_cvt_pk_bf16_f32 v19, v70, v71
    v_cvt_pk_bf16_f32 v108, v72, v73
    buffer_store_dwordx4 v[16:19], v10, s[60:63], s69 offen offset:0 sc1
    s_waitcnt lgkmcnt(0)
    v_mfma_f32_32x32x16_bf16 v[64:79], v[40:43], v[96:99], 0
    v_mfma_f32_32x32x16_bf16 v[64:79], v[44:47], v[100:103], v[64:79]
    v_mfma_f32_32x32x16_bf16 v[64:79], v[48:51], v[104:107], v[64:79]
    ds_read_b128 v[96:99], v6 offset:30720
    ds_read_b128 v[100:103], v6 offset:30752
    ds_read_b128 v[104:107], v6 offset:30784
    v_add_f32 v12, 0x358637bd, v90
    v_rcp_f32 v12, v12
    s_nop 0
    v_mul_f32 v12, v12, v8
    v_mul_f32 v80, v12, v80
    v_mul_f32 v81, v12, v81
    v_mul_f32 v82, v12, v82
    v_mul_f32 v83, v12, v83
    v_mul_f32 v84, v12, v84
    v_mul_f32 v85, v12, v85
    v_mul_f32 v86, v12, v86
    v_mul_f32 v87, v12, v87
    v_mul_f32 v88, v12, v88
    v_mul_f32 v89, v12, v89
    v_cvt_pk_bf16_f32 v28, v80, v81
    v_cvt_pk_bf16_f32 v29, v82, v83
    v_cvt_pk_bf16_f32 v30, v84, v85
    v_cvt_pk_bf16_f32 v31, v86, v87
    v_cvt_pk_bf16_f32 v109, v88, v89
    buffer_store_dwordx4 v[28:31], v10, s[60:63], s69 offen offset:512 sc1
    s_waitcnt lgkmcnt(0)
    v_mfma_f32_32x32x16_bf16 v[80:95], v[52:55], v[96:99], 0
    v_mfma_f32_32x32x16_bf16 v[80:95], v[56:59], v[100:103], v[80:95]
    v_mfma_f32_32x32x16_bf16 v[80:95], v[60:63], v[104:107], v[80:95]
    v_mov_b32 v2, 162052
    v_mov_b32 v3, 1
    s_mov_b64 exec, 1
    ds_add_u32 v2, v3
    s_mov_b64 exec, -1
    v_add_f32 v12, 0x358637bd, v74
    v_rcp_f32 v12, v12
    s_nop 0
    v_mul_f32 v12, v12, v8
    v_mul_f32 v64, v12, v64
    v_mul_f32 v65, v12, v65
    v_mul_f32 v66, v12, v66
    v_mul_f32 v67, v12, v67
    v_mul_f32 v68, v12, v68
    v_mul_f32 v69, v12, v69
    v_mul_f32 v70, v12, v70
    v_mul_f32 v71, v12, v71
    v_mul_f32 v72, v12, v72
    v_mul_f32 v73, v12, v73
    v_cvt_pk_bf16_f32 v40, v64, v65
    v_cvt_pk_bf16_f32 v41, v66, v67
    v_cvt_pk_bf16_f32 v42, v68, v69
    v_cvt_pk_bf16_f32 v43, v70, v71
    v_cvt_pk_bf16_f32 v110, v72, v73
    buffer_store_dwordx4 v[40:43], v10, s[60:63], s69 offen offset:1024 sc1
    v_add_f32 v12, 0x358637bd, v90
    v_rcp_f32 v12, v12
    s_nop 0
    v_mul_f32 v12, v12, v8
    v_mul_f32 v80, v12, v80
    v_mul_f32 v81, v12, v81
    v_mul_f32 v82, v12, v82
    v_mul_f32 v83, v12, v83
    v_mul_f32 v84, v12, v84
    v_mul_f32 v85, v12, v85
    v_mul_f32 v86, v12, v86
    v_mul_f32 v87, v12, v87
    v_mul_f32 v88, v12, v88
    v_mul_f32 v89, v12, v89
    v_cvt_pk_bf16_f32 v52, v80, v81
    v_cvt_pk_bf16_f32 v53, v82, v83
    v_cvt_pk_bf16_f32 v54, v84, v85
    v_cvt_pk_bf16_f32 v55, v86, v87
    v_cvt_pk_bf16_f32 v111, v88, v89
    buffer_store_dwordx4 v[52:55], v10, s[60:63], s69 offen offset:1536 sc1
    s_mov_b32 exec_hi, 0
    buffer_store_dwordx4 v[108:111], v9, s[60:63], s70 offen sc1
    s_mov_b64 exec, -1
    s_cmp_eq_u32 s11, 0
    s_cbranch_scc1 L_oapost
    ds_read_b32 v18, v236 offset:224
    s_mov_b32 s77, 1
    s_waitcnt lgkmcnt(0)
    v_readfirstlane_b32 s12, v18
    s_nop 0
    s_cmp_lg_u32 s12, 0
    s_cbranch_scc1 L_oafast
    s_mov_b32 s77, 0
L_oapost:
    v_mov_b32 v2, 162076
    v_mov_b32 v3, 1
    v_mov_b32 v5, s71
    v_mov_b32 v4, s9
    s_mov_b64 exec, 1
    s_waitcnt vmcnt(0)
    ds_add_rtn_u32 v3, v2, v3
    s_waitcnt lgkmcnt(0)
    v_readfirstlane_b32 s12, v3
    s_nop 0
    s_cmp_lg_u32 s12, 3
    s_cbranch_scc1 L_nf54
    buffer_store_dword v4, v5, s[60:63], 0 offen sc1
L_nf54:
    s_mov_b64 exec, -1
    s_cmp_eq_u32 s11, 0
    s_cbranch_scc1 L_oadone
L_oaskip:
    s_waitcnt vmcnt(0)
L_oafast:
    s_mov_b32 s82, 262144
L_aw55:
    ds_read_b32 v125, v236 offset:96
    s_waitcnt lgkmcnt(0)
    v_readfirstlane_b32 s12, v125
    s_nop 0
    s_cmp_lg_u32 s12, 0
    s_cbranch_scc1 L_ak56
    s_sleep 8
    s_sub_u32 s82, s82, 1
    s_cbranch_scc0 L_aw55
L_ak56:
    ds_read2st64_b64 v[80:83], v235 offset0:0 offset1:1
    ds_read2st64_b64 v[84:87], v235 offset0:2 offset1:3
    ds_read2st64_b64 v[88:91], v235 offset0:4 offset1:4
    s_setprio 0
    s_waitcnt lgkmcnt(0)
    v_mfma_f32_32x32x4_2b_bf16 v[16:47], v[160:161], v[116:117], 0
    s_nop 15
    s_nop 1
    v_mfma_f32_32x32x16_bf16 v[16:31], v[128:131], v[112:115], v[16:31]
    v_mfma_f32_32x32x16_bf16 v[32:47], v[132:135], v[112:115], v[32:47]
    s_nop 11
    v_exp_f32 v16, v16
    v_exp_f32 v17, v17
    v_exp_f32 v18, v18
    v_exp_f32 v19, v19
    v_exp_f32 v20, v20
    v_exp_f32 v21, v21
    v_mfma_f32_32x32x4_2b_bf16 v[48:79], v[162:163], v[116:117], 0
    v_exp_f32 v22, v22
    v_exp_f32 v23, v23
    v_exp_f32 v24, v24
    v_exp_f32 v25, v25
    v_exp_f32 v26, v26
    v_exp_f32 v27, v27
    v_exp_f32 v28, v28
    v_exp_f32 v29, v29
    v_smfmac_f32_32x32x32_bf16 v[80:95], v[168:171], v[16:23], v232
    v_exp_f32 v30, v30
    v_exp_f32 v31, v31
    v_exp_f32 v32, v32
    v_exp_f32 v33, v33
    v_smfmac_f32_32x32x32_bf16 v[80:95], v[172:175], v[24:31], v232
    v_exp_f32 v34, v34
    v_exp_f32 v35, v35
    v_exp_f32 v36, v36
    v_exp_f32 v37, v37
    v_mfma_f32_32x32x16_bf16 v[48:63], v[136:139], v[112:115], v[48:63]
    v_exp_f32 v38, v38
    v_exp_f32 v39, v39
    v_exp_f32 v40, v40
    v_exp_f32 v41, v41
    v_smfmac_f32_32x32x32_bf16 v[80:95], v[176:179], v[32:39], v232
    v_exp_f32 v42, v42
    v_exp_f32 v43, v43
    v_exp_f32 v44, v44
    v_exp_f32 v45, v45
    v_mfma_f32_32x32x16_bf16 v[64:79], v[140:143], v[112:115], v[64:79]
    v_exp_f32 v46, v46
    v_exp_f32 v47, v47
    v_exp_f32 v48, v48
    v_exp_f32 v49, v49
    v_smfmac_f32_32x32x32_bf16 v[80:95], v[180:183], v[40:47], v232
    v_exp_f32 v50, v50
    v_exp_f32 v51, v51
    v_exp_f32 v52, v52
    v_exp_f32 v53, v53
    v_mfma_f32_32x32x4_2b_bf16 v[16:47], v[164:165], v[116:117], 0
    v_exp_f32 v54, v54
    v_exp_f32 v55, v55
    v_exp_f32 v56, v56
    v_exp_f32 v57, v57
    v_exp_f32 v58, v58
    v_exp_f32 v59, v59
    v_exp_f32 v60, v60
    v_exp_f32 v61, v61
    v_smfmac_f32_32x32x32_bf16 v[80:95], v[184:187], v[48:55], v232
    v_exp_f32 v62, v62
    v_exp_f32 v63, v63
    v_exp_f32 v64, v64
    v_exp_f32 v65, v65
    v_smfmac_f32_32x32x32_bf16 v[80:95], v[188:191], v[56:63], v232
    v_exp_f32 v66, v66
    v_exp_f32 v67, v67
    v_exp_f32 v68, v68
    v_exp_f32 v69, v69
    v_mfma_f32_32x32x16_bf16 v[16:31], v[144:147], v[112:115], v[16:31]
    v_exp_f32 v70, v70
    v_exp_f32 v71, v71
    v_exp_f32 v72, v72
    v_exp_f32 v73, v73
    v_smfmac_f32_32x32x32_bf16 v[80:95], v[192:195], v[64:71], v232
    s_cmp_eq_u32 s77, 1
    v_exp_f32 v74, v74
    v_exp_f32 v75, v75
    v_exp_f32 v76, v76
    v_exp_f32 v77, v77
    v_mfma_f32_32x32x16_bf16 v[32:47], v[148:151], v[112:115], v[32:47]
    s_cbranch_scc1 L_oalate
L_oaback:
    v_exp_f32 v78, v78
    v_exp_f32 v79, v79
    v_exp_f32 v16, v16
    v_exp_f32 v17, v17
    v_smfmac_f32_32x32x32_bf16 v[80:95], v[196:199], v[72:79], v232
    v_exp_f32 v18, v18
    v_exp_f32 v19, v19
    v_exp_f32 v20, v20
    v_exp_f32 v21, v21
    v_mfma_f32_32x32x4_2b_bf16 v[48:79], v[166:167], v[116:117], 0
    v_exp_f32 v22, v22
    v_exp_f32 v23, v23
    v_exp_f32 v24, v24
    v_exp_f32 v25, v25
    v_exp_f32 v26, v26
    v_exp_f32 v27, v27
    v_exp_f32 v28, v28
    v_exp_f32 v29, v29
    v_smfmac_f32_32x32x32_bf16 v[80:95], v[200:203], v[16:23], v232
    v_exp_f32 v30, v30
    v_exp_f32 v31, v31
    v_exp_f32 v32, v32
    v_exp_f32 v33, v33
    v_smfmac_f32_32x32x32_bf16 v[80:95], v[204:207], v[24:31], v232
    ds_read2st64_b64 v[96:99], v235 offset0:20 offset1:21
    v_exp_f32 v34, v34
    v_exp_f32 v35, v35
    v_exp_f32 v36, v36
    v_exp_f32 v37, v37
    v_mfma_f32_32x32x16_bf16 v[48:63], v[152:155], v[112:115], v[48:63]
    ds_read2st64_b64 v[100:103], v235 offset0:22 offset1:23
    v_exp_f32 v38, v38
    v_exp_f32 v39, v39
    v_exp_f32 v40, v40
    v_exp_f32 v41, v41
    v_smfmac_f32_32x32x32_bf16 v[80:95], v[208:211], v[32:39], v232
    ds_read2st64_b64 v[104:107], v235 offset0:24 offset1:24
    v_exp_f32 v42, v42
    v_exp_f32 v43, v43
    v_exp_f32 v44, v44
    v_exp_f32 v45, v45
    v_mfma_f32_32x32x16_bf16 v[64:79], v[156:159], v[112:115], v[64:79]
    ds_read_b128 v[112:115], v233 offset:1536
    v_exp_f32 v46, v46
    v_exp_f32 v47, v47
    v_exp_f32 v48, v48
    v_exp_f32 v49, v49
    v_smfmac_f32_32x32x32_bf16 v[80:95], v[212:215], v[40:47], v232
    v_exp_f32 v50, v50
    v_exp_f32 v51, v51
    v_exp_f32 v52, v52
    v_exp_f32 v53, v53
    v_mfma_f32_32x32x4_2b_bf16 v[16:47], v[160:161], v[118:119], 0
    v_exp_f32 v54, v54
    v_exp_f32 v55, v55
    v_exp_f32 v56, v56
    v_exp_f32 v57, v57
    v_exp_f32 v58, v58
    v_exp_f32 v59, v59
    v_exp_f32 v60, v60
    v_exp_f32 v61, v61
    v_smfmac_f32_32x32x32_bf16 v[80:95], v[216:219], v[48:55], v232
    v_exp_f32 v62, v62
    v_exp_f32 v63, v63
    v_exp_f32 v64, v64
    v_exp_f32 v65, v65
    v_smfmac_f32_32x32x32_bf16 v[80:95], v[220:223], v[56:63], v232
    s_waitcnt lgkmcnt(0)
    v_exp_f32 v66, v66
    v_exp_f32 v67, v67
    v_exp_f32 v68, v68
    v_exp_f32 v69, v69
    v_mfma_f32_32x32x16_bf16 v[16:31], v[128:131], v[112:115], v[16:31]
    v_exp_f32 v70, v70
    v_exp_f32 v71, v71
    v_exp_f32 v72, v72
    v_exp_f32 v73, v73
    v_smfmac_f32_32x32x32_bf16 v[80:95], v[224:227], v[64:71], v232
    v_exp_f32 v74, v74
    v_exp_f32 v75, v75
    v_exp_f32 v76, v76
    v_exp_f32 v77, v77
    v_mfma_f32_32x32x16_bf16 v[32:47], v[132:135], v[112:115], v[32:47]
    v_exp_f32 v78, v78
    v_exp_f32 v79, v79
    v_exp_f32 v16, v16
    v_exp_f32 v17, v17
    v_smfmac_f32_32x32x32_bf16 v[80:95], v[228:231], v[72:79], v232
    v_exp_f32 v18, v18
    v_exp_f32 v19, v19
    v_exp_f32 v20, v20
    v_exp_f32 v21, v21
    v_mfma_f32_32x32x4_2b_bf16 v[48:79], v[162:163], v[118:119], 0
    v_exp_f32 v22, v22
    v_exp_f32 v23, v23
    v_exp_f32 v24, v24
    v_exp_f32 v25, v25
    v_exp_f32 v26, v26
    v_exp_f32 v27, v27
    v_exp_f32 v28, v28
    v_exp_f32 v29, v29
    v_smfmac_f32_32x32x32_bf16 v[96:111], v[168:171], v[16:23], v232
    ds_write2st64_b64 v235, v[80:81], v[82:83] offset0:0 offset1:1
    v_exp_f32 v30, v30
    v_exp_f32 v31, v31
    v_exp_f32 v32, v32
    v_exp_f32 v33, v33
    v_smfmac_f32_32x32x32_bf16 v[96:111], v[172:175], v[24:31], v232
    ds_write2st64_b64 v235, v[84:85], v[86:87] offset0:2 offset1:3
    v_exp_f32 v34, v34
    v_exp_f32 v35, v35
    v_exp_f32 v36, v36
    v_exp_f32 v37, v37
    v_mfma_f32_32x32x16_bf16 v[48:63], v[136:139], v[112:115], v[48:63]
    ds_write_b64 v235, v[88:89] offset:2048
    v_exp_f32 v38, v38
    v_exp_f32 v39, v39
    v_exp_f32 v40, v40
    v_exp_f32 v41, v41
    v_smfmac_f32_32x32x32_bf16 v[96:111], v[176:179], v[32:39], v232
    ds_write_b32 v236, v232 offset:16
    v_exp_f32 v42, v42
    v_exp_f32 v43, v43
    v_exp_f32 v44, v44
    v_exp_f32 v45, v45
    v_mfma_f32_32x32x16_bf16 v[64:79], v[140:143], v[112:115], v[64:79]
    v_exp_f32 v46, v46
    v_exp_f32 v47, v47
    v_exp_f32 v48, v48
    v_exp_f32 v49, v49
    v_smfmac_f32_32x32x32_bf16 v[96:111], v[180:183], v[40:47], v232
    v_exp_f32 v50, v50
    v_exp_f32 v51, v51
    v_exp_f32 v52, v52
    v_exp_f32 v53, v53
    v_mfma_f32_32x32x4_2b_bf16 v[16:47], v[164:165], v[118:119], 0
    v_exp_f32 v54, v54
    v_exp_f32 v55, v55
    v_exp_f32 v56, v56
    v_exp_f32 v57, v57
    v_exp_f32 v58, v58
    v_exp_f32 v59, v59
    v_exp_f32 v60, v60
    v_exp_f32 v61, v61
    v_smfmac_f32_32x32x32_bf16 v[96:111], v[184:187], v[48:55], v232
    v_exp_f32 v62, v62
    v_exp_f32 v63, v63
    v_exp_f32 v64, v64
    v_exp_f32 v65, v65
    v_smfmac_f32_32x32x32_bf16 v[96:111], v[188:191], v[56:63], v232
    v_exp_f32 v66, v66
    v_exp_f32 v67, v67
    v_exp_f32 v68, v68
    v_exp_f32 v69, v69
    v_mfma_f32_32x32x16_bf16 v[16:31], v[144:147], v[112:115], v[16:31]
    v_exp_f32 v70, v70
    v_exp_f32 v71, v71
    v_exp_f32 v72, v72
    v_exp_f32 v73, v73
    v_smfmac_f32_32x32x32_bf16 v[96:111], v[192:195], v[64:71], v232
    v_exp_f32 v74, v74
    v_exp_f32 v75, v75
    v_exp_f32 v76, v76
    v_exp_f32 v77, v77
    v_mfma_f32_32x32x16_bf16 v[32:47], v[148:151], v[112:115], v[32:47]
    v_exp_f32 v78, v78
    v_exp_f32 v79, v79
    v_exp_f32 v16, v16
    v_exp_f32 v17, v17
    v_smfmac_f32_32x32x32_bf16 v[96:111], v[196:199], v[72:79], v232
    v_exp_f32 v18, v18
    v_exp_f32 v19, v19
    v_exp_f32 v20, v20
    v_exp_f32 v21, v21
    v_mfma_f32_32x32x4_2b_bf16 v[48:79], v[166:167], v[118:119], 0
    v_exp_f32 v22, v22
    v_exp_f32 v23, v23
    v_exp_f32 v24, v24
    v_exp_f32 v25, v25
    v_exp_f32 v26, v26
    v_exp_f32 v27, v27
    v_exp_f32 v28, v28
    v_exp_f32 v29, v29
    v_smfmac_f32_32x32x32_bf16 v[96:111], v[200:203], v[16:23], v232
    ds_read2st64_b64 v[116:119], v234 offset0:6 offset1:9
    v_exp_f32 v30, v30
    v_exp_f32 v31, v31
    v_exp_f32 v32, v32
    v_exp_f32 v33, v33
    v_smfmac_f32_32x32x32_bf16 v[96:111], v[204:207], v[24:31], v232
    ds_read2st64_b64 v[80:83], v235 offset0:40 offset1:41
    v_exp_f32 v34, v34
    v_exp_f32 v35, v35
    v_exp_f32 v36, v36
    v_exp_f32 v37, v37
    v_mfma_f32_32x32x16_bf16 v[48:63], v[152:155], v[112:115], v[48:63]
    ds_read2st64_b64 v[84:87], v235 offset0:42 offset1:43
    v_exp_f32 v38, v38
    v_exp_f32 v39, v39
    v_exp_f32 v40, v40
    v_exp_f32 v41, v41
    v_smfmac_f32_32x32x32_bf16 v[96:111], v[208:211], v[32:39], v232
    ds_read2st64_b64 v[88:91], v235 offset0:44 offset1:44
    v_exp_f32 v42, v42
    v_exp_f32 v43, v43
    v_exp_f32 v44, v44
    v_exp_f32 v45, v45
    v_mfma_f32_32x32x16_bf16 v[64:79], v[156:159], v[112:115], v[64:79]
    ds_read_b128 v[112:115], v233 offset:3072
    v_exp_f32 v46, v46
    v_exp_f32 v47, v47
    v_exp_f32 v48, v48
    v_exp_f32 v49, v49
    v_smfmac_f32_32x32x32_bf16 v[96:111], v[212:215], v[40:47], v232
    s_waitcnt lgkmcnt(4)
    v_exp_f32 v50, v50
    v_exp_f32 v51, v51
    v_exp_f32 v52, v52
    v_exp_f32 v53, v53
    v_mfma_f32_32x32x4_2b_bf16 v[16:47], v[160:161], v[116:117], 0
    v_exp_f32 v54, v54
    v_exp_f32 v55, v55
    v_exp_f32 v56, v56
    v_exp_f32 v57, v57
    v_exp_f32 v58, v58
    v_exp_f32 v59, v59
    v_exp_f32 v60, v60
    v_exp_f32 v61, v61
    v_smfmac_f32_32x32x32_bf16 v[96:111], v[216:219], v[48:55], v232
    v_exp_f32 v62, v62
    v_exp_f32 v63, v63
    v_exp_f32 v64, v64
    v_exp_f32 v65, v65
    v_smfmac_f32_32x32x32_bf16 v[96:111], v[220:223], v[56:63], v232
    s_waitcnt lgkmcnt(0)
    v_exp_f32 v66, v66
    v_exp_f32 v67, v67
    v_exp_f32 v68, v68
    v_exp_f32 v69, v69
    v_mfma_f32_32x32x16_bf16 v[16:31], v[128:131], v[112:115], v[16:31]
    v_exp_f32 v70, v70
    v_exp_f32 v71, v71
    v_exp_f32 v72, v72
    v_exp_f32 v73, v73
    v_smfmac_f32_32x32x32_bf16 v[96:111], v[224:227], v[64:71], v232
    v_exp_f32 v74, v74
    v_exp_f32 v75, v75
    v_exp_f32 v76, v76
    v_exp_f32 v77, v77
    v_mfma_f32_32x32x16_bf16 v[32:47], v[132:135], v[112:115], v[32:47]
    v_exp_f32 v78, v78
    v_exp_f32 v79, v79
    v_exp_f32 v16, v16
    v_exp_f32 v17, v17
    v_smfmac_f32_32x32x32_bf16 v[96:111], v[228:231], v[72:79], v232
    v_exp_f32 v18, v18
    v_exp_f32 v19, v19
    v_exp_f32 v20, v20
    v_exp_f32 v21, v21
    v_mfma_f32_32x32x4_2b_bf16 v[48:79], v[162:163], v[116:117], 0
    v_exp_f32 v22, v22
    v_exp_f32 v23, v23
    v_exp_f32 v24, v24
    v_exp_f32 v25, v25
    v_exp_f32 v26, v26
    v_exp_f32 v27, v27
    v_exp_f32 v28, v28
    v_exp_f32 v29, v29
    v_smfmac_f32_32x32x32_bf16 v[80:95], v[168:171], v[16:23], v232
    ds_write2st64_b64 v235, v[96:97], v[98:99] offset0:20 offset1:21
    v_exp_f32 v30, v30
    v_exp_f32 v31, v31
    v_exp_f32 v32, v32
    v_exp_f32 v33, v33
    v_smfmac_f32_32x32x32_bf16 v[80:95], v[172:175], v[24:31], v232
    ds_write2st64_b64 v235, v[100:101], v[102:103] offset0:22 offset1:23
    v_exp_f32 v34, v34
    v_exp_f32 v35, v35
    v_exp_f32 v36, v36
    v_exp_f32 v37, v37
    v_mfma_f32_32x32x16_bf16 v[48:63], v[136:139], v[112:115], v[48:63]
    ds_write_b64 v235, v[104:105] offset:12288
    v_exp_f32 v38, v38
    v_exp_f32 v39, v39
    v_exp_f32 v40, v40
    v_exp_f32 v41, v41
    v_smfmac_f32_32x32x32_bf16 v[80:95], v[176:179], v[32:39], v232
    ds_write_b32 v236, v232 offset:48
    v_exp_f32 v42, v42
    v_exp_f32 v43, v43
    v_exp_f32 v44, v44
    v_exp_f32 v45, v45
    v_mfma_f32_32x32x16_bf16 v[64:79], v[140:143], v[112:115], v[64:79]
    v_exp_f32 v46, v46
    v_exp_f32 v47, v47
    v_exp_f32 v48, v48
    v_exp_f32 v49, v49
    v_smfmac_f32_32x32x32_bf16 v[80:95], v[180:183], v[40:47], v232
    v_exp_f32 v50, v50
    v_exp_f32 v51, v51
    v_exp_f32 v52, v52
    v_exp_f32 v53, v53
    v_mfma_f32_32x32x4_2b_bf16 v[16:47], v[164:165], v[116:117], 0
    v_exp_f32 v54, v54
    v_exp_f32 v55, v55
    v_exp_f32 v56, v56
    v_exp_f32 v57, v57
    v_exp_f32 v58, v58
    v_exp_f32 v59, v59
    v_exp_f32 v60, v60
    v_exp_f32 v61, v61
    v_smfmac_f32_32x32x32_bf16 v[80:95], v[184:187], v[48:55], v232
    v_exp_f32 v62, v62
    v_exp_f32 v63, v63
    v_exp_f32 v64, v64
    v_exp_f32 v65, v65
    v_smfmac_f32_32x32x32_bf16 v[80:95], v[188:191], v[56:63], v232
    v_exp_f32 v66, v66
    v_exp_f32 v67, v67
    v_exp_f32 v68, v68
    v_exp_f32 v69, v69
    v_mfma_f32_32x32x16_bf16 v[16:31], v[144:147], v[112:115], v[16:31]
    v_exp_f32 v70, v70
    v_exp_f32 v71, v71
    v_exp_f32 v72, v72
    v_exp_f32 v73, v73
    v_smfmac_f32_32x32x32_bf16 v[80:95], v[192:195], v[64:71], v232
    v_exp_f32 v74, v74
    v_exp_f32 v75, v75
    v_exp_f32 v76, v76
    v_exp_f32 v77, v77
    v_mfma_f32_32x32x16_bf16 v[32:47], v[148:151], v[112:115], v[32:47]
    v_exp_f32 v78, v78
    v_exp_f32 v79, v79
    v_exp_f32 v16, v16
    v_exp_f32 v17, v17
    v_smfmac_f32_32x32x32_bf16 v[80:95], v[196:199], v[72:79], v232
    v_exp_f32 v18, v18
    v_exp_f32 v19, v19
    v_exp_f32 v20, v20
    v_exp_f32 v21, v21
    v_mfma_f32_32x32x4_2b_bf16 v[48:79], v[166:167], v[116:117], 0
    v_exp_f32 v22, v22
    v_exp_f32 v23, v23
    v_exp_f32 v24, v24
    v_exp_f32 v25, v25
    v_exp_f32 v26, v26
    v_exp_f32 v27, v27
    v_exp_f32 v28, v28
    v_exp_f32 v29, v29
    v_smfmac_f32_32x32x32_bf16 v[80:95], v[200:203], v[16:23], v232
    v_exp_f32 v30, v30
    v_exp_f32 v31, v31
    v_exp_f32 v32, v32
    v_exp_f32 v33, v33
    v_smfmac_f32_32x32x32_bf16 v[80:95], v[204:207], v[24:31], v232
    ds_read2st64_b64 v[96:99], v235 offset0:60 offset1:61
    v_exp_f32 v34, v34
    v_exp_f32 v35, v35
    v_exp_f32 v36, v36
    v_exp_f32 v37, v37
    v_mfma_f32_32x32x16_bf16 v[48:63], v[152:155], v[112:115], v[48:63]
    ds_read2st64_b64 v[100:103], v235 offset0:62 offset1:63
    v_exp_f32 v38, v38
    v_exp_f32 v39, v39
    v_exp_f32 v40, v40
    v_exp_f32 v41, v41
    v_smfmac_f32_32x32x32_bf16 v[80:95], v[208:211], v[32:39], v232
    ds_read2st64_b64 v[104:107], v235 offset0:64 offset1:64
    v_exp_f32 v42, v42
    v_exp_f32 v43, v43
    v_exp_f32 v44, v44
    v_exp_f32 v45, v45
    v_mfma_f32_32x32x16_bf16 v[64:79], v[156:159], v[112:115], v[64:79]
    ds_read_b128 v[112:115], v233 offset:4608
    v_exp_f32 v46, v46
    v_exp_f32 v47, v47
    v_exp_f32 v48, v48
    v_exp_f32 v49, v49
    v_smfmac_f32_32x32x32_bf16 v[80:95], v[212:215], v[40:47], v232
    v_exp_f32 v50, v50
    v_exp_f32 v51, v51
    v_exp_f32 v52, v52
    v_exp_f32 v53, v53
    v_mfma_f32_32x32x4_2b_bf16 v[16:47], v[160:161], v[118:119], 0
    v_exp_f32 v54, v54
    v_exp_f32 v55, v55
    v_exp_f32 v56, v56
    v_exp_f32 v57, v57
    v_exp_f32 v58, v58
    v_exp_f32 v59, v59
    v_exp_f32 v60, v60
    v_exp_f32 v61, v61
    v_smfmac_f32_32x32x32_bf16 v[80:95], v[216:219], v[48:55], v232
    v_exp_f32 v62, v62
    v_exp_f32 v63, v63
    v_exp_f32 v64, v64
    v_exp_f32 v65, v65
    v_smfmac_f32_32x32x32_bf16 v[80:95], v[220:223], v[56:63], v232
    s_waitcnt lgkmcnt(0)
    v_exp_f32 v66, v66
    v_exp_f32 v67, v67
    v_exp_f32 v68, v68
    v_exp_f32 v69, v69
    v_mfma_f32_32x32x16_bf16 v[16:31], v[128:131], v[112:115], v[16:31]
    v_exp_f32 v70, v70
    v_exp_f32 v71, v71
    v_exp_f32 v72, v72
    v_exp_f32 v73, v73
    v_smfmac_f32_32x32x32_bf16 v[80:95], v[224:227], v[64:71], v232
    v_exp_f32 v74, v74
    v_exp_f32 v75, v75
    v_exp_f32 v76, v76
    v_exp_f32 v77, v77
    v_mfma_f32_32x32x16_bf16 v[32:47], v[132:135], v[112:115], v[32:47]
    v_exp_f32 v78, v78
    v_exp_f32 v79, v79
    v_exp_f32 v16, v16
    v_exp_f32 v17, v17
    v_smfmac_f32_32x32x32_bf16 v[80:95], v[228:231], v[72:79], v232
    v_exp_f32 v18, v18
    v_exp_f32 v19, v19
    v_exp_f32 v20, v20
    v_exp_f32 v21, v21
    v_mfma_f32_32x32x4_2b_bf16 v[48:79], v[162:163], v[118:119], 0
    v_exp_f32 v22, v22
    v_exp_f32 v23, v23
    v_exp_f32 v24, v24
    v_exp_f32 v25, v25
    v_exp_f32 v26, v26
    v_exp_f32 v27, v27
    v_exp_f32 v28, v28
    v_exp_f32 v29, v29
    v_smfmac_f32_32x32x32_bf16 v[96:111], v[168:171], v[16:23], v232
    ds_write2st64_b64 v235, v[80:81], v[82:83] offset0:40 offset1:41
    v_exp_f32 v30, v30
    v_exp_f32 v31, v31
    v_exp_f32 v32, v32
    v_exp_f32 v33, v33
    v_smfmac_f32_32x32x32_bf16 v[96:111], v[172:175], v[24:31], v232
    ds_write2st64_b64 v235, v[84:85], v[86:87] offset0:42 offset1:43
    v_exp_f32 v34, v34
    v_exp_f32 v35, v35
    v_exp_f32 v36, v36
    v_exp_f32 v37, v37
    v_mfma_f32_32x32x16_bf16 v[48:63], v[136:139], v[112:115], v[48:63]
    ds_write_b64 v235, v[88:89] offset:22528
    v_exp_f32 v38, v38
    v_exp_f32 v39, v39
    v_exp_f32 v40, v40
    v_exp_f32 v41, v41
    v_smfmac_f32_32x32x32_bf16 v[96:111], v[176:179], v[32:39], v232
    ds_write_b32 v236, v232 offset:80
    v_exp_f32 v42, v42
    v_exp_f32 v43, v43
    v_exp_f32 v44, v44
    v_exp_f32 v45, v45
    v_mfma_f32_32x32x16_bf16 v[64:79], v[140:143], v[112:115], v[64:79]
    v_exp_f32 v46, v46
    v_exp_f32 v47, v47
    v_exp_f32 v48, v48
    v_exp_f32 v49, v49
    v_smfmac_f32_32x32x32_bf16 v[96:111], v[180:183], v[40:47], v232
    ds_read_b32 v125, v236 offset:224
    v_exp_f32 v50, v50
    v_exp_f32 v51, v51
    v_exp_f32 v52, v52
    v_exp_f32 v53, v53
    v_mfma_f32_32x32x4_2b_bf16 v[16:47], v[164:165], v[118:119], 0
    v_exp_f32 v54, v54
    v_exp_f32 v55, v55
    v_exp_f32 v56, v56
    v_exp_f32 v57, v57
    v_exp_f32 v58, v58
    v_exp_f32 v59, v59
    v_exp_f32 v60, v60
    v_exp_f32 v61, v61
    v_smfmac_f32_32x32x32_bf16 v[96:111], v[184:187], v[48:55], v232
    v_exp_f32 v62, v62
    v_exp_f32 v63, v63
    v_exp_f32 v64, v64
    v_exp_f32 v65, v65
    v_smfmac_f32_32x32x32_bf16 v[96:111], v[188:191], v[56:63], v232
    s_waitcnt lgkmcnt(0)
    v_exp_f32 v66, v66
    v_exp_f32 v67, v67
    v_readfirstlane_b32 s12, v125
    v_exp_f32 v68, v68
    v_exp_f32 v69, v69
    v_mfma_f32_32x32x16_bf16 v[16:31], v[144:147], v[112:115], v[16:31]
    v_exp_f32 v70, v70
    v_exp_f32 v71, v71
    v_exp_f32 v72, v72
    v_exp_f32 v73, v73
    v_smfmac_f32_32x32x32_bf16 v[96:111], v[192:195], v[64:71], v232
    s_cmp_eq_u32 s12, 0
    v_exp_f32 v74, v74
    v_exp_f32 v75, v75
    v_exp_f32 v76, v76
    v_exp_f32 v77, v77
    v_mfma_f32_32x32x16_bf16 v[32:47], v[148:151], v[112:115], v[32:47]
    s_cbranch_scc1 L_await
L_aback:
    s_setprio 1
    v_exp_f32 v78, v78
    v_exp_f32 v79, v79
    v_exp_f32 v16, v16
    v_exp_f32 v17, v17
    v_smfmac_f32_32x32x32_bf16 v[96:111], v[196:199], v[72:79], v232
    v_exp_f32 v18, v18
    v_exp_f32 v19, v19
    v_exp_f32 v20, v20
    v_exp_f32 v21, v21
    v_mfma_f32_32x32x4_2b_bf16 v[48:79], v[166:167], v[118:119], 0
    v_exp_f32 v22, v22
    v_exp_f32 v23, v23
    v_exp_f32 v24, v24
    v_exp_f32 v25, v25
    v_exp_f32 v26, v26
    v_exp_f32 v27, v27
    v_exp_f32 v28, v28
    v_exp_f32 v29, v29
    v_smfmac_f32_32x32x32_bf16 v[96:111], v[200:203], v[16:23], v232
    ds_read2st64_b64 v[116:119], v234 offset0:12 offset1:15
    v_exp_f32 v30, v30
    v_exp_f32 v31, v31
    v_exp_f32 v32, v32
    v_exp_f32 v33, v33
    v_smfmac_f32_32x32x32_bf16 v[96:111], v[204:207], v[24:31], v232
    ds_read2st64_b64 v[80:83], v235 offset0:80 offset1:81
    v_exp_f32 v34, v34
    v_exp_f32 v35, v35
    v_exp_f32 v36, v36
    v_exp_f32 v37, v37
    v_mfma_f32_32x32x16_bf16 v[48:63], v[152:155], v[112:115], v[48:63]
    ds_read2st64_b64 v[84:87], v235 offset0:82 offset1:83
    v_exp_f32 v38, v38
    v_exp_f32 v39, v39
    v_exp_f32 v40, v40
    v_exp_f32 v41, v41
    v_smfmac_f32_32x32x32_bf16 v[96:111], v[208:211], v[32:39], v232
    ds_read2st64_b64 v[88:91], v235 offset0:84 offset1:84
    v_exp_f32 v42, v42
    v_exp_f32 v43, v43
    v_exp_f32 v44, v44
    v_exp_f32 v45, v45
    v_mfma_f32_32x32x16_bf16 v[64:79], v[156:159], v[112:115], v[64:79]
    ds_read_b128 v[112:115], v233 offset:6144
    v_exp_f32 v46, v46
    v_exp_f32 v47, v47
    v_exp_f32 v48, v48
    v_exp_f32 v49, v49
    v_smfmac_f32_32x32x32_bf16 v[96:111], v[212:215], v[40:47], v232
    s_waitcnt lgkmcnt(4)
    v_exp_f32 v50, v50
    v_exp_f32 v51, v51
    v_exp_f32 v52, v52
    v_exp_f32 v53, v53
    v_mfma_f32_32x32x4_2b_bf16 v[16:47], v[160:161], v[116:117], 0
    v_exp_f32 v54, v54
    v_exp_f32 v55, v55
    v_exp_f32 v56, v56
    v_exp_f32 v57, v57
    v_exp_f32 v58, v58
    v_exp_f32 v59, v59
    v_exp_f32 v60, v60
    v_exp_f32 v61, v61
    v_smfmac_f32_32x32x32_bf16 v[96:111], v[216:219], v[48:55], v232
    v_exp_f32 v62, v62
    v_exp_f32 v63, v63
    v_exp_f32 v64, v64
    v_exp_f32 v65, v65
    v_smfmac_f32_32x32x32_bf16 v[96:111], v[220:223], v[56:63], v232
    s_waitcnt lgkmcnt(0)
    v_exp_f32 v66, v66
    v_exp_f32 v67, v67
    v_exp_f32 v68, v68
    v_exp_f32 v69, v69
    v_mfma_f32_32x32x16_bf16 v[16:31], v[128:131], v[112:115], v[16:31]
    v_exp_f32 v70, v70
    v_exp_f32 v71, v71
    v_exp_f32 v72, v72
    v_exp_f32 v73, v73
    v_smfmac_f32_32x32x32_bf16 v[96:111], v[224:227], v[64:71], v232
    v_exp_f32 v74, v74
    v_exp_f32 v75, v75
    v_exp_f32 v76, v76
    v_exp_f32 v77, v77
    v_mfma_f32_32x32x16_bf16 v[32:47], v[132:135], v[112:115], v[32:47]
    v_exp_f32 v78, v78
    v_exp_f32 v79, v79
    v_exp_f32 v16, v16
    v_exp_f32 v17, v17
    v_smfmac_f32_32x32x32_bf16 v[96:111], v[228:231], v[72:79], v232
    v_exp_f32 v18, v18
    v_exp_f32 v19, v19
    v_exp_f32 v20, v20
    v_exp_f32 v21, v21
    v_mfma_f32_32x32x4_2b_bf16 v[48:79], v[162:163], v[116:117], 0
    v_exp_f32 v22, v22
    v_exp_f32 v23, v23
    v_exp_f32 v24, v24
    v_exp_f32 v25, v25
    v_exp_f32 v26, v26
    v_exp_f32 v27, v27
    v_exp_f32 v28, v28
    v_exp_f32 v29, v29
    v_smfmac_f32_32x32x32_bf16 v[80:95], v[168:171], v[16:23], v232
    ds_write2st64_b64 v235, v[96:97], v[98:99] offset0:60 offset1:61
    v_exp_f32 v30, v30
    v_exp_f32 v31, v31
    v_exp_f32 v32, v32
    v_exp_f32 v33, v33
    v_smfmac_f32_32x32x32_bf16 v[80:95], v[172:175], v[24:31], v232
    ds_write2st64_b64 v235, v[100:101], v[102:103] offset0:62 offset1:63
    v_exp_f32 v34, v34
    v_exp_f32 v35, v35
    v_exp_f32 v36, v36
    v_exp_f32 v37, v37
    v_mfma_f32_32x32x16_bf16 v[48:63], v[136:139], v[112:115], v[48:63]
    ds_write_b64 v235, v[104:105] offset:32768
    v_exp_f32 v38, v38
    v_exp_f32 v39, v39
    v_exp_f32 v40, v40
    v_exp_f32 v41, v41
    v_smfmac_f32_32x32x32_bf16 v[80:95], v[176:179], v[32:39], v232
    ds_write_b32 v236, v232 offset:112
    v_exp_f32 v42, v42
    v_exp_f32 v43, v43
    v_exp_f32 v44, v44
    v_exp_f32 v45, v45
    v_mfma_f32_32x32x16_bf16 v[64:79], v[140:143], v[112:115], v[64:79]
    v_exp_f32 v46, v46
    v_exp_f32 v47, v47
    v_exp_f32 v48, v48
    v_exp_f32 v49, v49
    v_smfmac_f32_32x32x32_bf16 v[80:95], v[180:183], v[40:47], v232
    v_exp_f32 v50, v50
    v_exp_f32 v51, v51
    v_exp_f32 v52, v52
    v_exp_f32 v53, v53
    v_mfma_f32_32x32x4_2b_bf16 v[16:47], v[164:165], v[116:117], 0
    v_exp_f32 v54, v54
    v_exp_f32 v55, v55
    v_exp_f32 v56, v56
    v_exp_f32 v57, v57
    v_exp_f32 v58, v58
    v_exp_f32 v59, v59
    v_exp_f32 v60, v60
    v_exp_f32 v61, v61
    v_smfmac_f32_32x32x32_bf16 v[80:95], v[184:187], v[48:55], v232
    v_exp_f32 v62, v62
    v_exp_f32 v63, v63
    v_exp_f32 v64, v64
    v_exp_f32 v65, v65
    v_smfmac_f32_32x32x32_bf16 v[80:95], v[188:191], v[56:63], v232
    v_exp_f32 v66, v66
    v_exp_f32 v67, v67
    v_exp_f32 v68, v68
    v_exp_f32 v69, v69
    v_mfma_f32_32x32x16_bf16 v[16:31], v[144:147], v[112:115], v[16:31]
    v_exp_f32 v70, v70
    v_exp_f32 v71, v71
    v_exp_f32 v72, v72
    v_exp_f32 v73, v73
    v_smfmac_f32_32x32x32_bf16 v[80:95], v[192:195], v[64:71], v232
    v_exp_f32 v74, v74
    v_exp_f32 v75, v75
    v_exp_f32 v76, v76
    v_exp_f32 v77, v77
    v_mfma_f32_32x32x16_bf16 v[32:47], v[148:151], v[112:115], v[32:47]
    v_exp_f32 v78, v78
    v_exp_f32 v79, v79
    v_exp_f32 v16, v16
    v_exp_f32 v17, v17
    v_smfmac_f32_32x32x32_bf16 v[80:95], v[196:199], v[72:79], v232
    v_exp_f32 v18, v18
    v_exp_f32 v19, v19
    v_exp_f32 v20, v20
    v_exp_f32 v21, v21
    v_mfma_f32_32x32x4_2b_bf16 v[48:79], v[166:167], v[116:117], 0
    v_exp_f32 v22, v22
    v_exp_f32 v23, v23
    v_exp_f32 v24, v24
    v_exp_f32 v25, v25
    v_exp_f32 v26, v26
    v_exp_f32 v27, v27
    v_exp_f32 v28, v28
    v_exp_f32 v29, v29
    v_smfmac_f32_32x32x32_bf16 v[80:95], v[200:203], v[16:23], v232
    v_exp_f32 v30, v30
    v_exp_f32 v31, v31
    v_exp_f32 v32, v32
    v_exp_f32 v33, v33
    v_smfmac_f32_32x32x32_bf16 v[80:95], v[204:207], v[24:31], v232
    ds_read2st64_b64 v[96:99], v235 offset0:100 offset1:101
    v_exp_f32 v34, v34
    v_exp_f32 v35, v35
    v_exp_f32 v36, v36
    v_exp_f32 v37, v37
    v_mfma_f32_32x32x16_bf16 v[48:63], v[152:155], v[112:115], v[48:63]
    ds_read2st64_b64 v[100:103], v235 offset0:102 offset1:103
    v_exp_f32 v38, v38
    v_exp_f32 v39, v39
    v_exp_f32 v40, v40
    v_exp_f32 v41, v41
    v_smfmac_f32_32x32x32_bf16 v[80:95], v[208:211], v[32:39], v232
    ds_read2st64_b64 v[104:107], v235 offset0:104 offset1:104
    v_exp_f32 v42, v42
    v_exp_f32 v43, v43
    v_exp_f32 v44, v44
    v_exp_f32 v45, v45
    v_mfma_f32_32x32x16_bf16 v[64:79], v[156:159], v[112:115], v[64:79]
    ds_read_b128 v[112:115], v233 offset:7680
    v_exp_f32 v46, v46
    v_exp_f32 v47, v47
    v_exp_f32 v48, v48
    v_exp_f32 v49, v49
    v_smfmac_f32_32x32x32_bf16 v[80:95], v[212:215], v[40:47], v232
    v_exp_f32 v50, v50
    v_exp_f32 v51, v51
    v_exp_f32 v52, v52
    v_exp_f32 v53, v53
    v_mfma_f32_32x32x4_2b_bf16 v[16:47], v[160:161], v[118:119], 0
    v_exp_f32 v54, v54
    v_exp_f32 v55, v55
    v_exp_f32 v56, v56
    v_exp_f32 v57, v57
    v_exp_f32 v58, v58
    v_exp_f32 v59, v59
    v_exp_f32 v60, v60
    v_exp_f32 v61, v61
    v_smfmac_f32_32x32x32_bf16 v[80:95], v[216:219], v[48:55], v232
    v_exp_f32 v62, v62
    v_exp_f32 v63, v63
    v_exp_f32 v64, v64
    v_exp_f32 v65, v65
    v_smfmac_f32_32x32x32_bf16 v[80:95], v[220:223], v[56:63], v232
    s_waitcnt lgkmcnt(0)
    v_exp_f32 v66, v66
    v_exp_f32 v67, v67
    v_exp_f32 v68, v68
    v_exp_f32 v69, v69
    v_mfma_f32_32x32x16_bf16 v[16:31], v[128:131], v[112:115], v[16:31]
    v_exp_f32 v70, v70
    v_exp_f32 v71, v71
    v_exp_f32 v72, v72
    v_exp_f32 v73, v73
    v_smfmac_f32_32x32x32_bf16 v[80:95], v[224:227], v[64:71], v232
    v_exp_f32 v74, v74
    v_exp_f32 v75, v75
    v_exp_f32 v76, v76
    v_exp_f32 v77, v77
    v_mfma_f32_32x32x16_bf16 v[32:47], v[132:135], v[112:115], v[32:47]
    v_exp_f32 v78, v78
    v_exp_f32 v79, v79
    v_exp_f32 v16, v16
    v_exp_f32 v17, v17
    v_smfmac_f32_32x32x32_bf16 v[80:95], v[228:231], v[72:79], v232
    v_exp_f32 v18, v18
    v_exp_f32 v19, v19
    v_exp_f32 v20, v20
    v_exp_f32 v21, v21
    v_mfma_f32_32x32x4_2b_bf16 v[48:79], v[162:163], v[118:119], 0
    v_exp_f32 v22, v22
    v_exp_f32 v23, v23
    v_exp_f32 v24, v24
    v_exp_f32 v25, v25
    v_exp_f32 v26, v26
    v_exp_f32 v27, v27
    v_exp_f32 v28, v28
    v_exp_f32 v29, v29
    v_smfmac_f32_32x32x32_bf16 v[96:111], v[168:171], v[16:23], v232
    ds_write2st64_b64 v235, v[80:81], v[82:83] offset0:80 offset1:81
    v_exp_f32 v30, v30
    v_exp_f32 v31, v31
    v_exp_f32 v32, v32
    v_exp_f32 v33, v33
    v_smfmac_f32_32x32x32_bf16 v[96:111], v[172:175], v[24:31], v232
    ds_write2st64_b64 v235, v[84:85], v[86:87] offset0:82 offset1:83
    v_exp_f32 v34, v34
    v_exp_f32 v35, v35
    v_exp_f32 v36, v36
    v_exp_f32 v37, v37
    v_mfma_f32_32x32x16_bf16 v[48:63], v[136:139], v[112:115], v[48:63]
    ds_write_b64 v235, v[88:89] offset:43008
    v_exp_f32 v38, v38
    v_exp_f32 v39, v39
    v_exp_f32 v40, v40
    v_exp_f32 v41, v41
    v_smfmac_f32_32x32x32_bf16 v[96:111], v[176:179], v[32:39], v232
    ds_write_b32 v236, v232 offset:144
    v_exp_f32 v42, v42
    v_exp_f32 v43, v43
    v_exp_f32 v44, v44
    v_exp_f32 v45, v45
    v_mfma_f32_32x32x16_bf16 v[64:79], v[140:143], v[112:115], v[64:79]
    v_exp_f32 v46, v46
    v_exp_f32 v47, v47
    v_exp_f32 v48, v48
    v_exp_f32 v49, v49
    v_smfmac_f32_32x32x32_bf16 v[96:111], v[180:183], v[40:47], v232
    v_exp_f32 v50, v50
    v_exp_f32 v51, v51
    v_exp_f32 v52, v52
    v_exp_f32 v53, v53
    v_mfma_f32_32x32x4_2b_bf16 v[16:47], v[164:165], v[118:119], 0
    v_exp_f32 v54, v54
    v_exp_f32 v55, v55
    v_exp_f32 v56, v56
    v_exp_f32 v57, v57
    v_exp_f32 v58, v58
    v_exp_f32 v59, v59
    v_exp_f32 v60, v60
    v_exp_f32 v61, v61
    v_smfmac_f32_32x32x32_bf16 v[96:111], v[184:187], v[48:55], v232
    v_exp_f32 v62, v62
    v_exp_f32 v63, v63
    v_exp_f32 v64, v64
    v_exp_f32 v65, v65
    v_smfmac_f32_32x32x32_bf16 v[96:111], v[188:191], v[56:63], v232
    v_exp_f32 v66, v66
    v_exp_f32 v67, v67
    v_exp_f32 v68, v68
    v_exp_f32 v69, v69
    v_mfma_f32_32x32x16_bf16 v[16:31], v[144:147], v[112:115], v[16:31]
    v_exp_f32 v70, v70
    v_exp_f32 v71, v71
    v_exp_f32 v72, v72
    v_exp_f32 v73, v73
    v_smfmac_f32_32x32x32_bf16 v[96:111], v[192:195], v[64:71], v232
    v_exp_f32 v74, v74
    v_exp_f32 v75, v75
    v_exp_f32 v76, v76
    v_exp_f32 v77, v77
    v_mfma_f32_32x32x16_bf16 v[32:47], v[148:151], v[112:115], v[32:47]
    v_exp_f32 v78, v78
    v_exp_f32 v79, v79
    v_exp_f32 v16, v16
    v_exp_f32 v17, v17
    v_smfmac_f32_32x32x32_bf16 v[96:111], v[196:199], v[72:79], v232
    v_exp_f32 v18, v18
    v_exp_f32 v19, v19
    v_exp_f32 v20, v20
    v_exp_f32 v21, v21
    v_mfma_f32_32x32x4_2b_bf16 v[48:79], v[166:167], v[118:119], 0
    v_exp_f32 v22, v22
    v_exp_f32 v23, v23
    v_exp_f32 v24, v24
    v_exp_f32 v25, v25
    v_exp_f32 v26, v26
    v_exp_f32 v27, v27
    v_exp_f32 v28, v28
    v_exp_f32 v29, v29
    v_smfmac_f32_32x32x32_bf16 v[96:111], v[200:203], v[16:23], v232
    ds_read2st64_b64 v[116:119], v234 offset0:18 offset1:21
    v_exp_f32 v30, v30
    v_exp_f32 v31, v31
    v_exp_f32 v32, v32
    v_exp_f32 v33, v33
    v_smfmac_f32_32x32x32_bf16 v[96:111], v[204:207], v[24:31], v232
    ds_read2st64_b64 v[80:83], v235 offset0:120 offset1:121
    v_exp_f32 v34, v34
    v_exp_f32 v35, v35
    v_exp_f32 v36, v36
    v_exp_f32 v37, v37
    v_mfma_f32_32x32x16_bf16 v[48:63], v[152:155], v[112:115], v[48:63]
    ds_read2st64_b64 v[84:87], v235 offset0:122 offset1:123
    v_exp_f32 v38, v38
    v_exp_f32 v39, v39
    v_exp_f32 v40, v40
    v_exp_f32 v41, v41
    v_smfmac_f32_32x32x32_bf16 v[96:111], v[208:211], v[32:39], v232
    ds_read2st64_b64 v[88:91], v235 offset0:124 offset1:124
    v_exp_f32 v42, v42
    v_exp_f32 v43, v43
    v_exp_f32 v44, v44
    v_exp_f32 v45, v45
    v_mfma_f32_32x32x16_bf16 v[64:79], v[156:159], v[112:115], v[64:79]
    ds_read_b128 v[112:115], v233 offset:9216
    v_exp_f32 v46, v46
    v_exp_f32 v47, v47
    v_exp_f32 v48, v48
    v_exp_f32 v49, v49
    v_smfmac_f32_32x32x32_bf16 v[96:111], v[212:215], v[40:47], v232
    s_waitcnt lgkmcnt(4)
    v_exp_f32 v50, v50
    v_exp_f32 v51, v51
    v_exp_f32 v52, v52
    v_exp_f32 v53, v53
    v_mfma_f32_32x32x4_2b_bf16 v[16:47], v[160:161], v[116:117], 0
    v_exp_f32 v54, v54
    v_exp_f32 v55, v55
    v_exp_f32 v56, v56
    v_exp_f32 v57, v57
    v_exp_f32 v58, v58
    v_exp_f32 v59, v59
    v_exp_f32 v60, v60
    v_exp_f32 v61, v61
    v_smfmac_f32_32x32x32_bf16 v[96:111], v[216:219], v[48:55], v232
    v_exp_f32 v62, v62
    v_exp_f32 v63, v63
    v_exp_f32 v64, v64
    v_exp_f32 v65, v65
    v_smfmac_f32_32x32x32_bf16 v[96:111], v[220:223], v[56:63], v232
    s_waitcnt lgkmcnt(0)
    v_exp_f32 v66, v66
    v_exp_f32 v67, v67
    v_exp_f32 v68, v68
    v_exp_f32 v69, v69
    v_mfma_f32_32x32x16_bf16 v[16:31], v[128:131], v[112:115], v[16:31]
    v_exp_f32 v70, v70
    v_exp_f32 v71, v71
    v_exp_f32 v72, v72
    v_exp_f32 v73, v73
    v_smfmac_f32_32x32x32_bf16 v[96:111], v[224:227], v[64:71], v232
    v_exp_f32 v74, v74
    v_exp_f32 v75, v75
    v_exp_f32 v76, v76
    v_exp_f32 v77, v77
    v_mfma_f32_32x32x16_bf16 v[32:47], v[132:135], v[112:115], v[32:47]
    v_exp_f32 v78, v78
    v_exp_f32 v79, v79
    v_exp_f32 v16, v16
    v_exp_f32 v17, v17
    v_smfmac_f32_32x32x32_bf16 v[96:111], v[228:231], v[72:79], v232
    v_exp_f32 v18, v18
    v_exp_f32 v19, v19
    v_exp_f32 v20, v20
    v_exp_f32 v21, v21
    v_mfma_f32_32x32x4_2b_bf16 v[48:79], v[162:163], v[116:117], 0
    v_exp_f32 v22, v22
    v_exp_f32 v23, v23
    v_exp_f32 v24, v24
    v_exp_f32 v25, v25
    v_exp_f32 v26, v26
    v_exp_f32 v27, v27
    v_exp_f32 v28, v28
    v_exp_f32 v29, v29
    v_smfmac_f32_32x32x32_bf16 v[80:95], v[168:171], v[16:23], v232
    ds_write2st64_b64 v235, v[96:97], v[98:99] offset0:100 offset1:101
    v_exp_f32 v30, v30
    v_exp_f32 v31, v31
    v_exp_f32 v32, v32
    v_exp_f32 v33, v33
    v_smfmac_f32_32x32x32_bf16 v[80:95], v[172:175], v[24:31], v232
    ds_write2st64_b64 v235, v[100:101], v[102:103] offset0:102 offset1:103
    v_exp_f32 v34, v34
    v_exp_f32 v35, v35
    v_exp_f32 v36, v36
    v_exp_f32 v37, v37
    v_mfma_f32_32x32x16_bf16 v[48:63], v[136:139], v[112:115], v[48:63]
    ds_write_b64 v235, v[104:105] offset:53248
    v_exp_f32 v38, v38
    v_exp_f32 v39, v39
    v_exp_f32 v40, v40
    v_exp_f32 v41, v41
    v_smfmac_f32_32x32x32_bf16 v[80:95], v[176:179], v[32:39], v232
    ds_write_b32 v236, v232 offset:176
    v_exp_f32 v42, v42
    v_exp_f32 v43, v43
    v_exp_f32 v44, v44
    v_exp_f32 v45, v45
    v_mfma_f32_32x32x16_bf16 v[64:79], v[140:143], v[112:115], v[64:79]
    v_exp_f32 v46, v46
    v_exp_f32 v47, v47
    v_exp_f32 v48, v48
    v_exp_f32 v49, v49
    v_smfmac_f32_32x32x32_bf16 v[80:95], v[180:183], v[40:47], v232
    v_exp_f32 v50, v50
    v_exp_f32 v51, v51
    v_exp_f32 v52, v52
    v_exp_f32 v53, v53
    v_mfma_f32_32x32x4_2b_bf16 v[16:47], v[164:165], v[116:117], 0
    v_exp_f32 v54, v54
    v_exp_f32 v55, v55
    v_exp_f32 v56, v56
    v_exp_f32 v57, v57
    v_exp_f32 v58, v58
    v_exp_f32 v59, v59
    v_exp_f32 v60, v60
    v_exp_f32 v61, v61
    v_smfmac_f32_32x32x32_bf16 v[80:95], v[184:187], v[48:55], v232
    v_exp_f32 v62, v62
    v_exp_f32 v63, v63
    v_exp_f32 v64, v64
    v_exp_f32 v65, v65
    v_smfmac_f32_32x32x32_bf16 v[80:95], v[188:191], v[56:63], v232
    v_exp_f32 v66, v66
    v_exp_f32 v67, v67
    v_exp_f32 v68, v68
    v_exp_f32 v69, v69
    v_mfma_f32_32x32x16_bf16 v[16:31], v[144:147], v[112:115], v[16:31]
    v_exp_f32 v70, v70
    v_exp_f32 v71, v71
    v_exp_f32 v72, v72
    v_exp_f32 v73, v73
    v_smfmac_f32_32x32x32_bf16 v[80:95], v[192:195], v[64:71], v232
    v_exp_f32 v74, v74
    v_exp_f32 v75, v75
    v_exp_f32 v76, v76
    v_exp_f32 v77, v77
    v_mfma_f32_32x32x16_bf16 v[32:47], v[148:151], v[112:115], v[32:47]
    v_exp_f32 v78, v78
    v_exp_f32 v79, v79
    v_exp_f32 v16, v16
    v_exp_f32 v17, v17
    v_smfmac_f32_32x32x32_bf16 v[80:95], v[196:199], v[72:79], v232
    v_exp_f32 v18, v18
    v_exp_f32 v19, v19
    v_exp_f32 v20, v20
    v_exp_f32 v21, v21
    v_mfma_f32_32x32x4_2b_bf16 v[48:79], v[166:167], v[116:117], 0
    v_exp_f32 v22, v22
    v_exp_f32 v23, v23
    v_exp_f32 v24, v24
    v_exp_f32 v25, v25
    v_exp_f32 v26, v26
    v_exp_f32 v27, v27
    v_exp_f32 v28, v28
    v_exp_f32 v29, v29
    v_smfmac_f32_32x32x32_bf16 v[80:95], v[200:203], v[16:23], v232
    v_exp_f32 v30, v30
    v_exp_f32 v31, v31
    v_exp_f32 v32, v32
    v_exp_f32 v33, v33
    v_smfmac_f32_32x32x32_bf16 v[80:95], v[204:207], v[24:31], v232
    ds_read2st64_b64 v[96:99], v235 offset0:140 offset1:141
    v_exp_f32 v34, v34
    v_exp_f32 v35, v35
    v_exp_f32 v36, v36
    v_exp_f32 v37, v37
    v_mfma_f32_32x32x16_bf16 v[48:63], v[152:155], v[112:115], v[48:63]
    ds_read2st64_b64 v[100:103], v235 offset0:142 offset1:143
    v_exp_f32 v38, v38
    v_exp_f32 v39, v39
    v_exp_f32 v40, v40
    v_exp_f32 v41, v41
    v_smfmac_f32_32x32x32_bf16 v[80:95], v[208:211], v[32:39], v232
    ds_read2st64_b64 v[104:107], v235 offset0:144 offset1:144
    v_exp_f32 v42, v42
    v_exp_f32 v43, v43
    v_exp_f32 v44, v44
    v_exp_f32 v45, v45
    v_mfma_f32_32x32x16_bf16 v[64:79], v[156:159], v[112:115], v[64:79]
    ds_read_b128 v[112:115], v233 offset:10752
    v_exp_f32 v46, v46
    v_exp_f32 v47, v47
    v_exp_f32 v48, v48
    v_exp_f32 v49, v49
    v_smfmac_f32_32x32x32_bf16 v[80:95], v[212:215], v[40:47], v232
    v_exp_f32 v50, v50
    v_exp_f32 v51, v51
    v_exp_f32 v52, v52
    v_exp_f32 v53, v53
    v_mfma_f32_32x32x4_2b_bf16 v[16:47], v[160:161], v[118:119], 0
    v_exp_f32 v54, v54
    v_exp_f32 v55, v55
    v_exp_f32 v56, v56
    v_exp_f32 v57, v57
    v_exp_f32 v58, v58
    v_exp_f32 v59, v59
    v_exp_f32 v60, v60
    v_exp_f32 v61, v61
    v_smfmac_f32_32x32x32_bf16 v[80:95], v[216:219], v[48:55], v232
    v_exp_f32 v62, v62
    v_exp_f32 v63, v63
    v_exp_f32 v64, v64
    v_exp_f32 v65, v65
    v_smfmac_f32_32x32x32_bf16 v[80:95], v[220:223], v[56:63], v232
    s_waitcnt lgkmcnt(0)
    v_exp_f32 v66, v66
    v_exp_f32 v67, v67
    v_exp_f32 v68, v68
    v_exp_f32 v69, v69
    v_mfma_f32_32x32x16_bf16 v[16:31], v[128:131], v[112:115], v[16:31]
    v_exp_f32 v70, v70
    v_exp_f32 v71, v71
    v_exp_f32 v72, v72
    v_exp_f32 v73, v73
    v_smfmac_f32_32x32x32_bf16 v[80:95], v[224:227], v[64:71], v232
    v_exp_f32 v74, v74
    v_exp_f32 v75, v75
    v_exp_f32 v76, v76
    v_exp_f32 v77, v77
    v_mfma_f32_32x32x16_bf16 v[32:47], v[132:135], v[112:115], v[32:47]
    v_exp_f32 v78, v78
    v_exp_f32 v79, v79
    v_exp_f32 v16, v16
    v_exp_f32 v17, v17
    v_smfmac_f32_32x32x32_bf16 v[80:95], v[228:231], v[72:79], v232
    v_exp_f32 v18, v18
    v_exp_f32 v19, v19
    v_exp_f32 v20, v20
    v_exp_f32 v21, v21
    v_mfma_f32_32x32x4_2b_bf16 v[48:79], v[162:163], v[118:119], 0
    v_exp_f32 v22, v22
    v_exp_f32 v23, v23
    v_exp_f32 v24, v24
    v_exp_f32 v25, v25
    v_exp_f32 v26, v26
    v_exp_f32 v27, v27
    v_exp_f32 v28, v28
    v_exp_f32 v29, v29
    v_smfmac_f32_32x32x32_bf16 v[96:111], v[168:171], v[16:23], v232
    ds_write2st64_b64 v235, v[80:81], v[82:83] offset0:120 offset1:121
    v_exp_f32 v30, v30
    v_exp_f32 v31, v31
    v_exp_f32 v32, v32
    v_exp_f32 v33, v33
    v_smfmac_f32_32x32x32_bf16 v[96:111], v[172:175], v[24:31], v232
    ds_write2st64_b64 v235, v[84:85], v[86:87] offset0:122 offset1:123
    v_exp_f32 v34, v34
    v_exp_f32 v35, v35
    v_exp_f32 v36, v36
    v_exp_f32 v37, v37
    v_mfma_f32_32x32x16_bf16 v[48:63], v[136:139], v[112:115], v[48:63]
    ds_write_b64 v235, v[88:89] offset:63488
    v_exp_f32 v38, v38
    v_exp_f32 v39, v39
    v_exp_f32 v40, v40
    v_exp_f32 v41, v41
    v_smfmac_f32_32x32x32_bf16 v[96:111], v[176:179], v[32:39], v232
    ds_write_b32 v236, v232 offset:208
    v_exp_f32 v42, v42
    v_exp_f32 v43, v43
    v_exp_f32 v44, v44
    v_exp_f32 v45, v45
    v_mfma_f32_32x32x16_bf16 v[64:79], v[140:143], v[112:115], v[64:79]
    v_exp_f32 v46, v46
    v_exp_f32 v47, v47
    v_exp_f32 v48, v48
    v_exp_f32 v49, v49
    v_smfmac_f32_32x32x32_bf16 v[96:111], v[180:183], v[40:47], v232
    v_exp_f32 v50, v50
    v_exp_f32 v51, v51
    v_exp_f32 v52, v52
    v_exp_f32 v53, v53
    v_mfma_f32_32x32x4_2b_bf16 v[16:47], v[164:165], v[118:119], 0
    v_exp_f32 v54, v54
    v_exp_f32 v55, v55
    v_exp_f32 v56, v56
    v_exp_f32 v57, v57
    v_exp_f32 v58, v58
    v_exp_f32 v59, v59
    v_exp_f32 v60, v60
    v_exp_f32 v61, v61
    v_smfmac_f32_32x32x32_bf16 v[96:111], v[184:187], v[48:55], v232
    v_exp_f32 v62, v62
    v_exp_f32 v63, v63
    v_exp_f32 v64, v64
    v_exp_f32 v65, v65
    v_smfmac_f32_32x32x32_bf16 v[96:111], v[188:191], v[56:63], v232
    v_exp_f32 v66, v66
    v_exp_f32 v67, v67
    v_exp_f32 v68, v68
    v_exp_f32 v69, v69
    v_mfma_f32_32x32x16_bf16 v[16:31], v[144:147], v[112:115], v[16:31]
    v_exp_f32 v70, v70
    v_exp_f32 v71, v71
    v_exp_f32 v72, v72
    v_exp_f32 v73, v73
    v_smfmac_f32_32x32x32_bf16 v[96:111], v[192:195], v[64:71], v232
    v_exp_f32 v74, v74
    v_exp_f32 v75, v75
    v_exp_f32 v76, v76
    v_exp_f32 v77, v77
    v_mfma_f32_32x32x16_bf16 v[32:47], v[148:151], v[112:115], v[32:47]
    v_exp_f32 v78, v78
    v_exp_f32 v79, v79
    v_exp_f32 v16, v16
    v_exp_f32 v17, v17
    v_smfmac_f32_32x32x32_bf16 v[96:111], v[196:199], v[72:79], v232
    v_exp_f32 v18, v18
    v_exp_f32 v19, v19
    v_exp_f32 v20, v20
    v_exp_f32 v21, v21
    v_mfma_f32_32x32x4_2b_bf16 v[48:79], v[166:167], v[118:119], 0
    v_exp_f32 v22, v22
    v_exp_f32 v23, v23
    v_exp_f32 v24, v24
    v_exp_f32 v25, v25
    v_exp_f32 v26, v26
    v_exp_f32 v27, v27
    v_exp_f32 v28, v28
    v_exp_f32 v29, v29
    v_smfmac_f32_32x32x32_bf16 v[96:111], v[200:203], v[16:23], v232
    v_exp_f32 v30, v30
    v_exp_f32 v31, v31
    v_exp_f32 v32, v32
    v_exp_f32 v33, v33
    v_smfmac_f32_32x32x32_bf16 v[96:111], v[204:207], v[24:31], v232
    v_exp_f32 v34, v34
    v_exp_f32 v35, v35
    v_exp_f32 v36, v36
    v_exp_f32 v37, v37
    v_mfma_f32_32x32x16_bf16 v[48:63], v[152:155], v[112:115], v[48:63]
    v_exp_f32 v38, v38
    v_exp_f32 v39, v39
    v_exp_f32 v40, v40
    v_exp_f32 v41, v41
    v_smfmac_f32_32x32x32_bf16 v[96:111], v[208:211], v[32:39], v232
    v_exp_f32 v42, v42
    v_exp_f32 v43, v43
    v_exp_f32 v44, v44
    v_exp_f32 v45, v45
    v_mfma_f32_32x32x16_bf16 v[64:79], v[156:159], v[112:115], v[64:79]
    v_exp_f32 v46, v46
    v_exp_f32 v47, v47
    v_exp_f32 v48, v48
    v_exp_f32 v49, v49
    v_smfmac_f32_32x32x32_bf16 v[96:111], v[212:215], v[40:47], v232
    v_exp_f32 v50, v50
    v_exp_f32 v51, v51
    v_exp_f32 v52, v52
    v_exp_f32 v53, v53
    v_exp_f32 v54, v54
    v_exp_f32 v55, v55
    v_exp_f32 v56, v56
    v_exp_f32 v57, v57
    v_exp_f32 v58, v58
    v_exp_f32 v59, v59
    v_exp_f32 v60, v60
    v_exp_f32 v61, v61
    v_smfmac_f32_32x32x32_bf16 v[96:111], v[216:219], v[48:55], v232
    v_exp_f32 v62, v62
    v_exp_f32 v63, v63
    v_exp_f32 v64, v64
    v_exp_f32 v65, v65
    v_smfmac_f32_32x32x32_bf16 v[96:111], v[220:223], v[56:63], v232
    v_exp_f32 v66, v66
    v_exp_f32 v67, v67
    v_exp_f32 v68, v68
    v_exp_f32 v69, v69
    v_exp_f32 v70, v70
    v_exp_f32 v71, v71
    v_exp_f32 v72, v72
    v_exp_f32 v73, v73
    v_smfmac_f32_32x32x32_bf16 v[96:111], v[224:227], v[64:71], v232
    v_exp_f32 v74, v74
    v_exp_f32 v75, v75
    v_exp_f32 v76, v76
    v_exp_f32 v77, v77
    v_exp_f32 v78, v78
    v_exp_f32 v79, v79
    s_setprio 3
    s_nop 0
    v_smfmac_f32_32x32x32_bf16 v[96:111], v[228:231], v[72:79], v232
    s_nop 11
    ds_write2st64_b64 v235, v[96:97], v[98:99] offset0:140 offset1:141
    ds_write2st64_b64 v235, v[100:101], v[102:103] offset0:142 offset1:143
    ds_write2st64_b64 v235, v[104:105], v[104:105] offset0:144 offset1:144
    ds_write_b32 v236, v232 offset:240
    s_mov_b64 exec, 1
    ds_add_rtn_u32 v125, v238, v239
    s_mov_b64 exec, -1
    s_branch L_ftail
L_await:
    s_mov_b32 s82, 262144
L_aw57:
    ds_read_b32 v125, v236 offset:224
    s_waitcnt lgkmcnt(0)
    v_readfirstlane_b32 s12, v125
    s_nop 0
    s_cmp_lg_u32 s12, 0
    s_cbranch_scc1 L_aback
    s_sleep 8
    s_sub_u32 s82, s82, 1
    s_cbranch_scc0 L_aw57
    s_branch L_aback
L_oalate:
    v_mov_b32 v2, 162076
    v_mov_b32 v3, 1
    v_mov_b32 v5, s71
    v_mov_b32 v4, s9
    s_mov_b64 exec, 1
    s_waitcnt vmcnt(0)
    ds_add_rtn_u32 v3, v2, v3
    s_waitcnt lgkmcnt(0)
    v_readfirstlane_b32 s12, v3
    s_nop 0
    s_cmp_lg_u32 s12, 3
    s_cbranch_scc1 L_nf59
    buffer_store_dword v4, v5, s[60:63], 0 offen sc1
L_nf59:
    s_mov_b64 exec, -1
    s_branch L_oaback
L_krl0:
    s_cmp_eq_u32 s3, 0
    s_cbranch_scc1 L_kgl0
    s_sub_u32 s3, s3, 1
    s_waitcnt vmcnt(0)
    buffer_load_dword v160, v246, s[60:63], s54 offen offset:0 sc1
    buffer_load_dwordx4 v[128:131], v245, s[60:63], s53 offen offset:0 sc1
    buffer_load_dwordx4 v[132:135], v245, s[60:63], s53 offen offset:512 sc1
    buffer_load_dwordx4 v[168:171], v247, s[60:63], s55 offen offset:0 sc1
    buffer_load_dwordx4 v[172:175], v247, s[60:63], s55 offen offset:256 sc1
    buffer_load_dwordx4 v[176:179], v247, s[60:63], s55 offen offset:512 sc1
    buffer_load_dwordx4 v[180:183], v247, s[60:63], s55 offen offset:768 sc1
    buffer_load_dword v162, v246, s[60:63], s54 offen offset:256 sc1
    buffer_load_dwordx4 v[136:139], v245, s[60:63], s53 offen offset:1024 sc1
    buffer_load_dwordx4 v[140:143], v245, s[60:63], s53 offen offset:1536 sc1
    buffer_load_dwordx4 v[184:187], v247, s[60:63], s55 offen offset:1024 sc1
    buffer_load_dwordx4 v[188:191], v247, s[60:63], s55 offen offset:1280 sc1
    buffer_load_dwordx4 v[192:195], v247, s[60:63], s55 offen offset:1536 sc1
    buffer_load_dwordx4 v[196:199], v247, s[60:63], s55 offen offset:1792 sc1
    buffer_load_dword v164, v246, s[60:63], s54 offen offset:512 sc1
    buffer_load_dwordx4 v[144:147], v245, s[60:63], s53 offen offset:2048 sc1
    buffer_load_dwordx4 v[148:151], v245, s[60:63], s53 offen offset:2560 sc1
    buffer_load_dwordx4 v[200:203], v247, s[60:63], s55 offen offset:2048 sc1
    buffer_load_dwordx4 v[204:207], v247, s[60:63], s55 offen offset:2304 sc1
    buffer_load_dwordx4 v[208:211], v247, s[60:63], s55 offen offset:2560 sc1
    buffer_load_dwordx4 v[212:215], v247, s[60:63], s55 offen offset:2816 sc1
    buffer_load_dword v166, v246, s[60:63], s54 offen offset:768 sc1
    buffer_load_dwordx4 v[152:155], v245, s[60:63], s53 offen offset:3072 sc1
    buffer_load_dwordx4 v[156:159], v245, s[60:63], s53 offen offset:3584 sc1
    buffer_load_dwordx4 v[216:219], v247, s[60:63], s55 offen offset:3072 sc1
    buffer_load_dwordx4 v[220:223], v247, s[60:63], s55 offen offset:3328 sc1
    buffer_load_dwordx4 v[224:227], v247, s[60:63], s55 offen offset:3584 sc1
    buffer_load_dwordx4 v[228:231], v247, s[60:63], s55 offen offset:3840 sc1
    s_branch L_kcl0
L_krl1:
    s_cmp_eq_u32 s3, 0
    s_cbranch_scc1 L_kgl1
    s_sub_u32 s3, s3, 1
    s_waitcnt vmcnt(0)
    buffer_load_dwordx4 v[168:171], v247, s[60:63], s55 offen offset:0 sc1
    buffer_load_dwordx4 v[172:175], v247, s[60:63], s55 offen offset:256 sc1
    buffer_load_dwordx4 v[176:179], v247, s[60:63], s55 offen offset:512 sc1
    buffer_load_dwordx4 v[180:183], v247, s[60:63], s55 offen offset:768 sc1
    buffer_load_dword v162, v246, s[60:63], s54 offen offset:256 sc1
    buffer_load_dwordx4 v[136:139], v245, s[60:63], s53 offen offset:1024 sc1
    buffer_load_dwordx4 v[140:143], v245, s[60:63], s53 offen offset:1536 sc1
    buffer_load_dwordx4 v[184:187], v247, s[60:63], s55 offen offset:1024 sc1
    buffer_load_dwordx4 v[188:191], v247, s[60:63], s55 offen offset:1280 sc1
    buffer_load_dwordx4 v[192:195], v247, s[60:63], s55 offen offset:1536 sc1
    buffer_load_dwordx4 v[196:199], v247, s[60:63], s55 offen offset:1792 sc1
    buffer_load_dword v164, v246, s[60:63], s54 offen offset:512 sc1
    buffer_load_dwordx4 v[144:147], v245, s[60:63], s53 offen offset:2048 sc1
    buffer_load_dwordx4 v[148:151], v245, s[60:63], s53 offen offset:2560 sc1
    buffer_load_dwordx4 v[200:203], v247, s[60:63], s55 offen offset:2048 sc1
    buffer_load_dwordx4 v[204:207], v247, s[60:63], s55 offen offset:2304 sc1
    buffer_load_dwordx4 v[208:211], v247, s[60:63], s55 offen offset:2560 sc1
    buffer_load_dwordx4 v[212:215], v247, s[60:63], s55 offen offset:2816 sc1
    buffer_load_dword v166, v246, s[60:63], s54 offen offset:768 sc1
    buffer_load_dwordx4 v[152:155], v245, s[60:63], s53 offen offset:3072 sc1
    buffer_load_dwordx4 v[156:159], v245, s[60:63], s53 offen offset:3584 sc1
    buffer_load_dwordx4 v[216:219], v247, s[60:63], s55 offen offset:3072 sc1
    buffer_load_dwordx4 v[220:223], v247, s[60:63], s55 offen offset:3328 sc1
    buffer_load_dwordx4 v[224:227], v247, s[60:63], s55 offen offset:3584 sc1
    buffer_load_dwordx4 v[228:231], v247, s[60:63], s55 offen offset:3840 sc1
    s_branch L_kcl1
L_krl2:
    s_cmp_eq_u32 s3, 0
    s_cbranch_scc1 L_kgl2
    s_sub_u32 s3, s3, 1
    s_waitcnt vmcnt(0)
    buffer_load_dwordx4 v[184:187], v247, s[60:63], s55 offen offset:1024 sc1
    buffer_load_dwordx4 v[188:191], v247, s[60:63], s55 offen offset:1280 sc1
    buffer_load_dwordx4 v[192:195], v247, s[60:63], s55 offen offset:1536 sc1
    buffer_load_dwordx4 v[196:199], v247, s[60:63], s55 offen offset:1792 sc1
    buffer_load_dword v164, v246, s[60:63], s54 offen offset:512 sc1
    buffer_load_dwordx4 v[144:147], v245, s[60:63], s53 offen offset:2048 sc1
    buffer_load_dwordx4 v[148:151], v245, s[60:63], s53 offen offset:2560 sc1
    buffer_load_dwordx4 v[200:203], v247, s[60:63], s55 offen offset:2048 sc1
    buffer_load_dwordx4 v[204:207], v247, s[60:63], s55 offen offset:2304 sc1
    buffer_load_dwordx4 v[208:211], v247, s[60:63], s55 offen offset:2560 sc1
    buffer_load_dwordx4 v[212:215], v247, s[60:63], s55 offen offset:2816 sc1
    buffer_load_dword v166, v246, s[60:63], s54 offen offset:768 sc1
    buffer_load_dwordx4 v[152:155], v245, s[60:63], s53 offen offset:3072 sc1
    buffer_load_dwordx4 v[156:159], v245, s[60:63], s53 offen offset:3584 sc1
    buffer_load_dwordx4 v[216:219], v247, s[60:63], s55 offen offset:3072 sc1
    buffer_load_dwordx4 v[220:223], v247, s[60:63], s55 offen offset:3328 sc1
    buffer_load_dwordx4 v[224:227], v247, s[60:63], s55 offen offset:3584 sc1
    buffer_load_dwordx4 v[228:231], v247, s[60:63], s55 offen offset:3840 sc1
    s_branch L_kcl2
L_krl3:
    s_cmp_eq_u32 s3, 0
    s_cbranch_scc1 L_kgl3
    s_sub_u32 s3, s3, 1
    s_waitcnt vmcnt(0)
    buffer_load_dwordx4 v[200:203], v247, s[60:63], s55 offen offset:2048 sc1
    buffer_load_dwordx4 v[204:207], v247, s[60:63], s55 offen offset:2304 sc1
    buffer_load_dwordx4 v[208:211], v247, s[60:63], s55 offen offset:2560 sc1
    buffer_load_dwordx4 v[212:215], v247, s[60:63], s55 offen offset:2816 sc1
    buffer_load_dword v166, v246, s[60:63], s54 offen offset:768 sc1
    buffer_load_dwordx4 v[152:155], v245, s[60:63], s53 offen offset:3072 sc1
    buffer_load_dwordx4 v[156:159], v245, s[60:63], s53 offen offset:3584 sc1
    buffer_load_dwordx4 v[216:219], v247, s[60:63], s55 offen offset:3072 sc1
    buffer_load_dwordx4 v[220:223], v247, s[60:63], s55 offen offset:3328 sc1
    buffer_load_dwordx4 v[224:227], v247, s[60:63], s55 offen offset:3584 sc1
    buffer_load_dwordx4 v[228:231], v247, s[60:63], s55 offen offset:3840 sc1
    s_branch L_kcl3
L_krl4:
    s_cmp_eq_u32 s3, 0
    s_cbranch_scc1 L_kgl4
    s_sub_u32 s3, s3, 1
    s_waitcnt vmcnt(0)
    buffer_load_dwordx4 v[216:219], v247, s[60:63], s55 offen offset:3072 sc1
    buffer_load_dwordx4 v[220:223], v247, s[60:63], s55 offen offset:3328 sc1
    buffer_load_dwordx4 v[224:227], v247, s[60:63], s55 offen offset:3584 sc1
    buffer_load_dwordx4 v[228:231], v247, s[60:63], s55 offen offset:3840 sc1
    s_branch L_kcl4
L_krf0:
    s_cmp_eq_u32 s3, 0
    s_cbranch_scc1 L_kgf0
    s_sub_u32 s3, s3, 1
    s_waitcnt vmcnt(0)
    buffer_load_dword v160, v246, s[60:63], s54 offen offset:0 sc1
    buffer_load_dwordx4 v[128:131], v245, s[60:63], s53 offen offset:0 sc1
    buffer_load_dwordx4 v[132:135], v245, s[60:63], s53 offen offset:512 sc1
    buffer_load_dwordx4 v[168:171], v247, s[60:63], s55 offen offset:0 sc1
    buffer_load_dwordx4 v[172:175], v247, s[60:63], s55 offen offset:256 sc1
    buffer_load_dwordx4 v[176:179], v247, s[60:63], s55 offen offset:512 sc1
    buffer_load_dwordx4 v[180:183], v247, s[60:63], s55 offen offset:768 sc1
    buffer_load_dword v162, v246, s[60:63], s54 offen offset:256 sc1
    buffer_load_dwordx4 v[136:139], v245, s[60:63], s53 offen offset:1024 sc1
    buffer_load_dwordx4 v[140:143], v245, s[60:63], s53 offen offset:1536 sc1
    buffer_load_dwordx4 v[184:187], v247, s[60:63], s55 offen offset:1024 sc1
    buffer_load_dwordx4 v[188:191], v247, s[60:63], s55 offen offset:1280 sc1
    buffer_load_dwordx4 v[192:195], v247, s[60:63], s55 offen offset:1536 sc1
    buffer_load_dwordx4 v[196:199], v247, s[60:63], s55 offen offset:1792 sc1
    buffer_load_dword v164, v246, s[60:63], s54 offen offset:512 sc1
    buffer_load_dwordx4 v[144:147], v245, s[60:63], s53 offen offset:2048 sc1
    buffer_load_dwordx4 v[148:151], v245, s[60:63], s53 offen offset:2560 sc1
    buffer_load_dwordx4 v[200:203], v247, s[60:63], s55 offen offset:2048 sc1
    buffer_load_dwordx4 v[204:207], v247, s[60:63], s55 offen offset:2304 sc1
    buffer_load_dwordx4 v[208:211], v247, s[60:63], s55 offen offset:2560 sc1
    buffer_load_dwordx4 v[212:215], v247, s[60:63], s55 offen offset:2816 sc1
    buffer_load_dword v166, v246, s[60:63], s54 offen offset:768 sc1
    buffer_load_dwordx4 v[152:155], v245, s[60:63], s53 offen offset:3072 sc1
    buffer_load_dwordx4 v[156:159], v245, s[60:63], s53 offen offset:3584 sc1
    buffer_load_dwordx4 v[216:219], v247, s[60:63], s55 offen offset:3072 sc1
    buffer_load_dwordx4 v[220:223], v247, s[60:63], s55 offen offset:3328 sc1
    buffer_load_dwordx4 v[224:227], v247, s[60:63], s55 offen offset:3584 sc1
    buffer_load_dwordx4 v[228:231], v247, s[60:63], s55 offen offset:3840 sc1
    s_branch L_kcf0
L_lead:
    s_setprio 2
    s_cmp_eq_u32 s7, 0
    s_cbranch_scc1 L_oadone
    s_lshl_b32 s12, s10, 2
    s_add_u32 s12, s12, 162096
    v_mov_b32 v2, s12
    v_mov_b32 v3, 1
    s_mov_b64 exec, 1
    ds_add_rtn_u32 v3, v2, v3
    s_mov_b64 exec, -1
    s_waitcnt lgkmcnt(0)
    v_readfirstlane_b32 s12, v3
    s_nop 0
    s_cmp_lg_u32 s12, 0
    s_cbranch_scc1 L_oadone
    s_branch L_oaset
L_oalead:
    v_mov_b32 v2, 162064
    s_mov_b32 s82, 262144
L_ls60:
    ds_read_b32 v3, v2
    s_waitcnt lgkmcnt(0)
    v_readfirstlane_b32 s12, v3
    s_nop 0
    s_cmp_ge_u32 s12, 12
    s_cbranch_scc1 L_lo61
    s_sleep 1
    s_sub_u32 s82, s82, 1
    s_cbranch_scc0 L_ls60
L_lo61:
    ds_read_b128 v[96:99], v6 offset:0
    ds_read_b128 v[100:103], v6 offset:32
    ds_read_b128 v[104:107], v6 offset:64
    v_lshlrev_b32 v16, 5, v1
    s_lshl_b32 s13, s6, 11
    s_add_u32 s13, s13, 16384
    s_mov_b32 s82, 262144
L_pl62:
    buffer_load_dword v17, v16, s[60:63], s13 offen sc1
    s_waitcnt vmcnt(0)
    v_cmp_ne_u32 vcc, s9, v17
    s_nop 0
    s_cmp_eq_u64 vcc, 0
    s_cbranch_scc1 L_po63
    s_sleep 8
    s_sub_u32 s82, s82, 1
    s_cbranch_scc0 L_pl62
L_po63:
    s_lshl_b32 s12, s10, 2
    s_add_u32 s12, s12, 162464
    v_mov_b32 v16, s12
    v_min_u32 v19, 19, v1
    v_lshlrev_b32 v19, 9, v19
    s_mov_b32 s82, 262144
L_ot64:
    buffer_load_dword v17, v19, s[60:63], s68 offen sc1
    s_waitcnt vmcnt(0) lgkmcnt(0)
    v_cmp_eq_u32 vcc, -1, v17
    s_cbranch_vccz L_og65
    s_sleep 4
    s_sub_u32 s82, s82, 1
    s_cbranch_scc0 L_ot64
L_og65:
    s_add_u32 s13, s68, 2560
    s_add_u32 s14, s68, 5120
    s_add_u32 s12, s68, 7680
    buffer_load_dwordx4 v[16:19], v4, s[60:63], s68 offen offset:0 sc1
    buffer_load_dwordx4 v[20:23], v4, s[60:63], s68 offen offset:1024 sc1
    buffer_load_dwordx4 v[24:27], v15, s[60:63], s68 offen offset:2048 sc1
    buffer_load_dwordx4 v[28:31], v14, s[60:63], s13 offen offset:0 sc1
    buffer_load_dwordx4 v[32:35], v14, s[60:63], s13 offen offset:1024 sc1
    buffer_load_dwordx4 v[36:39], v11, s[60:63], s13 offen offset:2048 sc1
    buffer_load_dwordx4 v[40:43], v4, s[60:63], s14 offen offset:0 sc1
    buffer_load_dwordx4 v[44:47], v4, s[60:63], s14 offen offset:1024 sc1
    buffer_load_dwordx4 v[48:51], v15, s[60:63], s14 offen offset:2048 sc1
    buffer_load_dwordx4 v[52:55], v14, s[60:63], s12 offen offset:0 sc1
    buffer_load_dwordx4 v[56:59], v14, s[60:63], s12 offen offset:1024 sc1
    buffer_load_dwordx4 v[60:63], v11, s[60:63], s12 offen offset:2048 sc1
    s_branch L_oajob
L_oadone:
    s_mov_b32 s13, s24
    s_lshl_b32 s13, s13, 9
    s_add_u32 s13, s13, 4096
    v_min_u32 v4, 17, v1
    v_lshlrev_b32 v4, 4, v4
    s_mov_b32 s77, 0
    s_mov_b32 s82, 262144
L_pl66:
    buffer_load_dword v5, v4, s[60:63], s13 offen sc1
    s_waitcnt vmcnt(0)
    v_cmp_ne_u32 vcc, s9, v5
    s_nop 0
    s_cmp_eq_u64 vcc, 0
    s_cbranch_scc1 L_po67
    s_sleep 4
    s_sub_u32 s82, s82, 1
    s_cbranch_scc0 L_pl66
L_po67:
    s_cmp_eq_u32 s7, 1
    s_cbranch_scc1 L_wf68
    v_mov_b32 v2, 162140
    s_mov_b32 s82, 262144
L_ls69:
    ds_read_b32 v3, v2
    s_waitcnt lgkmcnt(0)
    v_readfirstlane_b32 s12, v3
    s_nop 0
    s_cmp_ge_u32 s12, 4
    s_cbranch_scc1 L_lo70
    s_sleep 4
    s_sub_u32 s82, s82, 1
    s_cbranch_scc0 L_ls69
L_lo70:
L_wf68:
    v_mov_b32 v2, 162052
    s_mov_b32 s82, 262144
L_ls71:
    ds_read_b32 v3, v2
    s_waitcnt lgkmcnt(0)
    v_readfirstlane_b32 s12, v3
    s_nop 0
    s_cmp_ge_u32 s12, 4
    s_cbranch_scc1 L_lo72
    s_sleep 4
    s_sub_u32 s82, s82, 1
    s_cbranch_scc0 L_ls71
L_lo72:
    s_mov_b32 s12, s24
    s_mul_i32 s12, s12, 92160
    s_add_u32 s12, s12, 8912896
    s_mul_i32 s13, s10, 10240
    s_add_u32 s13, s13, s12
    s_lshl_b32 s15, s10, 1
    s_sub_u32 s14, s15, s80
    s_cselect_b32 s3, 9, 0
    s_add_u32 s14, s14, s3
    s_mul_i32 s14, s14, 5120
    s_add_u32 m0, s14, 0
    s_nop 0
    buffer_load_dwordx4 v253, s[60:63], s13 offen offset:0 sc1 lds
    buffer_load_dwordx4 v253, s[60:63], s13 offen offset:1024 sc1 lds
    buffer_load_dwordx4 v253, s[60:63], s13 offen offset:2048 sc1 lds
    buffer_load_dwordx4 v253, s[60:63], s13 offen offset:3072 sc1 lds
    s_cmp_ge_u32 s24, 8
    s_cbranch_scc1 L_w473
    s_add_u32 m0, s14, 1024
    s_add_u32 s3, s13, 1024
    buffer_load_dwordx4 v253, s[60:63], s3 offen offset:3072 sc1 lds
L_w473:
    s_add_u32 s13, s13, 5120
    s_add_u32 s15, s15, 1
    s_sub_u32 s14, s15, s80
    s_cselect_b32 s3, 9, 0
    s_add_u32 s14, s14, s3
    s_mul_i32 s14, s14, 5120
    s_add_u32 m0, s14, 0
    s_nop 0
    buffer_load_dwordx4 v253, s[60:63], s13 offen offset:0 sc1 lds
    buffer_load_dwordx4 v253, s[60:63], s13 offen offset:1024 sc1 lds
    buffer_load_dwordx4 v253, s[60:63], s13 offen offset:2048 sc1 lds
    buffer_load_dwordx4 v253, s[60:63], s13 offen offset:3072 sc1 lds
    s_cmp_ge_u32 s24, 8
    s_cbranch_scc1 L_w474
    s_add_u32 m0, s14, 1024
    s_add_u32 s3, s13, 1024
    buffer_load_dwordx4 v253, s[60:63], s3 offen offset:3072 sc1 lds
L_w474:
    s_sub_u32 s14, 8, s80
    s_cselect_b32 s3, 9, 0
    s_add_u32 s14, s14, s3
    s_mul_i32 s14, s14, 5120
    s_add_u32 s13, s12, 40960
    s_cmp_lg_u32 s10, 0
    s_cbranch_scc1 L_we75
    s_cmp_ge_u32 s24, 8
    s_cbranch_scc1 L_w476
    s_add_u32 m0, s14, 1024
    s_add_u32 s3, s13, 1024
    buffer_load_dwordx4 v253, s[60:63], s3 offen offset:3072 sc1 lds
L_w476:
L_we75:
    s_lshl_b32 s3, s10, 10
    s_add_u32 s13, s13, s3
    s_add_u32 s14, s14, s3
    s_add_u32 m0, s14, 0
    s_nop 0
    buffer_load_dwordx4 v253, s[60:63], s13 offen offset:0 sc1 lds
    s_mov_b32 s75, s4
    s_lshl_b32 s12, s5, 3
    s_add_u32 s13, s12, s75
    s_add_u32 s12, s12, s4
    s_mul_i32 s72, s12, 36864
    s_add_u32 s72, s72, 3164160
    s_mul_i32 s13, s13, 36864
    s_add_u32 s13, s13, 3164160
    s_lshl_b32 s74, s8, 7
    s_add_u32 s74, s74, s13
    s_add_u32 s74, s74, 16384
    s_lshl_b32 s73, s8, 10
    s_add_u32 s73, s73, s13
    s_mul_i32 s76, s12, 18432
    s_min_u32 s14, s24, 8
    s_lshl_b32 s14, s14, 4
    s_lshl_b32 s13, s24, 6
    s_add_u32 s13, s13, s14
    s_add_u32 s76, s76, s13
    s_mul_i32 s12, s75, 10240
    s_add_u32 s12, s12, 79872
    v_lshl_add_u32 v242, v1, 3, s12
    s_lshl_b32 s13, s75, 5
    s_add_u32 s13, s13, 162320
    v_and_b32 v243, 3, v1
    v_lshl_add_u32 v243, v243, 2, s13
    s_lshl_b32 s13, s75, 6
    s_add_u32 s13, s13, 74240
    v_add_u32 v255, s13, v254
    ds_read_b32 v255, v255
    s_sub_u32 s15, s72, 18432
    s_mov_b32 s3, s80
    s_lshl_b32 s44, s3, 11
    s_add_u32 s44, s44, s15
    s_add_u32 s3, s3, 1
    s_cmp_eq_u32 s3, 9
    s_cselect_b32 s3, 0, s3
    s_lshl_b32 s45, s3, 11
    s_add_u32 s45, s45, s15
    s_add_u32 s3, s3, 1
    s_cmp_eq_u32 s3, 9
    s_cselect_b32 s3, 0, s3
    s_lshl_b32 s46, s3, 11
    s_add_u32 s46, s46, s15
    s_add_u32 s3, s3, 1
    s_cmp_eq_u32 s3, 9
    s_cselect_b32 s3, 0, s3
    s_lshl_b32 s47, s3, 11
    s_add_u32 s47, s47, s15
    s_add_u32 s3, s3, 1
    s_cmp_eq_u32 s3, 9
    s_cselect_b32 s3, 0, s3
    s_lshl_b32 s48, s3, 11
    s_add_u32 s48, s48, s15
    s_add_u32 s3, s3, 1
    s_cmp_eq_u32 s3, 9
    s_cselect_b32 s3, 0, s3
    s_lshl_b32 s49, s3, 11
    s_add_u32 s49, s49, s15
    s_add_u32 s3, s3, 1
    s_cmp_eq_u32 s3, 9
    s_cselect_b32 s3, 0, s3
    s_lshl_b32 s50, s3, 11
    s_add_u32 s50, s50, s15
    s_add_u32 s3, s3, 1
    s_cmp_eq_u32 s3, 9
    s_cselect_b32 s3, 0, s3
    s_lshl_b32 s51, s3, 11
    s_add_u32 s51, s51, s15
    s_add_u32 s3, s3, 1
    s_cmp_eq_u32 s3, 9
    s_cselect_b32 s3, 0, s3
    s_lshl_b32 s52, s3, 11
    s_add_u32 s52, s52, s15
    s_add_u32 s53, s72, 4096
    s_add_u32 s54, s72, 8192
    s_add_u32 s55, s72, 12288
    s_add_u32 s43, s72, 16384
    s_lshl_b32 s13, s5, 10
    s_add_u32 s13, s13, 32768
    v_and_b32 v4, 7, v1
    v_lshlrev_b32 v4, 7, v4
    s_mov_b32 s82, 262144
L_pl77:
    buffer_load_dword v5, v4, s[60:63], s13 offen sc1
    s_waitcnt vmcnt(0)
    v_cmp_ne_u32 vcc, s9, v5
    s_nop 0
    s_cmp_eq_u64 vcc, 0
    s_cbranch_scc1 L_po78
    s_sleep 4
    s_sub_u32 s82, s82, 1
    s_cbranch_scc0 L_pl77
L_po78:
    v_mov_b32 v2, 162056
    v_mov_b32 v3, 1
    s_mov_b64 exec, 1
    ds_add_u32 v2, v3
    s_mov_b64 exec, -1
    s_or_b32 s12, s2, s4
    s_cmp_lg_u32 s12, 0
    s_cbranch_scc1 L_g079
    v_lshlrev_b32 v4, 7, v1
    s_mov_b32 s13, 32768
    s_mov_b32 s82, 262144
L_pl80:
    buffer_load_dword v5, v4, s[60:63], s13 offen sc1
    s_waitcnt vmcnt(0)
    v_cmp_ne_u32 vcc, s9, v5
    s_nop 0
    s_cmp_eq_u64 vcc, 0
    s_cbranch_scc1 L_po81
    s_sleep 4
    s_sub_u32 s82, s82, 1
    s_cbranch_scc0 L_pl80
L_po81:
    s_add_u32 s13, s13, 8192
    s_mov_b32 s82, 262144
L_pl82:
    buffer_load_dword v5, v4, s[60:63], s13 offen sc1
    s_waitcnt vmcnt(0)
    v_cmp_ne_u32 vcc, s9, v5
    s_nop 0
    s_cmp_eq_u64 vcc, 0
    s_cbranch_scc1 L_po83
    s_sleep 4
    s_sub_u32 s82, s82, 1
    s_cbranch_scc0 L_pl82
L_po83:
L_g079:
    buffer_load_dwordx4 v[16:19], v253, s[60:63], s44 offen offset:0 sc1
    buffer_load_dwordx4 v[20:23], v250, s[60:63], s44 offen offset:0 sc1
    buffer_load_dwordx4 v[24:27], v253, s[60:63], s44 offen offset:1024 sc1
    buffer_load_dwordx4 v[28:31], v250, s[60:63], s44 offen offset:1024 sc1
    buffer_load_dwordx4 v[32:35], v253, s[60:63], s45 offen offset:0 sc1
    buffer_load_dwordx4 v[36:39], v250, s[60:63], s45 offen offset:0 sc1
    buffer_load_dwordx4 v[40:43], v253, s[60:63], s45 offen offset:1024 sc1
    buffer_load_dwordx4 v[44:47], v250, s[60:63], s45 offen offset:1024 sc1
    buffer_load_dwordx4 v[48:51], v253, s[60:63], s46 offen offset:0 sc1
    buffer_load_dwordx4 v[52:55], v250, s[60:63], s46 offen offset:0 sc1
    buffer_load_dwordx4 v[56:59], v253, s[60:63], s46 offen offset:1024 sc1
    buffer_load_dwordx4 v[60:63], v250, s[60:63], s46 offen offset:1024 sc1
    buffer_load_dwordx4 v[64:67], v253, s[60:63], s47 offen offset:0 sc1
    buffer_load_dwordx4 v[68:71], v250, s[60:63], s47 offen offset:0 sc1
    buffer_load_dwordx4 v[72:75], v253, s[60:63], s47 offen offset:1024 sc1
    buffer_load_dwordx4 v[76:79], v250, s[60:63], s47 offen offset:1024 sc1
    buffer_load_dwordx4 v[80:83], v253, s[60:63], s48 offen offset:0 sc1
    buffer_load_dwordx4 v[84:87], v250, s[60:63], s48 offen offset:0 sc1
    buffer_load_dwordx4 v[88:91], v253, s[60:63], s48 offen offset:1024 sc1
    buffer_load_dwordx4 v[92:95], v250, s[60:63], s48 offen offset:1024 sc1
    buffer_load_dwordx4 v[96:99], v253, s[60:63], s49 offen offset:0 sc1
    buffer_load_dwordx4 v[100:103], v250, s[60:63], s49 offen offset:0 sc1
    buffer_load_dwordx4 v[104:107], v253, s[60:63], s49 offen offset:1024 sc1
    buffer_load_dwordx4 v[108:111], v250, s[60:63], s49 offen offset:1024 sc1
    buffer_load_dwordx4 v[112:115], v253, s[60:63], s50 offen offset:0 sc1
    buffer_load_dwordx4 v[116:119], v250, s[60:63], s50 offen offset:0 sc1
    buffer_load_dwordx4 v[120:123], v253, s[60:63], s50 offen offset:1024 sc1
    buffer_load_dwordx4 v[124:127], v250, s[60:63], s50 offen offset:1024 sc1
    buffer_load_dwordx4 v[128:131], v253, s[60:63], s51 offen offset:0 sc1
    buffer_load_dwordx4 v[132:135], v250, s[60:63], s51 offen offset:0 sc1
    buffer_load_dwordx4 v[136:139], v253, s[60:63], s51 offen offset:1024 sc1
    buffer_load_dwordx4 v[140:143], v250, s[60:63], s51 offen offset:1024 sc1
    buffer_load_dwordx4 v[144:147], v253, s[60:63], s52 offen offset:0 sc1
    buffer_load_dwordx4 v[148:151], v250, s[60:63], s52 offen offset:0 sc1
    buffer_load_dwordx4 v[152:155], v253, s[60:63], s52 offen offset:1024 sc1
    buffer_load_dwordx4 v[156:159], v250, s[60:63], s52 offen offset:1024 sc1
    s_mov_b32 s82, 262144
L_fsp0:
    ds_read_b32 v9, v243
    s_waitcnt lgkmcnt(0)
    v_cmp_eq_u32 vcc, 0, v9
    s_cbranch_vccz L_final
    s_sleep 4
    s_sub_u32 s82, s82, 1
    s_cbranch_scc0 L_fsp0
L_final:
    s_mov_b32 s82, 262144
L_fsp:
    ds_read_b32 v9, v243
    ds_read2st64_b64 v[160:163], v242 offset0:0 offset1:1
    ds_read2st64_b64 v[164:167], v242 offset0:2 offset1:3
    ds_read2st64_b64 v[168:171], v242 offset0:4 offset1:4
    ds_read2st64_b64 v[172:175], v242 offset0:5 offset1:6
    ds_read2st64_b64 v[176:179], v242 offset0:7 offset1:8
    ds_read2st64_b64 v[180:183], v242 offset0:9 offset1:9
    ds_read2st64_b64 v[184:187], v242 offset0:10 offset1:11
    ds_read2st64_b64 v[188:191], v242 offset0:12 offset1:13
    ds_read2st64_b64 v[192:195], v242 offset0:14 offset1:14
    ds_read2st64_b64 v[196:199], v242 offset0:15 offset1:16
    ds_read2st64_b64 v[200:203], v242 offset0:17 offset1:18
    ds_read2st64_b64 v[204:207], v242 offset0:19 offset1:19
    s_waitcnt lgkmcnt(12)
    v_cmp_eq_u32 vcc, 0, v9
    s_cbranch_vccz L_fok
    s_waitcnt lgkmcnt(0)
    s_sub_u32 s82, s82, 1
    s_cbranch_scc0 L_fsp
L_fok:
    s_waitcnt lgkmcnt(6)
    v_add_f32 v160, v160, v172
    v_add_f32 v161, v161, v173
    v_add_f32 v162, v162, v174
    v_add_f32 v163, v163, v175
    v_add_f32 v164, v164, v176
    v_add_f32 v165, v165, v177
    v_add_f32 v166, v166, v178
    v_add_f32 v167, v167, v179
    v_add_f32 v168, v168, v180
    v_add_f32 v169, v169, v181
    s_waitcnt lgkmcnt(3)
    v_add_f32 v160, v160, v184
    v_add_f32 v161, v161, v185
    v_add_f32 v162, v162, v186
    v_add_f32 v163, v163, v187
    v_add_f32 v164, v164, v188
    v_add_f32 v165, v165, v189
    v_add_f32 v166, v166, v190
    v_add_f32 v167, v167, v191
    v_add_f32 v168, v168, v192
    v_add_f32 v169, v169, v193
    s_waitcnt lgkmcnt(0)
    v_add_f32 v160, v160, v196
    v_add_f32 v161, v161, v197
    v_add_f32 v162, v162, v198
    v_add_f32 v163, v163, v199
    v_add_f32 v164, v164, v200
    v_add_f32 v165, v165, v201
    v_add_f32 v166, v166, v202
    v_add_f32 v167, v167, v203
    v_add_f32 v168, v168, v204
    v_add_f32 v169, v169, v205
    v_mov_b32 v170, v168
    v_mov_b32 v13, v168
    s_nop 1
    v_permlane32_swap_b32 v13, v170
    v_subrev_u32 v9, 0x17800000, v170
    v_rcp_f32 v12, v170
    v_cmp_le_u32 vcc, 0x68000000, v9
    s_cbranch_vccnz L_slow
L_fnorm:
    v_mul_f32 v12, v12, v255
    v_mul_f32 v160, v12, v160
    v_mul_f32 v161, v12, v161
    v_mul_f32 v162, v12, v162
    v_mul_f32 v163, v12, v163
    v_mul_f32 v164, v12, v164
    v_mul_f32 v165, v12, v165
    v_mul_f32 v166, v12, v166
    v_mul_f32 v167, v12, v167
    v_mul_f32 v168, v12, v168
    v_mul_f32 v169, v12, v169
    v_cvt_pk_bf16_f32 v172, v160, v161
    v_cvt_pk_bf16_f32 v173, v162, v163
    v_cvt_pk_bf16_f32 v174, v164, v165
    v_cvt_pk_bf16_f32 v175, v166, v167
    v_cvt_pk_bf16_f32 v176, v168, v169
    buffer_store_dwordx4 v[172:175], v244, s[60:63], s73 offen sc1
    s_mov_b32 exec_hi, 0
    buffer_store_dword v176, v248, s[60:63], s74 offen sc1
    s_mov_b64 exec, -1
    s_cmp_eq_u32 s11, 1
    s_cbranch_scc1 L_ftail2
    s_cmp_eq_u32 s77, 1
    s_cbranch_scc1 L_lead2
    v_mov_b32 v2, 162068
    v_mov_b32 v3, 1
    s_mov_b64 exec, 1
    ds_add_u32 v2, v3
    s_mov_b64 exec, -1
    v_mov_b32 v2, 162068
    s_mov_b32 s82, 262144
L_ls84:
    ds_read_b32 v3, v2
    s_waitcnt lgkmcnt(0)
    v_readfirstlane_b32 s12, v3
    s_nop 0
    s_cmp_ge_u32 s12, 4
    s_cbranch_scc1 L_lo85
    s_sleep 4
    s_sub_u32 s82, s82, 1
    s_cbranch_scc0 L_ls84
L_lo85:
    s_mov_b32 s12, s24
    s_mul_i32 s12, s12, 92160
    s_add_u32 s12, s12, 8958976
    s_mul_i32 s13, s10, 10240
    s_add_u32 s13, s13, s12
    s_lshl_b32 s15, s10, 1
    s_mul_i32 s14, s15, 5120
    s_add_u32 m0, s14, 74752
    s_nop 0
    buffer_load_dwordx4 v253, s[60:63], s13 offen offset:0 sc1 lds
    buffer_load_dwordx4 v253, s[60:63], s13 offen offset:1024 sc1 lds
    buffer_load_dwordx4 v253, s[60:63], s13 offen offset:2048 sc1 lds
    buffer_load_dwordx4 v253, s[60:63], s13 offen offset:3072 sc1 lds
    s_cmp_ge_u32 s24, 8
    s_cbranch_scc1 L_w486
    s_add_u32 m0, s14, 75776
    s_add_u32 s3, s13, 1024
    buffer_load_dwordx4 v253, s[60:63], s3 offen offset:3072 sc1 lds
L_w486:
    s_add_u32 s13, s13, 5120
    s_add_u32 s15, s15, 1
    s_mul_i32 s14, s15, 5120
    s_add_u32 m0, s14, 74752
    s_nop 0
    buffer_load_dwordx4 v253, s[60:63], s13 offen offset:0 sc1 lds
    buffer_load_dwordx4 v253, s[60:63], s13 offen offset:1024 sc1 lds
    buffer_load_dwordx4 v253, s[60:63], s13 offen offset:2048 sc1 lds
    buffer_load_dwordx4 v253, s[60:63], s13 offen offset:3072 sc1 lds
    s_cmp_ge_u32 s24, 8
    s_cbranch_scc1 L_w487
    s_add_u32 m0, s14, 75776
    s_add_u32 s3, s13, 1024
    buffer_load_dwordx4 v253, s[60:63], s3 offen offset:3072 sc1 lds
L_w487:
    s_mov_b32 s14, 40960
    s_add_u32 s13, s12, 40960
    s_cmp_lg_u32 s10, 0
    s_cbranch_scc1 L_we88
    s_cmp_ge_u32 s24, 8
    s_cbranch_scc1 L_w489
    s_add_u32 m0, s14, 75776
    s_add_u32 s3, s13, 1024
    buffer_load_dwordx4 v253, s[60:63], s3 offen offset:3072 sc1 lds
L_w489:
L_we88:
    s_lshl_b32 s3, s10, 10
    s_add_u32 s13, s13, s3
    s_add_u32 s14, s14, s3
    s_add_u32 m0, s14, 74752
    s_nop 0
    buffer_load_dwordx4 v253, s[60:63], s13 offen offset:0 sc1 lds
    s_lshl_b32 s13, s4, 6
    s_add_u32 s13, s13, 74368
    v_add_u32 v255, s13, v254
    ds_read_b32 v255, v255
    v_add_u32 v242, 20480, v242
    v_add_u32 v243, 64, v243
    s_add_u32 s73, s73, 73728
    s_add_u32 s74, s74, 73728
    s_add_u32 s75, s75, 2
    s_mov_b32 s77, 1
    s_waitcnt vmcnt(0)
    v_mov_b32 v2, 162072
    v_mov_b32 v3, 1
    s_mov_b64 exec, 1
    ds_add_u32 v2, v3
    s_mov_b64 exec, -1
    s_mov_b32 s82, 262144
    s_cmp_ge_u32 s4, 2
    s_cbranch_scc1 L_fsp0
    s_branch L_lead3
L_lead2:
    v_mov_b32 v2, 162048
    v_mov_b32 v3, 1
    s_mov_b64 exec, 1
    ds_add_u32 v2, v3
    s_mov_b64 exec, -1
L_lead3:
    buffer_load_dwordx4 v[160:163], v253, s[60:63], s72 offen offset:0 sc1
    buffer_load_dwordx4 v[164:167], v253, s[60:63], s72 offen offset:1024 sc1
    buffer_load_dwordx4 v[168:171], v253, s[60:63], s72 offen offset:2048 sc1
    buffer_load_dwordx4 v[172:175], v253, s[60:63], s72 offen offset:3072 sc1
    buffer_load_dwordx4 v[176:179], v253, s[60:63], s53 offen offset:0 sc1
    buffer_load_dwordx4 v[180:183], v253, s[60:63], s53 offen offset:1024 sc1
    buffer_load_dwordx4 v[184:187], v253, s[60:63], s53 offen offset:2048 sc1
    buffer_load_dwordx4 v[188:191], v253, s[60:63], s53 offen offset:3072 sc1
    v_mov_b32 v2, 162056
    s_mov_b32 s82, 262144
L_ls90:
    ds_read_b32 v3, v2
    s_waitcnt lgkmcnt(0)
    v_readfirstlane_b32 s12, v3
    s_nop 0
    s_cmp_ge_u32 s12, 4
    s_cbranch_scc1 L_lo91
    s_sleep 1
    s_sub_u32 s82, s82, 1
    s_cbranch_scc0 L_ls90
L_lo91:
    s_lshl_b32 s12, s10, 2
    s_cmp_lt_u32 s24, 8
    s_cselect_b32 s13, 6, 6
    s_lshl_b32 s13, s13, 5
    s_add_u32 s12, s12, s13
    s_add_u32 s12, s12, 162320
    v_mov_b32 v2, s12
    s_mov_b32 s82, 262144
L_hs92:
    ds_read_b32 v3, v2
    s_waitcnt lgkmcnt(0)
    v_cmp_eq_u32 vcc, 0, v3
    s_cbranch_vccz L_ho93
    s_sleep 2
    s_sub_u32 s82, s82, 1
    s_cbranch_scc0 L_hs92
L_ho93:
    s_setprio 0
    s_cmp_ge_u32 s24, 8
    s_cbranch_scc1 L_m294
    ds_read_b128 v[192:195], v252 offset:0
    ds_read_b128 v[196:199], v252 offset:1024
    ds_read_b128 v[200:203], v240 offset:4096
    ds_read_b128 v[204:207], v252 offset:2048
    ds_read_b128 v[208:211], v252 offset:3072
    ds_read_b128 v[212:215], v240 offset:4608
    s_waitcnt lgkmcnt(3)
    ds_read_b128 v[4:7], v252 offset:5120
    ds_read_b128 v[8:11], v252 offset:6144
    ds_read_b128 v[12:15], v240 offset:9216
    v_mfma_f32_16x16x32_bf16 v[216:219], v[192:195], v[16:19], 0
    v_mfma_f32_16x16x32_bf16 v[228:231], v[192:195], v[20:23], 0
    v_mfma_f32_16x16x32_bf16 v[220:223], v[196:199], v[16:19], 0
    v_mfma_f32_16x16x32_bf16 v[232:235], v[196:199], v[20:23], 0
    v_mfma_f32_16x16x32_bf16 v[224:227], v[200:203], v[16:19], 0
    v_mfma_f32_16x16x32_bf16 v[236:239], v[200:203], v[20:23], 0
    s_waitcnt lgkmcnt(3)
    ds_read_b128 v[192:195], v252 offset:7168
    ds_read_b128 v[196:199], v252 offset:8192
    ds_read_b128 v[200:203], v240 offset:9728
    v_mfma_f32_16x16x32_bf16 v[216:219], v[204:207], v[24:27], v[216:219]
    v_mfma_f32_16x16x32_bf16 v[228:231], v[204:207], v[28:31], v[228:231]
    v_mfma_f32_16x16x32_bf16 v[220:223], v[208:211], v[24:27], v[220:223]
    v_mfma_f32_16x16x32_bf16 v[232:235], v[208:211], v[28:31], v[232:235]
    v_mfma_f32_16x16x32_bf16 v[224:227], v[212:215], v[24:27], v[224:227]
    v_mfma_f32_16x16x32_bf16 v[236:239], v[212:215], v[28:31], v[236:239]
    s_waitcnt lgkmcnt(3)
    ds_read_b128 v[204:207], v252 offset:10240
    ds_read_b128 v[208:211], v252 offset:11264
    ds_read_b128 v[212:215], v240 offset:14336
    v_mfma_f32_16x16x32_bf16 v[216:219], v[4:7], v[32:35], v[216:219]
    v_mfma_f32_16x16x32_bf16 v[228:231], v[4:7], v[36:39], v[228:231]
    v_mfma_f32_16x16x32_bf16 v[220:223], v[8:11], v[32:35], v[220:223]
    v_mfma_f32_16x16x32_bf16 v[232:235], v[8:11], v[36:39], v[232:235]
    v_mfma_f32_16x16x32_bf16 v[224:227], v[12:15], v[32:35], v[224:227]
    v_mfma_f32_16x16x32_bf16 v[236:239], v[12:15], v[36:39], v[236:239]
    s_waitcnt lgkmcnt(3)
    ds_read_b128 v[4:7], v252 offset:12288
    ds_read_b128 v[8:11], v252 offset:13312
    ds_read_b128 v[12:15], v240 offset:14848
    v_mfma_f32_16x16x32_bf16 v[216:219], v[192:195], v[40:43], v[216:219]
    v_mfma_f32_16x16x32_bf16 v[228:231], v[192:195], v[44:47], v[228:231]
    v_mfma_f32_16x16x32_bf16 v[220:223], v[196:199], v[40:43], v[220:223]
    v_mfma_f32_16x16x32_bf16 v[232:235], v[196:199], v[44:47], v[232:235]
    v_mfma_f32_16x16x32_bf16 v[224:227], v[200:203], v[40:43], v[224:227]
    v_mfma_f32_16x16x32_bf16 v[236:239], v[200:203], v[44:47], v[236:239]
    s_waitcnt lgkmcnt(3)
    ds_read_b128 v[192:195], v252 offset:15360
    ds_read_b128 v[196:199], v252 offset:16384
    ds_read_b128 v[200:203], v240 offset:19456
    v_mfma_f32_16x16x32_bf16 v[216:219], v[204:207], v[48:51], v[216:219]
    v_mfma_f32_16x16x32_bf16 v[228:231], v[204:207], v[52:55], v[228:231]
    v_mfma_f32_16x16x32_bf16 v[220:223], v[208:211], v[48:51], v[220:223]
    v_mfma_f32_16x16x32_bf16 v[232:235], v[208:211], v[52:55], v[232:235]
    v_mfma_f32_16x16x32_bf16 v[224:227], v[212:215], v[48:51], v[224:227]
    v_mfma_f32_16x16x32_bf16 v[236:239], v[212:215], v[52:55], v[236:239]
    buffer_load_dwordx4 v[16:19], v253, s[60:63], s54 offen offset:0 sc1
    buffer_load_dwordx4 v[20:23], v253, s[60:63], s54 offen offset:1024 sc1
    buffer_load_dwordx4 v[24:27], v253, s[60:63], s54 offen offset:2048 sc1
    buffer_load_dwordx4 v[28:31], v253, s[60:63], s54 offen offset:3072 sc1
    buffer_load_dwordx4 v[32:35], v253, s[60:63], s55 offen offset:0 sc1
    buffer_load_dwordx4 v[36:39], v253, s[60:63], s55 offen offset:1024 sc1
    buffer_load_dwordx4 v[40:43], v253, s[60:63], s55 offen offset:2048 sc1
    buffer_load_dwordx4 v[44:47], v253, s[60:63], s55 offen offset:3072 sc1
    buffer_load_dwordx2 v[48:49], v251, s[60:63], s43 offen offset:0 sc1
    buffer_load_dwordx2 v[50:51], v251, s[60:63], s43 offen offset:128 sc1
    buffer_load_dwordx2 v[52:53], v251, s[60:63], s43 offen offset:1024 sc1
    buffer_load_dwordx2 v[54:55], v251, s[60:63], s43 offen offset:1152 sc1
    s_waitcnt lgkmcnt(3)
    ds_read_b128 v[204:207], v252 offset:17408
    ds_read_b128 v[208:211], v252 offset:18432
    ds_read_b128 v[212:215], v240 offset:19968
    v_mfma_f32_16x16x32_bf16 v[216:219], v[4:7], v[56:59], v[216:219]
    v_mfma_f32_16x16x32_bf16 v[228:231], v[4:7], v[60:63], v[228:231]
    v_mfma_f32_16x16x32_bf16 v[220:223], v[8:11], v[56:59], v[220:223]
    v_mfma_f32_16x16x32_bf16 v[232:235], v[8:11], v[60:63], v[232:235]
    v_mfma_f32_16x16x32_bf16 v[224:227], v[12:15], v[56:59], v[224:227]
    v_mfma_f32_16x16x32_bf16 v[236:239], v[12:15], v[60:63], v[236:239]
    s_waitcnt lgkmcnt(3)
    ds_read_b128 v[4:7], v252 offset:20480
    ds_read_b128 v[8:11], v252 offset:21504
    ds_read_b128 v[12:15], v240 offset:24576
    v_mfma_f32_16x16x32_bf16 v[216:219], v[192:195], v[64:67], v[216:219]
    v_mfma_f32_16x16x32_bf16 v[228:231], v[192:195], v[68:71], v[228:231]
    v_mfma_f32_16x16x32_bf16 v[220:223], v[196:199], v[64:67], v[220:223]
    v_mfma_f32_16x16x32_bf16 v[232:235], v[196:199], v[68:71], v[232:235]
    v_mfma_f32_16x16x32_bf16 v[224:227], v[200:203], v[64:67], v[224:227]
    v_mfma_f32_16x16x32_bf16 v[236:239], v[200:203], v[68:71], v[236:239]
    s_waitcnt lgkmcnt(3)
    ds_read_b128 v[192:195], v252 offset:22528
    ds_read_b128 v[196:199], v252 offset:23552
    ds_read_b128 v[200:203], v240 offset:25088
    v_mfma_f32_16x16x32_bf16 v[216:219], v[204:207], v[72:75], v[216:219]
    v_mfma_f32_16x16x32_bf16 v[228:231], v[204:207], v[76:79], v[228:231]
    v_mfma_f32_16x16x32_bf16 v[220:223], v[208:211], v[72:75], v[220:223]
    v_mfma_f32_16x16x32_bf16 v[232:235], v[208:211], v[76:79], v[232:235]
    v_mfma_f32_16x16x32_bf16 v[224:227], v[212:215], v[72:75], v[224:227]
    v_mfma_f32_16x16x32_bf16 v[236:239], v[212:215], v[76:79], v[236:239]
    s_waitcnt lgkmcnt(3)
    ds_read_b128 v[204:207], v252 offset:25600
    ds_read_b128 v[208:211], v252 offset:26624
    ds_read_b128 v[212:215], v240 offset:29696
    v_mfma_f32_16x16x32_bf16 v[216:219], v[4:7], v[80:83], v[216:219]
    v_mfma_f32_16x16x32_bf16 v[228:231], v[4:7], v[84:87], v[228:231]
    v_mfma_f32_16x16x32_bf16 v[220:223], v[8:11], v[80:83], v[220:223]
    v_mfma_f32_16x16x32_bf16 v[232:235], v[8:11], v[84:87], v[232:235]
    v_mfma_f32_16x16x32_bf16 v[224:227], v[12:15], v[80:83], v[224:227]
    v_mfma_f32_16x16x32_bf16 v[236:239], v[12:15], v[84:87], v[236:239]
    s_waitcnt lgkmcnt(3)
    ds_read_b128 v[4:7], v252 offset:27648
    ds_read_b128 v[8:11], v252 offset:28672
    ds_read_b128 v[12:15], v240 offset:30208
    v_mfma_f32_16x16x32_bf16 v[216:219], v[192:195], v[88:91], v[216:219]
    v_mfma_f32_16x16x32_bf16 v[228:231], v[192:195], v[92:95], v[228:231]
    v_mfma_f32_16x16x32_bf16 v[220:223], v[196:199], v[88:91], v[220:223]
    v_mfma_f32_16x16x32_bf16 v[232:235], v[196:199], v[92:95], v[232:235]
    v_mfma_f32_16x16x32_bf16 v[224:227], v[200:203], v[88:91], v[224:227]
    v_mfma_f32_16x16x32_bf16 v[236:239], v[200:203], v[92:95], v[236:239]
    s_waitcnt lgkmcnt(3)
    ds_read_b128 v[192:195], v252 offset:30720
    ds_read_b128 v[196:199], v252 offset:31744
    ds_read_b128 v[200:203], v240 offset:34816
    v_mfma_f32_16x16x32_bf16 v[216:219], v[204:207], v[96:99], v[216:219]
    v_mfma_f32_16x16x32_bf16 v[228:231], v[204:207], v[100:103], v[228:231]
    v_mfma_f32_16x16x32_bf16 v[220:223], v[208:211], v[96:99], v[220:223]
    v_mfma_f32_16x16x32_bf16 v[232:235], v[208:211], v[100:103], v[232:235]
    v_mfma_f32_16x16x32_bf16 v[224:227], v[212:215], v[96:99], v[224:227]
    v_mfma_f32_16x16x32_bf16 v[236:239], v[212:215], v[100:103], v[236:239]
    s_waitcnt lgkmcnt(3)
    ds_read_b128 v[204:207], v252 offset:32768
    ds_read_b128 v[208:211], v252 offset:33792
    ds_read_b128 v[212:215], v240 offset:35328
    v_mfma_f32_16x16x32_bf16 v[216:219], v[4:7], v[104:107], v[216:219]
    v_mfma_f32_16x16x32_bf16 v[228:231], v[4:7], v[108:111], v[228:231]
    v_mfma_f32_16x16x32_bf16 v[220:223], v[8:11], v[104:107], v[220:223]
    v_mfma_f32_16x16x32_bf16 v[232:235], v[8:11], v[108:111], v[232:235]
    v_mfma_f32_16x16x32_bf16 v[224:227], v[12:15], v[104:107], v[224:227]
    v_mfma_f32_16x16x32_bf16 v[236:239], v[12:15], v[108:111], v[236:239]
    s_waitcnt lgkmcnt(3)
    ds_read_b128 v[4:7], v252 offset:35840
    ds_read_b128 v[8:11], v252 offset:36864
    ds_read_b128 v[12:15], v240 offset:39936
    v_mfma_f32_16x16x32_bf16 v[216:219], v[192:195], v[112:115], v[216:219]
    v_mfma_f32_16x16x32_bf16 v[228:231], v[192:195], v[116:119], v[228:231]
    v_mfma_f32_16x16x32_bf16 v[220:223], v[196:199], v[112:115], v[220:223]
    v_mfma_f32_16x16x32_bf16 v[232:235], v[196:199], v[116:119], v[232:235]
    v_mfma_f32_16x16x32_bf16 v[224:227], v[200:203], v[112:115], v[224:227]
    v_mfma_f32_16x16x32_bf16 v[236:239], v[200:203], v[116:119], v[236:239]
    s_waitcnt lgkmcnt(3)
    ds_read_b128 v[192:195], v252 offset:37888
    ds_read_b128 v[196:199], v252 offset:38912
    ds_read_b128 v[200:203], v240 offset:40448
    v_mfma_f32_16x16x32_bf16 v[216:219], v[204:207], v[120:123], v[216:219]
    v_mfma_f32_16x16x32_bf16 v[228:231], v[204:207], v[124:127], v[228:231]
    v_mfma_f32_16x16x32_bf16 v[220:223], v[208:211], v[120:123], v[220:223]
    v_mfma_f32_16x16x32_bf16 v[232:235], v[208:211], v[124:127], v[232:235]
    v_mfma_f32_16x16x32_bf16 v[224:227], v[212:215], v[120:123], v[224:227]
    v_mfma_f32_16x16x32_bf16 v[236:239], v[212:215], v[124:127], v[236:239]
    s_waitcnt lgkmcnt(3)
    ds_read_b128 v[204:207], v252 offset:40960
    ds_read_b128 v[208:211], v252 offset:41984
    ds_read_b128 v[212:215], v240 offset:45056
    v_mfma_f32_16x16x32_bf16 v[216:219], v[4:7], v[128:131], v[216:219]
    v_mfma_f32_16x16x32_bf16 v[228:231], v[4:7], v[132:135], v[228:231]
    v_mfma_f32_16x16x32_bf16 v[220:223], v[8:11], v[128:131], v[220:223]
    v_mfma_f32_16x16x32_bf16 v[232:235], v[8:11], v[132:135], v[232:235]
    v_mfma_f32_16x16x32_bf16 v[224:227], v[12:15], v[128:131], v[224:227]
    v_mfma_f32_16x16x32_bf16 v[236:239], v[12:15], v[132:135], v[236:239]
    s_waitcnt lgkmcnt(3)
    ds_read_b128 v[4:7], v252 offset:43008
    ds_read_b128 v[8:11], v252 offset:44032
    ds_read_b128 v[12:15], v240 offset:45568
    v_mfma_f32_16x16x32_bf16 v[216:219], v[192:195], v[136:139], v[216:219]
    v_mfma_f32_16x16x32_bf16 v[228:231], v[192:195], v[140:143], v[228:231]
    v_mfma_f32_16x16x32_bf16 v[220:223], v[196:199], v[136:139], v[220:223]
    v_mfma_f32_16x16x32_bf16 v[232:235], v[196:199], v[140:143], v[232:235]
    v_mfma_f32_16x16x32_bf16 v[224:227], v[200:203], v[136:139], v[224:227]
    v_mfma_f32_16x16x32_bf16 v[236:239], v[200:203], v[140:143], v[236:239]
    s_waitcnt lgkmcnt(3)
    v_mfma_f32_16x16x32_bf16 v[216:219], v[204:207], v[144:147], v[216:219]
    v_mfma_f32_16x16x32_bf16 v[228:231], v[204:207], v[148:151], v[228:231]
    v_mfma_f32_16x16x32_bf16 v[220:223], v[208:211], v[144:147], v[220:223]
    v_mfma_f32_16x16x32_bf16 v[232:235], v[208:211], v[148:151], v[232:235]
    v_mfma_f32_16x16x32_bf16 v[224:227], v[212:215], v[144:147], v[224:227]
    v_mfma_f32_16x16x32_bf16 v[236:239], v[212:215], v[148:151], v[236:239]
    s_waitcnt lgkmcnt(0)
    v_mfma_f32_16x16x32_bf16 v[216:219], v[4:7], v[152:155], v[216:219]
    v_mfma_f32_16x16x32_bf16 v[228:231], v[4:7], v[156:159], v[228:231]
    v_mfma_f32_16x16x32_bf16 v[220:223], v[8:11], v[152:155], v[220:223]
    v_mfma_f32_16x16x32_bf16 v[232:235], v[8:11], v[156:159], v[232:235]
    v_mfma_f32_16x16x32_bf16 v[224:227], v[12:15], v[152:155], v[224:227]
    v_mfma_f32_16x16x32_bf16 v[236:239], v[12:15], v[156:159], v[236:239]
    s_branch L_m295
L_m294:
    ds_read_b128 v[192:195], v252 offset:0
    ds_read_b128 v[196:199], v252 offset:1024
    ds_read_b128 v[204:207], v252 offset:2048
    ds_read_b128 v[208:211], v252 offset:3072
    s_waitcnt lgkmcnt(2)
    ds_read_b128 v[4:7], v252 offset:5120
    ds_read_b128 v[8:11], v252 offset:6144
    v_mfma_f32_16x16x32_bf16 v[216:219], v[192:195], v[16:19], 0
    v_mfma_f32_16x16x32_bf16 v[228:231], v[192:195], v[20:23], 0
    v_mfma_f32_16x16x32_bf16 v[220:223], v[196:199], v[16:19], 0
    v_mfma_f32_16x16x32_bf16 v[232:235], v[196:199], v[20:23], 0
    s_waitcnt lgkmcnt(2)
    ds_read_b128 v[192:195], v252 offset:7168
    ds_read_b128 v[196:199], v252 offset:8192
    v_mfma_f32_16x16x32_bf16 v[216:219], v[204:207], v[24:27], v[216:219]
    v_mfma_f32_16x16x32_bf16 v[228:231], v[204:207], v[28:31], v[228:231]
    v_mfma_f32_16x16x32_bf16 v[220:223], v[208:211], v[24:27], v[220:223]
    v_mfma_f32_16x16x32_bf16 v[232:235], v[208:211], v[28:31], v[232:235]
    s_waitcnt lgkmcnt(2)
    ds_read_b128 v[204:207], v252 offset:10240
    ds_read_b128 v[208:211], v252 offset:11264
    v_mfma_f32_16x16x32_bf16 v[216:219], v[4:7], v[32:35], v[216:219]
    v_mfma_f32_16x16x32_bf16 v[228:231], v[4:7], v[36:39], v[228:231]
    v_mfma_f32_16x16x32_bf16 v[220:223], v[8:11], v[32:35], v[220:223]
    v_mfma_f32_16x16x32_bf16 v[232:235], v[8:11], v[36:39], v[232:235]
    s_waitcnt lgkmcnt(2)
    ds_read_b128 v[4:7], v252 offset:12288
    ds_read_b128 v[8:11], v252 offset:13312
    v_mfma_f32_16x16x32_bf16 v[216:219], v[192:195], v[40:43], v[216:219]
    v_mfma_f32_16x16x32_bf16 v[228:231], v[192:195], v[44:47], v[228:231]
    v_mfma_f32_16x16x32_bf16 v[220:223], v[196:199], v[40:43], v[220:223]
    v_mfma_f32_16x16x32_bf16 v[232:235], v[196:199], v[44:47], v[232:235]
    s_waitcnt lgkmcnt(2)
    ds_read_b128 v[192:195], v252 offset:15360
    ds_read_b128 v[196:199], v252 offset:16384
    v_mfma_f32_16x16x32_bf16 v[216:219], v[204:207], v[48:51], v[216:219]
    v_mfma_f32_16x16x32_bf16 v[228:231], v[204:207], v[52:55], v[228:231]
    v_mfma_f32_16x16x32_bf16 v[220:223], v[208:211], v[48:51], v[220:223]
    v_mfma_f32_16x16x32_bf16 v[232:235], v[208:211], v[52:55], v[232:235]
    buffer_load_dwordx4 v[16:19], v253, s[60:63], s54 offen offset:0 sc1
    buffer_load_dwordx4 v[20:23], v253, s[60:63], s54 offen offset:1024 sc1
    buffer_load_dwordx4 v[24:27], v253, s[60:63], s54 offen offset:2048 sc1
    buffer_load_dwordx4 v[28:31], v253, s[60:63], s54 offen offset:3072 sc1
    buffer_load_dwordx4 v[32:35], v253, s[60:63], s55 offen offset:0 sc1
    buffer_load_dwordx4 v[36:39], v253, s[60:63], s55 offen offset:1024 sc1
    buffer_load_dwordx4 v[40:43], v253, s[60:63], s55 offen offset:2048 sc1
    buffer_load_dwordx4 v[44:47], v253, s[60:63], s55 offen offset:3072 sc1
    buffer_load_dwordx2 v[48:49], v251, s[60:63], s43 offen offset:0 sc1
    buffer_load_dwordx2 v[50:51], v251, s[60:63], s43 offen offset:128 sc1
    buffer_load_dwordx2 v[52:53], v251, s[60:63], s43 offen offset:1024 sc1
    buffer_load_dwordx2 v[54:55], v251, s[60:63], s43 offen offset:1152 sc1
    s_waitcnt lgkmcnt(2)
    ds_read_b128 v[204:207], v252 offset:17408
    ds_read_b128 v[208:211], v252 offset:18432
    v_mfma_f32_16x16x32_bf16 v[216:219], v[4:7], v[56:59], v[216:219]
    v_mfma_f32_16x16x32_bf16 v[228:231], v[4:7], v[60:63], v[228:231]
    v_mfma_f32_16x16x32_bf16 v[220:223], v[8:11], v[56:59], v[220:223]
    v_mfma_f32_16x16x32_bf16 v[232:235], v[8:11], v[60:63], v[232:235]
    s_waitcnt lgkmcnt(2)
    ds_read_b128 v[4:7], v252 offset:20480
    ds_read_b128 v[8:11], v252 offset:21504
    v_mfma_f32_16x16x32_bf16 v[216:219], v[192:195], v[64:67], v[216:219]
    v_mfma_f32_16x16x32_bf16 v[228:231], v[192:195], v[68:71], v[228:231]
    v_mfma_f32_16x16x32_bf16 v[220:223], v[196:199], v[64:67], v[220:223]
    v_mfma_f32_16x16x32_bf16 v[232:235], v[196:199], v[68:71], v[232:235]
    s_waitcnt lgkmcnt(2)
    ds_read_b128 v[192:195], v252 offset:22528
    ds_read_b128 v[196:199], v252 offset:23552
    v_mfma_f32_16x16x32_bf16 v[216:219], v[204:207], v[72:75], v[216:219]
    v_mfma_f32_16x16x32_bf16 v[228:231], v[204:207], v[76:79], v[228:231]
    v_mfma_f32_16x16x32_bf16 v[220:223], v[208:211], v[72:75], v[220:223]
    v_mfma_f32_16x16x32_bf16 v[232:235], v[208:211], v[76:79], v[232:235]
    s_waitcnt lgkmcnt(2)
    ds_read_b128 v[204:207], v252 offset:25600
    ds_read_b128 v[208:211], v252 offset:26624
    v_mfma_f32_16x16x32_bf16 v[216:219], v[4:7], v[80:83], v[216:219]
    v_mfma_f32_16x16x32_bf16 v[228:231], v[4:7], v[84:87], v[228:231]
    v_mfma_f32_16x16x32_bf16 v[220:223], v[8:11], v[80:83], v[220:223]
    v_mfma_f32_16x16x32_bf16 v[232:235], v[8:11], v[84:87], v[232:235]
    s_waitcnt lgkmcnt(2)
    ds_read_b128 v[4:7], v252 offset:27648
    ds_read_b128 v[8:11], v252 offset:28672
    v_mfma_f32_16x16x32_bf16 v[216:219], v[192:195], v[88:91], v[216:219]
    v_mfma_f32_16x16x32_bf16 v[228:231], v[192:195], v[92:95], v[228:231]
    v_mfma_f32_16x16x32_bf16 v[220:223], v[196:199], v[88:91], v[220:223]
    v_mfma_f32_16x16x32_bf16 v[232:235], v[196:199], v[92:95], v[232:235]
    s_waitcnt lgkmcnt(2)
    ds_read_b128 v[192:195], v252 offset:30720
    ds_read_b128 v[196:199], v252 offset:31744
    v_mfma_f32_16x16x32_bf16 v[216:219], v[204:207], v[96:99], v[216:219]
    v_mfma_f32_16x16x32_bf16 v[228:231], v[204:207], v[100:103], v[228:231]
    v_mfma_f32_16x16x32_bf16 v[220:223], v[208:211], v[96:99], v[220:223]
    v_mfma_f32_16x16x32_bf16 v[232:235], v[208:211], v[100:103], v[232:235]
    s_waitcnt lgkmcnt(2)
    ds_read_b128 v[204:207], v252 offset:32768
    ds_read_b128 v[208:211], v252 offset:33792
    v_mfma_f32_16x16x32_bf16 v[216:219], v[4:7], v[104:107], v[216:219]
    v_mfma_f32_16x16x32_bf16 v[228:231], v[4:7], v[108:111], v[228:231]
    v_mfma_f32_16x16x32_bf16 v[220:223], v[8:11], v[104:107], v[220:223]
    v_mfma_f32_16x16x32_bf16 v[232:235], v[8:11], v[108:111], v[232:235]
    s_waitcnt lgkmcnt(2)
    ds_read_b128 v[4:7], v252 offset:35840
    ds_read_b128 v[8:11], v252 offset:36864
    v_mfma_f32_16x16x32_bf16 v[216:219], v[192:195], v[112:115], v[216:219]
    v_mfma_f32_16x16x32_bf16 v[228:231], v[192:195], v[116:119], v[228:231]
    v_mfma_f32_16x16x32_bf16 v[220:223], v[196:199], v[112:115], v[220:223]
    v_mfma_f32_16x16x32_bf16 v[232:235], v[196:199], v[116:119], v[232:235]
    s_waitcnt lgkmcnt(2)
    ds_read_b128 v[192:195], v252 offset:37888
    ds_read_b128 v[196:199], v252 offset:38912
    v_mfma_f32_16x16x32_bf16 v[216:219], v[204:207], v[120:123], v[216:219]
    v_mfma_f32_16x16x32_bf16 v[228:231], v[204:207], v[124:127], v[228:231]
    v_mfma_f32_16x16x32_bf16 v[220:223], v[208:211], v[120:123], v[220:223]
    v_mfma_f32_16x16x32_bf16 v[232:235], v[208:211], v[124:127], v[232:235]
    s_waitcnt lgkmcnt(2)
    ds_read_b128 v[204:207], v252 offset:40960
    ds_read_b128 v[208:211], v252 offset:41984
    v_mfma_f32_16x16x32_bf16 v[216:219], v[4:7], v[128:131], v[216:219]
    v_mfma_f32_16x16x32_bf16 v[228:231], v[4:7], v[132:135], v[228:231]
    v_mfma_f32_16x16x32_bf16 v[220:223], v[8:11], v[128:131], v[220:223]
    v_mfma_f32_16x16x32_bf16 v[232:235], v[8:11], v[132:135], v[232:235]
    s_waitcnt lgkmcnt(2)
    ds_read_b128 v[4:7], v252 offset:43008
    ds_read_b128 v[8:11], v252 offset:44032
    v_mfma_f32_16x16x32_bf16 v[216:219], v[192:195], v[136:139], v[216:219]
    v_mfma_f32_16x16x32_bf16 v[228:231], v[192:195], v[140:143], v[228:231]
    v_mfma_f32_16x16x32_bf16 v[220:223], v[196:199], v[136:139], v[220:223]
    v_mfma_f32_16x16x32_bf16 v[232:235], v[196:199], v[140:143], v[232:235]
    s_waitcnt lgkmcnt(2)
    v_mfma_f32_16x16x32_bf16 v[216:219], v[204:207], v[144:147], v[216:219]
    v_mfma_f32_16x16x32_bf16 v[228:231], v[204:207], v[148:151], v[228:231]
    v_mfma_f32_16x16x32_bf16 v[220:223], v[208:211], v[144:147], v[220:223]
    v_mfma_f32_16x16x32_bf16 v[232:235], v[208:211], v[148:151], v[232:235]
    s_waitcnt lgkmcnt(0)
    v_mfma_f32_16x16x32_bf16 v[216:219], v[4:7], v[152:155], v[216:219]
    v_mfma_f32_16x16x32_bf16 v[228:231], v[4:7], v[156:159], v[228:231]
    v_mfma_f32_16x16x32_bf16 v[220:223], v[8:11], v[152:155], v[220:223]
    v_mfma_f32_16x16x32_bf16 v[232:235], v[8:11], v[156:159], v[232:235]
L_m295:
    s_mul_i32 s12, s10, 3072
    s_add_u32 s12, s12, 49152
    v_add_u32 v100, s12, v253
    s_lshl_b32 s12, s10, 2
    s_add_u32 s12, s12, 162080
    v_mov_b32 v101, s12
    v_add_u32 v252, 74752, v252
    v_add_u32 v240, 74752, v240
    ds_write_b128 v100, v[228:231] offset:0
    ds_write_b128 v100, v[232:235] offset:1024
    ds_write_b128 v100, v[236:239] offset:2048
    ds_write_b32 v101, v101
    v_mov_b32 v2, 162072
    s_mov_b32 s82, 262144
L_ls96:
    ds_read_b32 v3, v2
    s_waitcnt lgkmcnt(0)
    v_readfirstlane_b32 s12, v3
    s_nop 0
    s_cmp_ge_u32 s12, 4
    s_cbranch_scc1 L_lo97
    s_sleep 1
    s_sub_u32 s82, s82, 1
    s_cbranch_scc0 L_ls96
L_lo97:
    s_mov_b32 s68, s36
    s_mov_b32 s69, s37
    s_mov_b32 s70, 2359296
    s_mov_b32 s71, 0x00020000
    ds_read_b128 v[192:195], v252 offset:0
    ds_read_b128 v[196:199], v252 offset:1024
    ds_read_b128 v[200:203], v240 offset:4096
    ds_read_b128 v[204:207], v252 offset:2048
    ds_read_b128 v[208:211], v252 offset:3072
    ds_read_b128 v[212:215], v240 offset:4608
    s_mov_b32 s82, 262144
L_lck:
    s_waitcnt vmcnt(0)
    v_max3_u32 v7, v163, v167, v171
    v_max3_u32 v7, v7, v175, v179
    v_max3_u32 v7, v7, v183, v187
    v_max3_u32 v7, v7, v191, v19
    v_max3_u32 v7, v7, v23, v27
    v_max3_u32 v7, v7, v31, v35
    v_max3_u32 v7, v7, v39, v43
    v_max3_u32 v7, v7, v47, v48
    v_max3_u32 v7, v7, v49, v50
    v_max3_u32 v7, v7, v51, v52
    v_max3_u32 v7, v7, v53, v54
    v_max3_u32 v7, v7, v55, v163
    v_cmp_eq_u32 vcc, -1, v7
    s_cbranch_vccz L_lgo
    s_sub_u32 s82, s82, 1
    s_cbranch_scc1 L_lgo
    s_sleep 2
    buffer_load_dwordx4 v[160:163], v253, s[60:63], s72 offen offset:0 sc1
    buffer_load_dwordx4 v[164:167], v253, s[60:63], s72 offen offset:1024 sc1
    buffer_load_dwordx4 v[168:171], v253, s[60:63], s72 offen offset:2048 sc1
    buffer_load_dwordx4 v[172:175], v253, s[60:63], s72 offen offset:3072 sc1
    buffer_load_dwordx4 v[176:179], v253, s[60:63], s53 offen offset:0 sc1
    buffer_load_dwordx4 v[180:183], v253, s[60:63], s53 offen offset:1024 sc1
    buffer_load_dwordx4 v[184:187], v253, s[60:63], s53 offen offset:2048 sc1
    buffer_load_dwordx4 v[188:191], v253, s[60:63], s53 offen offset:3072 sc1
    buffer_load_dwordx4 v[16:19], v253, s[60:63], s54 offen offset:0 sc1
    buffer_load_dwordx4 v[20:23], v253, s[60:63], s54 offen offset:1024 sc1
    buffer_load_dwordx4 v[24:27], v253, s[60:63], s54 offen offset:2048 sc1
    buffer_load_dwordx4 v[28:31], v253, s[60:63], s54 offen offset:3072 sc1
    buffer_load_dwordx4 v[32:35], v253, s[60:63], s55 offen offset:0 sc1
    buffer_load_dwordx4 v[36:39], v253, s[60:63], s55 offen offset:1024 sc1
    buffer_load_dwordx4 v[40:43], v253, s[60:63], s55 offen offset:2048 sc1
    buffer_load_dwordx4 v[44:47], v253, s[60:63], s55 offen offset:3072 sc1
    buffer_load_dwordx2 v[48:49], v251, s[60:63], s43 offen offset:0 sc1
    buffer_load_dwordx2 v[50:51], v251, s[60:63], s43 offen offset:128 sc1
    buffer_load_dwordx2 v[52:53], v251, s[60:63], s43 offen offset:1024 sc1
    buffer_load_dwordx2 v[54:55], v251, s[60:63], s43 offen offset:1152 sc1
    s_branch L_lck
L_lgo:
    s_cmp_ge_u32 s24, 8
    s_cbranch_scc1 L_m298
    s_waitcnt lgkmcnt(3)
    ds_read_b128 v[104:107], v252 offset:5120
    ds_read_b128 v[108:111], v252 offset:6144
    ds_read_b128 v[112:115], v240 offset:9216
    v_mfma_f32_16x16x32_bf16 v[216:219], v[192:195], v[160:163], v[216:219]
    v_mfma_f32_16x16x32_bf16 v[220:223], v[196:199], v[160:163], v[220:223]
    v_mfma_f32_16x16x32_bf16 v[224:227], v[200:203], v[160:163], v[224:227]
    s_waitcnt lgkmcnt(3)
    ds_read_b128 v[192:195], v252 offset:7168
    ds_read_b128 v[196:199], v252 offset:8192
    ds_read_b128 v[200:203], v240 offset:9728
    v_mfma_f32_16x16x32_bf16 v[216:219], v[204:207], v[164:167], v[216:219]
    v_mfma_f32_16x16x32_bf16 v[220:223], v[208:211], v[164:167], v[220:223]
    v_mfma_f32_16x16x32_bf16 v[224:227], v[212:215], v[164:167], v[224:227]
    s_waitcnt lgkmcnt(3)
    ds_read_b128 v[204:207], v252 offset:10240
    ds_read_b128 v[208:211], v252 offset:11264
    ds_read_b128 v[212:215], v240 offset:14336
    v_mfma_f32_16x16x32_bf16 v[216:219], v[104:107], v[168:171], v[216:219]
    v_mfma_f32_16x16x32_bf16 v[220:223], v[108:111], v[168:171], v[220:223]
    v_mfma_f32_16x16x32_bf16 v[224:227], v[112:115], v[168:171], v[224:227]
    s_waitcnt lgkmcnt(3)
    ds_read_b128 v[104:107], v252 offset:12288
    ds_read_b128 v[108:111], v252 offset:13312
    ds_read_b128 v[112:115], v240 offset:14848
    v_mfma_f32_16x16x32_bf16 v[216:219], v[192:195], v[172:175], v[216:219]
    v_mfma_f32_16x16x32_bf16 v[220:223], v[196:199], v[172:175], v[220:223]
    v_mfma_f32_16x16x32_bf16 v[224:227], v[200:203], v[172:175], v[224:227]
    s_waitcnt lgkmcnt(3)
    ds_read_b128 v[192:195], v252 offset:15360
    ds_read_b128 v[196:199], v252 offset:16384
    ds_read_b128 v[200:203], v240 offset:19456
    v_mfma_f32_16x16x32_bf16 v[216:219], v[204:207], v[176:179], v[216:219]
    v_mfma_f32_16x16x32_bf16 v[220:223], v[208:211], v[176:179], v[220:223]
    v_mfma_f32_16x16x32_bf16 v[224:227], v[212:215], v[176:179], v[224:227]
    s_waitcnt lgkmcnt(3)
    ds_read_b128 v[204:207], v252 offset:17408
    ds_read_b128 v[208:211], v252 offset:18432
    ds_read_b128 v[212:215], v240 offset:19968
    v_mfma_f32_16x16x32_bf16 v[216:219], v[104:107], v[180:183], v[216:219]
    v_mfma_f32_16x16x32_bf16 v[220:223], v[108:111], v[180:183], v[220:223]
    v_mfma_f32_16x16x32_bf16 v[224:227], v[112:115], v[180:183], v[224:227]
    s_waitcnt lgkmcnt(3)
    ds_read_b128 v[104:107], v252 offset:20480
    ds_read_b128 v[108:111], v252 offset:21504
    ds_read_b128 v[112:115], v240 offset:24576
    v_mfma_f32_16x16x32_bf16 v[216:219], v[192:195], v[184:187], v[216:219]
    v_mfma_f32_16x16x32_bf16 v[220:223], v[196:199], v[184:187], v[220:223]
    v_mfma_f32_16x16x32_bf16 v[224:227], v[200:203], v[184:187], v[224:227]
    s_waitcnt lgkmcnt(3)
    ds_read_b128 v[192:195], v252 offset:22528
    ds_read_b128 v[196:199], v252 offset:23552
    ds_read_b128 v[200:203], v240 offset:25088
    v_mfma_f32_16x16x32_bf16 v[216:219], v[204:207], v[188:191], v[216:219]
    v_mfma_f32_16x16x32_bf16 v[220:223], v[208:211], v[188:191], v[220:223]
    v_mfma_f32_16x16x32_bf16 v[224:227], v[212:215], v[188:191], v[224:227]
    s_waitcnt lgkmcnt(3)
    ds_read_b128 v[204:207], v252 offset:25600
    ds_read_b128 v[208:211], v252 offset:26624
    ds_read_b128 v[212:215], v240 offset:29696
    v_mfma_f32_16x16x32_bf16 v[216:219], v[104:107], v[16:19], v[216:219]
    v_mfma_f32_16x16x32_bf16 v[220:223], v[108:111], v[16:19], v[220:223]
    v_mfma_f32_16x16x32_bf16 v[224:227], v[112:115], v[16:19], v[224:227]
    s_waitcnt lgkmcnt(3)
    ds_read_b128 v[104:107], v252 offset:27648
    ds_read_b128 v[108:111], v252 offset:28672
    ds_read_b128 v[112:115], v240 offset:30208
    v_mfma_f32_16x16x32_bf16 v[216:219], v[192:195], v[20:23], v[216:219]
    v_mfma_f32_16x16x32_bf16 v[220:223], v[196:199], v[20:23], v[220:223]
    v_mfma_f32_16x16x32_bf16 v[224:227], v[200:203], v[20:23], v[224:227]
    s_waitcnt lgkmcnt(3)
    ds_read_b128 v[192:195], v252 offset:30720
    ds_read_b128 v[196:199], v252 offset:31744
    ds_read_b128 v[200:203], v240 offset:34816
    v_mfma_f32_16x16x32_bf16 v[216:219], v[204:207], v[24:27], v[216:219]
    v_mfma_f32_16x16x32_bf16 v[220:223], v[208:211], v[24:27], v[220:223]
    v_mfma_f32_16x16x32_bf16 v[224:227], v[212:215], v[24:27], v[224:227]
    s_waitcnt lgkmcnt(3)
    ds_read_b128 v[204:207], v252 offset:32768
    ds_read_b128 v[208:211], v252 offset:33792
    ds_read_b128 v[212:215], v240 offset:35328
    v_mfma_f32_16x16x32_bf16 v[216:219], v[104:107], v[28:31], v[216:219]
    v_mfma_f32_16x16x32_bf16 v[220:223], v[108:111], v[28:31], v[220:223]
    v_mfma_f32_16x16x32_bf16 v[224:227], v[112:115], v[28:31], v[224:227]
    s_waitcnt lgkmcnt(3)
    ds_read_b128 v[104:107], v252 offset:35840
    ds_read_b128 v[108:111], v252 offset:36864
    ds_read_b128 v[112:115], v240 offset:39936
    v_mfma_f32_16x16x32_bf16 v[216:219], v[192:195], v[32:35], v[216:219]
    v_mfma_f32_16x16x32_bf16 v[220:223], v[196:199], v[32:35], v[220:223]
    v_mfma_f32_16x16x32_bf16 v[224:227], v[200:203], v[32:35], v[224:227]
    s_waitcnt lgkmcnt(3)
    ds_read_b128 v[192:195], v252 offset:37888
    ds_read_b128 v[196:199], v252 offset:38912
    ds_read_b128 v[200:203], v240 offset:40448
    v_mfma_f32_16x16x32_bf16 v[216:219], v[204:207], v[36:39], v[216:219]
    v_mfma_f32_16x16x32_bf16 v[220:223], v[208:211], v[36:39], v[220:223]
    v_mfma_f32_16x16x32_bf16 v[224:227], v[212:215], v[36:39], v[224:227]
    s_waitcnt lgkmcnt(3)
    ds_read_b128 v[204:207], v252 offset:40960
    ds_read_b128 v[208:211], v252 offset:41984
    ds_read_b128 v[212:215], v240 offset:45056
    v_mfma_f32_16x16x32_bf16 v[216:219], v[104:107], v[40:43], v[216:219]
    v_mfma_f32_16x16x32_bf16 v[220:223], v[108:111], v[40:43], v[220:223]
    v_mfma_f32_16x16x32_bf16 v[224:227], v[112:115], v[40:43], v[224:227]
    s_waitcnt lgkmcnt(3)
    ds_read_b128 v[104:107], v252 offset:43008
    ds_read_b128 v[108:111], v252 offset:44032
    ds_read_b128 v[112:115], v240 offset:45568
    v_mfma_f32_16x16x32_bf16 v[216:219], v[192:195], v[44:47], v[216:219]
    v_mfma_f32_16x16x32_bf16 v[220:223], v[196:199], v[44:47], v[220:223]
    v_mfma_f32_16x16x32_bf16 v[224:227], v[200:203], v[44:47], v[224:227]
    s_waitcnt lgkmcnt(3)
    v_mfma_f32_16x16x32_bf16 v[216:219], v[204:207], v[48:51], v[216:219]
    v_mfma_f32_16x16x32_bf16 v[220:223], v[208:211], v[48:51], v[220:223]
    v_mfma_f32_16x16x32_bf16 v[224:227], v[212:215], v[48:51], v[224:227]
    s_waitcnt lgkmcnt(0)
    v_mfma_f32_16x16x32_bf16 v[216:219], v[104:107], v[52:55], v[216:219]
    v_mfma_f32_16x16x32_bf16 v[220:223], v[108:111], v[52:55], v[220:223]
    v_mfma_f32_16x16x32_bf16 v[224:227], v[112:115], v[52:55], v[224:227]
    s_branch L_m299
L_m298:
    s_waitcnt lgkmcnt(2)
    ds_read_b128 v[104:107], v252 offset:5120
    ds_read_b128 v[108:111], v252 offset:6144
    v_mfma_f32_16x16x32_bf16 v[216:219], v[192:195], v[160:163], v[216:219]
    v_mfma_f32_16x16x32_bf16 v[220:223], v[196:199], v[160:163], v[220:223]
    s_waitcnt lgkmcnt(2)
    ds_read_b128 v[192:195], v252 offset:7168
    ds_read_b128 v[196:199], v252 offset:8192
    v_mfma_f32_16x16x32_bf16 v[216:219], v[204:207], v[164:167], v[216:219]
    v_mfma_f32_16x16x32_bf16 v[220:223], v[208:211], v[164:167], v[220:223]
    s_waitcnt lgkmcnt(2)
    ds_read_b128 v[204:207], v252 offset:10240
    ds_read_b128 v[208:211], v252 offset:11264
    v_mfma_f32_16x16x32_bf16 v[216:219], v[104:107], v[168:171], v[216:219]
    v_mfma_f32_16x16x32_bf16 v[220:223], v[108:111], v[168:171], v[220:223]
    s_waitcnt lgkmcnt(2)
    ds_read_b128 v[104:107], v252 offset:12288
    ds_read_b128 v[108:111], v252 offset:13312
    v_mfma_f32_16x16x32_bf16 v[216:219], v[192:195], v[172:175], v[216:219]
    v_mfma_f32_16x16x32_bf16 v[220:223], v[196:199], v[172:175], v[220:223]
    s_waitcnt lgkmcnt(2)
    ds_read_b128 v[192:195], v252 offset:15360
    ds_read_b128 v[196:199], v252 offset:16384
    v_mfma_f32_16x16x32_bf16 v[216:219], v[204:207], v[176:179], v[216:219]
    v_mfma_f32_16x16x32_bf16 v[220:223], v[208:211], v[176:179], v[220:223]
    s_waitcnt lgkmcnt(2)
    ds_read_b128 v[204:207], v252 offset:17408
    ds_read_b128 v[208:211], v252 offset:18432
    v_mfma_f32_16x16x32_bf16 v[216:219], v[104:107], v[180:183], v[216:219]
    v_mfma_f32_16x16x32_bf16 v[220:223], v[108:111], v[180:183], v[220:223]
    s_waitcnt lgkmcnt(2)
    ds_read_b128 v[104:107], v252 offset:20480
    ds_read_b128 v[108:111], v252 offset:21504
    v_mfma_f32_16x16x32_bf16 v[216:219], v[192:195], v[184:187], v[216:219]
    v_mfma_f32_16x16x32_bf16 v[220:223], v[196:199], v[184:187], v[220:223]
    s_waitcnt lgkmcnt(2)
    ds_read_b128 v[192:195], v252 offset:22528
    ds_read_b128 v[196:199], v252 offset:23552
    v_mfma_f32_16x16x32_bf16 v[216:219], v[204:207], v[188:191], v[216:219]
    v_mfma_f32_16x16x32_bf16 v[220:223], v[208:211], v[188:191], v[220:223]
    s_waitcnt lgkmcnt(2)
    ds_read_b128 v[204:207], v252 offset:25600
    ds_read_b128 v[208:211], v252 offset:26624
    v_mfma_f32_16x16x32_bf16 v[216:219], v[104:107], v[16:19], v[216:219]
    v_mfma_f32_16x16x32_bf16 v[220:223], v[108:111], v[16:19], v[220:223]
    s_waitcnt lgkmcnt(2)
    ds_read_b128 v[104:107], v252 offset:27648
    ds_read_b128 v[108:111], v252 offset:28672
    v_mfma_f32_16x16x32_bf16 v[216:219], v[192:195], v[20:23], v[216:219]
    v_mfma_f32_16x16x32_bf16 v[220:223], v[196:199], v[20:23], v[220:223]
    s_waitcnt lgkmcnt(2)
    ds_read_b128 v[192:195], v252 offset:30720
    ds_read_b128 v[196:199], v252 offset:31744
    v_mfma_f32_16x16x32_bf16 v[216:219], v[204:207], v[24:27], v[216:219]
    v_mfma_f32_16x16x32_bf16 v[220:223], v[208:211], v[24:27], v[220:223]
    s_waitcnt lgkmcnt(2)
    ds_read_b128 v[204:207], v252 offset:32768
    ds_read_b128 v[208:211], v252 offset:33792
    v_mfma_f32_16x16x32_bf16 v[216:219], v[104:107], v[28:31], v[216:219]
    v_mfma_f32_16x16x32_bf16 v[220:223], v[108:111], v[28:31], v[220:223]
    s_waitcnt lgkmcnt(2)
    ds_read_b128 v[104:107], v252 offset:35840
    ds_read_b128 v[108:111], v252 offset:36864
    v_mfma_f32_16x16x32_bf16 v[216:219], v[192:195], v[32:35], v[216:219]
    v_mfma_f32_16x16x32_bf16 v[220:223], v[196:199], v[32:35], v[220:223]
    s_waitcnt lgkmcnt(2)
    ds_read_b128 v[192:195], v252 offset:37888
    ds_read_b128 v[196:199], v252 offset:38912
    v_mfma_f32_16x16x32_bf16 v[216:219], v[204:207], v[36:39], v[216:219]
    v_mfma_f32_16x16x32_bf16 v[220:223], v[208:211], v[36:39], v[220:223]
    s_waitcnt lgkmcnt(2)
    ds_read_b128 v[204:207], v252 offset:40960
    ds_read_b128 v[208:211], v252 offset:41984
    v_mfma_f32_16x16x32_bf16 v[216:219], v[104:107], v[40:43], v[216:219]
    v_mfma_f32_16x16x32_bf16 v[220:223], v[108:111], v[40:43], v[220:223]
    s_waitcnt lgkmcnt(2)
    ds_read_b128 v[104:107], v252 offset:43008
    ds_read_b128 v[108:111], v252 offset:44032
    v_mfma_f32_16x16x32_bf16 v[216:219], v[192:195], v[44:47], v[216:219]
    v_mfma_f32_16x16x32_bf16 v[220:223], v[196:199], v[44:47], v[220:223]
    s_waitcnt lgkmcnt(2)
    v_mfma_f32_16x16x32_bf16 v[216:219], v[204:207], v[48:51], v[216:219]
    v_mfma_f32_16x16x32_bf16 v[220:223], v[208:211], v[48:51], v[220:223]
    s_waitcnt lgkmcnt(0)
    v_mfma_f32_16x16x32_bf16 v[216:219], v[104:107], v[52:55], v[216:219]
    v_mfma_f32_16x16x32_bf16 v[220:223], v[108:111], v[52:55], v[220:223]
L_m299:
    s_nop 6
    v_cvt_pk_bf16_f32 v120, v216, v217
    v_cvt_pk_bf16_f32 v121, v218, v219
    v_cvt_pk_bf16_f32 v122, v220, v221
    v_cvt_pk_bf16_f32 v123, v222, v223
    v_cvt_pk_bf16_f32 v124, v224, v225
    v_cvt_pk_bf16_f32 v125, v226, v227
    buffer_store_dwordx2 v[120:121], v249, s[68:71], s76 offen
    buffer_store_dwordx2 v[122:123], v249, s[68:71], s76 offen offset:32
    s_cmp_ge_u32 s24, 8
    s_cbranch_scc1 L_o3100
    s_mov_b32 exec_hi, 0
    buffer_store_dwordx2 v[124:125], v249, s[68:71], s76 offen offset:64
    s_mov_b64 exec, -1
L_o3100:
    s_or_b32 s12, s2, s4
    s_cmp_lg_u32 s12, 0
    s_cbranch_scc1 L_fin
    s_mov_b64 exec, 1
    v_mov_b32 v2, 0
    v_mov_b32 v3, s9
    buffer_store_dword v3, v2, s[60:63], 0 offen sc1
    s_branch L_fin
L_ftail:
    s_waitcnt lgkmcnt(0)
    v_readfirstlane_b32 s12, v125
    s_nop 0
    s_mov_b32 s77, s12
    s_cmp_eq_u32 s12, 3
    s_cbranch_scc1 L_final
    s_cmp_lg_u32 s12, 0
    s_cbranch_scc1 L_ftail3
    v_add_u32 v255, 74624, v254
    ds_read_b32 v255, v255
    v_add_u32 v242, -10240, v242
    v_add_u32 v243, -32, v243
    s_sub_u32 s73, s73, 36864
    s_sub_u32 s74, s74, 36864
    s_mov_b32 s75, 6
    s_branch L_final
    s_branch L_ftail3
L_ftail2:
    v_mov_b32 v2, 162048
    v_mov_b32 v3, 1
    s_mov_b64 exec, 1
    ds_add_u32 v2, v3
    s_mov_b64 exec, -1
L_ftail3:
    v_mov_b32 v6, v241
    v_mov_b32 v250, v240
    s_add_u32 s53, s72, 4096
    s_add_u32 s54, s72, 8192
    s_add_u32 s55, s72, 12288
    s_add_u32 s43, s72, 16384
    v_mov_b32 v88, 0
    v_mov_b32 v89, 0
    v_mov_b32 v90, 0
    v_mov_b32 v91, 0
    v_mov_b32 v92, 0
    v_mov_b32 v93, 0
    v_mov_b32 v94, 0
    v_mov_b32 v95, 0
    v_mov_b32 v96, 0
    v_mov_b32 v97, 0
    v_mov_b32 v98, 0
    v_mov_b32 v99, 0
    v_mov_b32 v2, 162072
    s_mov_b32 s82, 262144
L_ls101:
    ds_read_b32 v3, v2
    s_waitcnt lgkmcnt(0)
    v_readfirstlane_b32 s12, v3
    s_nop 0
    s_cmp_ge_u32 s12, 4
    s_cbranch_scc1 L_lo102
    s_sleep 1
    s_sub_u32 s82, s82, 1
    s_cbranch_scc0 L_ls101
L_lo102:
    v_mov_b32 v2, 162048
    ds_read_b32 v3, v2
    ds_read_b128 v[100:103], v252 offset:0
    ds_read_b128 v[104:107], v252 offset:1024
    ds_read_b128 v[112:115], v252 offset:2048
    ds_read_b128 v[116:119], v252 offset:3072
    ds_read_b128 v[124:127], v252 offset:5120
    ds_read_b128 v[128:131], v252 offset:6144
    s_cmp_ge_u32 s24, 8
    s_cbranch_scc1 L_m3103
    ds_read_b128 v[108:111], v250 offset:4096
    ds_read_b128 v[120:123], v250 offset:4608
    ds_read_b128 v[132:135], v250 offset:9216
L_m3103:
    s_waitcnt lgkmcnt(6)
    v_readfirstlane_b32 s15, v3
    s_cmp_lt_u32 s4, 0
    s_cselect_b32 s15, 4, s15
    s_cmp_lt_u32 s15, 4
    s_cbranch_scc1 L_e1
    buffer_load_dwordx4 v[16:19], v253, s[60:63], s72 offen offset:0 sc1
    buffer_load_dwordx4 v[20:23], v253, s[60:63], s72 offen offset:1024 sc1
    buffer_load_dwordx4 v[24:27], v253, s[60:63], s72 offen offset:2048 sc1
    buffer_load_dwordx4 v[28:31], v253, s[60:63], s72 offen offset:3072 sc1
    buffer_load_dwordx4 v[32:35], v253, s[60:63], s53 offen offset:0 sc1
    buffer_load_dwordx4 v[36:39], v253, s[60:63], s53 offen offset:1024 sc1
    buffer_load_dwordx4 v[40:43], v253, s[60:63], s53 offen offset:2048 sc1
    buffer_load_dwordx4 v[44:47], v253, s[60:63], s53 offen offset:3072 sc1
    buffer_load_dwordx4 v[48:51], v253, s[60:63], s54 offen offset:0 sc1
    buffer_load_dwordx4 v[52:55], v253, s[60:63], s54 offen offset:1024 sc1
    buffer_load_dwordx4 v[56:59], v253, s[60:63], s54 offen offset:2048 sc1
    buffer_load_dwordx4 v[60:63], v253, s[60:63], s54 offen offset:3072 sc1
    buffer_load_dwordx4 v[64:67], v253, s[60:63], s55 offen offset:0 sc1
    buffer_load_dwordx4 v[68:71], v253, s[60:63], s55 offen offset:1024 sc1
    buffer_load_dwordx4 v[72:75], v253, s[60:63], s55 offen offset:2048 sc1
    buffer_load_dwordx4 v[76:79], v253, s[60:63], s55 offen offset:3072 sc1
    buffer_load_dwordx2 v[80:81], v251, s[60:63], s43 offen offset:0 sc1
    buffer_load_dwordx2 v[82:83], v251, s[60:63], s43 offen offset:128 sc1
    buffer_load_dwordx2 v[84:85], v251, s[60:63], s43 offen offset:1024 sc1
    buffer_load_dwordx2 v[86:87], v251, s[60:63], s43 offen offset:1152 sc1
L_e1:
    s_waitcnt lgkmcnt(5)
    ds_read_b128 v[136:139], v252 offset:7168
    ds_read_b128 v[140:143], v252 offset:8192
    ds_read_b128 v[148:151], v252 offset:10240
    ds_read_b128 v[152:155], v252 offset:11264
    ds_read_b128 v[160:163], v252 offset:12288
    ds_read_b128 v[164:167], v252 offset:13312
    s_cmp_ge_u32 s24, 8
    s_cbranch_scc1 L_m3104
    ds_read_b128 v[144:147], v250 offset:9728
    ds_read_b128 v[156:159], v250 offset:14336
    ds_read_b128 v[168:171], v250 offset:14848
L_m3104:
    s_waitcnt lgkmcnt(5)
    ds_read_b128 v[172:175], v252 offset:15360
    ds_read_b128 v[176:179], v252 offset:16384
    ds_read_b128 v[184:187], v252 offset:17408
    ds_read_b128 v[188:191], v252 offset:18432
    ds_read_b128 v[196:199], v252 offset:20480
    ds_read_b128 v[200:203], v252 offset:21504
    s_cmp_ge_u32 s24, 8
    s_cbranch_scc1 L_m3105
    ds_read_b128 v[180:183], v250 offset:19456
    ds_read_b128 v[192:195], v250 offset:19968
    ds_read_b128 v[204:207], v250 offset:24576
L_m3105:
    s_waitcnt lgkmcnt(5)
    ds_read_b128 v[208:211], v252 offset:22528
    ds_read_b128 v[212:215], v252 offset:23552
    ds_read_b128 v[220:223], v252 offset:25600
    ds_read_b128 v[224:227], v252 offset:26624
    ds_read_b128 v[232:235], v252 offset:27648
    ds_read_b128 v[236:239], v252 offset:28672
    s_cmp_ge_u32 s24, 8
    s_cbranch_scc1 L_m3106
    ds_read_b128 v[216:219], v250 offset:25088
    ds_read_b128 v[228:231], v250 offset:29696
    ds_read_b128 v[240:243], v250 offset:30208
L_m3106:
    s_waitcnt lgkmcnt(5)
    s_mov_b32 s68, s36
    s_mov_b32 s69, s37
    s_mov_b32 s70, 2359296
    s_mov_b32 s71, 0x00020000
    s_cmp_ge_u32 s15, 4
    s_cbranch_scc1 L_e2
    v_mov_b32 v2, 162048
    s_mov_b32 s82, 262144
L_ls107:
    ds_read_b32 v3, v2
    s_waitcnt lgkmcnt(0)
    v_readfirstlane_b32 s12, v3
    s_nop 0
    s_cmp_ge_u32 s12, 4
    s_cbranch_scc1 L_lo108
    s_sleep 1
    s_sub_u32 s82, s82, 1
    s_cbranch_scc0 L_ls107
L_lo108:
    buffer_load_dwordx4 v[16:19], v253, s[60:63], s72 offen offset:0 sc1
    buffer_load_dwordx4 v[20:23], v253, s[60:63], s72 offen offset:1024 sc1
    buffer_load_dwordx4 v[24:27], v253, s[60:63], s72 offen offset:2048 sc1
    buffer_load_dwordx4 v[28:31], v253, s[60:63], s72 offen offset:3072 sc1
    buffer_load_dwordx4 v[32:35], v253, s[60:63], s53 offen offset:0 sc1
    buffer_load_dwordx4 v[36:39], v253, s[60:63], s53 offen offset:1024 sc1
    buffer_load_dwordx4 v[40:43], v253, s[60:63], s53 offen offset:2048 sc1
    buffer_load_dwordx4 v[44:47], v253, s[60:63], s53 offen offset:3072 sc1
    buffer_load_dwordx4 v[48:51], v253, s[60:63], s54 offen offset:0 sc1
    buffer_load_dwordx4 v[52:55], v253, s[60:63], s54 offen offset:1024 sc1
    buffer_load_dwordx4 v[56:59], v253, s[60:63], s54 offen offset:2048 sc1
    buffer_load_dwordx4 v[60:63], v253, s[60:63], s54 offen offset:3072 sc1
    buffer_load_dwordx4 v[64:67], v253, s[60:63], s55 offen offset:0 sc1
    buffer_load_dwordx4 v[68:71], v253, s[60:63], s55 offen offset:1024 sc1
    buffer_load_dwordx4 v[72:75], v253, s[60:63], s55 offen offset:2048 sc1
    buffer_load_dwordx4 v[76:79], v253, s[60:63], s55 offen offset:3072 sc1
    buffer_load_dwordx2 v[80:81], v251, s[60:63], s43 offen offset:0 sc1
    buffer_load_dwordx2 v[82:83], v251, s[60:63], s43 offen offset:128 sc1
    buffer_load_dwordx2 v[84:85], v251, s[60:63], s43 offen offset:1024 sc1
    buffer_load_dwordx2 v[86:87], v251, s[60:63], s43 offen offset:1152 sc1
L_e2:
    s_waitcnt lgkmcnt(0)
    s_mov_b32 s15, 0
    s_waitcnt vmcnt(17)
    v_max3_u32 v7, v19, v23, v27
    v_cmp_eq_u32 vcc, -1, v7
    s_cbranch_vccz L_g10
    s_bitset1_b32 s15, 0
    s_branch L_g20
L_g10:
    v_mfma_f32_16x16x32_bf16 v[88:91], v[100:103], v[16:19], v[88:91]
    v_mfma_f32_16x16x32_bf16 v[92:95], v[104:107], v[16:19], v[92:95]
    v_mfma_f32_16x16x32_bf16 v[88:91], v[112:115], v[20:23], v[88:91]
    v_mfma_f32_16x16x32_bf16 v[92:95], v[116:119], v[20:23], v[92:95]
    v_mfma_f32_16x16x32_bf16 v[88:91], v[124:127], v[24:27], v[88:91]
    v_mfma_f32_16x16x32_bf16 v[92:95], v[128:131], v[24:27], v[92:95]
    s_cmp_ge_u32 s24, 8
    s_cbranch_scc1 L_m3109
    v_mfma_f32_16x16x32_bf16 v[96:99], v[108:111], v[16:19], v[96:99]
    v_mfma_f32_16x16x32_bf16 v[96:99], v[120:123], v[20:23], v[96:99]
    v_mfma_f32_16x16x32_bf16 v[96:99], v[132:135], v[24:27], v[96:99]
L_m3109:
L_g20:
    s_waitcnt lgkmcnt(0)
    ds_read_b128 v[100:103], v252 offset:30720
    ds_read_b128 v[104:107], v252 offset:31744
    ds_read_b128 v[112:115], v252 offset:32768
    ds_read_b128 v[116:119], v252 offset:33792
    ds_read_b128 v[124:127], v252 offset:35840
    ds_read_b128 v[128:131], v252 offset:36864
    s_cmp_ge_u32 s24, 8
    s_cbranch_scc1 L_m3110
    ds_read_b128 v[108:111], v250 offset:34816
    ds_read_b128 v[120:123], v250 offset:35328
    ds_read_b128 v[132:135], v250 offset:39936
L_m3110:
    s_waitcnt vmcnt(14)
    v_max3_u32 v7, v31, v35, v39
    v_cmp_eq_u32 vcc, -1, v7
    s_cbranch_vccz L_g11
    s_bitset1_b32 s15, 1
    s_branch L_g21
L_g11:
    v_mfma_f32_16x16x32_bf16 v[88:91], v[136:139], v[28:31], v[88:91]
    v_mfma_f32_16x16x32_bf16 v[92:95], v[140:143], v[28:31], v[92:95]
    v_mfma_f32_16x16x32_bf16 v[88:91], v[148:151], v[32:35], v[88:91]
    v_mfma_f32_16x16x32_bf16 v[92:95], v[152:155], v[32:35], v[92:95]
    v_mfma_f32_16x16x32_bf16 v[88:91], v[160:163], v[36:39], v[88:91]
    v_mfma_f32_16x16x32_bf16 v[92:95], v[164:167], v[36:39], v[92:95]
    s_cmp_ge_u32 s24, 8
    s_cbranch_scc1 L_m3111
    v_mfma_f32_16x16x32_bf16 v[96:99], v[144:147], v[28:31], v[96:99]
    v_mfma_f32_16x16x32_bf16 v[96:99], v[156:159], v[32:35], v[96:99]
    v_mfma_f32_16x16x32_bf16 v[96:99], v[168:171], v[36:39], v[96:99]
L_m3111:
L_g21:
    s_waitcnt lgkmcnt(0)
    ds_read_b128 v[136:139], v252 offset:37888
    ds_read_b128 v[140:143], v252 offset:38912
    ds_read_b128 v[148:151], v252 offset:40960
    ds_read_b128 v[152:155], v252 offset:41984
    ds_read_b128 v[160:163], v252 offset:43008
    ds_read_b128 v[164:167], v252 offset:44032
    s_cmp_ge_u32 s24, 8
    s_cbranch_scc1 L_m3112
    ds_read_b128 v[144:147], v250 offset:40448
    ds_read_b128 v[156:159], v250 offset:45056
    ds_read_b128 v[168:171], v250 offset:45568
L_m3112:
    s_waitcnt vmcnt(11)
    v_max3_u32 v7, v43, v47, v51
    v_cmp_eq_u32 vcc, -1, v7
    s_cbranch_vccz L_g12
    s_bitset1_b32 s15, 2
    s_branch L_g22
L_g12:
    v_mfma_f32_16x16x32_bf16 v[88:91], v[172:175], v[40:43], v[88:91]
    v_mfma_f32_16x16x32_bf16 v[92:95], v[176:179], v[40:43], v[92:95]
    v_mfma_f32_16x16x32_bf16 v[88:91], v[184:187], v[44:47], v[88:91]
    v_mfma_f32_16x16x32_bf16 v[92:95], v[188:191], v[44:47], v[92:95]
    v_mfma_f32_16x16x32_bf16 v[88:91], v[196:199], v[48:51], v[88:91]
    v_mfma_f32_16x16x32_bf16 v[92:95], v[200:203], v[48:51], v[92:95]
    s_cmp_ge_u32 s24, 8
    s_cbranch_scc1 L_m3113
    v_mfma_f32_16x16x32_bf16 v[96:99], v[180:183], v[40:43], v[96:99]
    v_mfma_f32_16x16x32_bf16 v[96:99], v[192:195], v[44:47], v[96:99]
    v_mfma_f32_16x16x32_bf16 v[96:99], v[204:207], v[48:51], v[96:99]
L_m3113:
L_g22:
    s_waitcnt vmcnt(8)
    v_max3_u32 v7, v55, v59, v63
    v_cmp_eq_u32 vcc, -1, v7
    s_cbranch_vccz L_g13
    s_bitset1_b32 s15, 3
    s_branch L_g23
L_g13:
    v_mfma_f32_16x16x32_bf16 v[88:91], v[208:211], v[52:55], v[88:91]
    v_mfma_f32_16x16x32_bf16 v[92:95], v[212:215], v[52:55], v[92:95]
    v_mfma_f32_16x16x32_bf16 v[88:91], v[220:223], v[56:59], v[88:91]
    v_mfma_f32_16x16x32_bf16 v[92:95], v[224:227], v[56:59], v[92:95]
    v_mfma_f32_16x16x32_bf16 v[88:91], v[232:235], v[60:63], v[88:91]
    v_mfma_f32_16x16x32_bf16 v[92:95], v[236:239], v[60:63], v[92:95]
    s_cmp_ge_u32 s24, 8
    s_cbranch_scc1 L_m3114
    v_mfma_f32_16x16x32_bf16 v[96:99], v[216:219], v[52:55], v[96:99]
    v_mfma_f32_16x16x32_bf16 v[96:99], v[228:231], v[56:59], v[96:99]
    v_mfma_f32_16x16x32_bf16 v[96:99], v[240:243], v[60:63], v[96:99]
L_m3114:
L_g23:
    s_waitcnt vmcnt(5)
    v_max3_u32 v7, v67, v71, v75
    v_cmp_eq_u32 vcc, -1, v7
    s_cbranch_vccz L_g14
    s_bitset1_b32 s15, 4
    s_branch L_g24
L_g14:
    s_waitcnt lgkmcnt(0)
    v_mfma_f32_16x16x32_bf16 v[88:91], v[100:103], v[64:67], v[88:91]
    v_mfma_f32_16x16x32_bf16 v[92:95], v[104:107], v[64:67], v[92:95]
    v_mfma_f32_16x16x32_bf16 v[88:91], v[112:115], v[68:71], v[88:91]
    v_mfma_f32_16x16x32_bf16 v[92:95], v[116:119], v[68:71], v[92:95]
    v_mfma_f32_16x16x32_bf16 v[88:91], v[124:127], v[72:75], v[88:91]
    v_mfma_f32_16x16x32_bf16 v[92:95], v[128:131], v[72:75], v[92:95]
    s_cmp_ge_u32 s24, 8
    s_cbranch_scc1 L_m3115
    v_mfma_f32_16x16x32_bf16 v[96:99], v[108:111], v[64:67], v[96:99]
    v_mfma_f32_16x16x32_bf16 v[96:99], v[120:123], v[68:71], v[96:99]
    v_mfma_f32_16x16x32_bf16 v[96:99], v[132:135], v[72:75], v[96:99]
L_m3115:
L_g24:
    s_waitcnt vmcnt(0)
    v_max3_u32 v7, v79, v80, v81
    v_max3_u32 v7, v7, v82, v83
    v_max3_u32 v7, v7, v84, v85
    v_max3_u32 v7, v7, v86, v87
    v_cmp_eq_u32 vcc, -1, v7
    s_cbranch_vccz L_g15
    s_bitset1_b32 s15, 5
    s_branch L_g25
L_g15:
    s_waitcnt lgkmcnt(0)
    v_mfma_f32_16x16x32_bf16 v[88:91], v[136:139], v[76:79], v[88:91]
    v_mfma_f32_16x16x32_bf16 v[92:95], v[140:143], v[76:79], v[92:95]
    v_mfma_f32_16x16x32_bf16 v[88:91], v[148:151], v[80:83], v[88:91]
    v_mfma_f32_16x16x32_bf16 v[92:95], v[152:155], v[80:83], v[92:95]
    v_mfma_f32_16x16x32_bf16 v[88:91], v[160:163], v[84:87], v[88:91]
    v_mfma_f32_16x16x32_bf16 v[92:95], v[164:167], v[84:87], v[92:95]
    s_cmp_ge_u32 s24, 8
    s_cbranch_scc1 L_m3116
    v_mfma_f32_16x16x32_bf16 v[96:99], v[144:147], v[76:79], v[96:99]
    v_mfma_f32_16x16x32_bf16 v[96:99], v[156:159], v[80:83], v[96:99]
    v_mfma_f32_16x16x32_bf16 v[96:99], v[168:171], v[84:87], v[96:99]
L_m3116:
L_g25:
    s_mov_b32 s82, 262144
    s_mov_b32 s14, 0
L_gp:
    s_cmp_eq_u32 s15, 0
    s_cbranch_scc1 L_gdone
    s_sleep 2
    s_bitcmp0_b32 s15, 0
    s_cbranch_scc1 L_g30
    buffer_load_dwordx4 v[16:19], v253, s[60:63], s72 offen offset:0 sc1
    buffer_load_dwordx4 v[20:23], v253, s[60:63], s72 offen offset:1024 sc1
    buffer_load_dwordx4 v[24:27], v253, s[60:63], s72 offen offset:2048 sc1
    s_bitcmp1_b32 s15, 2
    s_cbranch_scc1 L_g30
    s_bitcmp1_b32 s14, 0
    s_cbranch_scc1 L_g30
    s_bitset1_b32 s14, 0
    s_waitcnt lgkmcnt(0)
    ds_read_b128 v[172:175], v252 offset:0
    ds_read_b128 v[176:179], v252 offset:1024
    ds_read_b128 v[184:187], v252 offset:2048
    ds_read_b128 v[188:191], v252 offset:3072
    ds_read_b128 v[196:199], v252 offset:5120
    ds_read_b128 v[200:203], v252 offset:6144
    s_cmp_ge_u32 s24, 8
    s_cbranch_scc1 L_m3117
    ds_read_b128 v[180:183], v250 offset:4096
    ds_read_b128 v[192:195], v250 offset:4608
    ds_read_b128 v[204:207], v250 offset:9216
L_m3117:
L_g30:
    s_bitcmp0_b32 s15, 1
    s_cbranch_scc1 L_g31
    buffer_load_dwordx4 v[28:31], v253, s[60:63], s72 offen offset:3072 sc1
    buffer_load_dwordx4 v[32:35], v253, s[60:63], s53 offen offset:0 sc1
    buffer_load_dwordx4 v[36:39], v253, s[60:63], s53 offen offset:1024 sc1
    s_bitcmp1_b32 s15, 3
    s_cbranch_scc1 L_g31
    s_bitcmp1_b32 s14, 1
    s_cbranch_scc1 L_g31
    s_bitset1_b32 s14, 1
    s_waitcnt lgkmcnt(0)
    ds_read_b128 v[208:211], v252 offset:7168
    ds_read_b128 v[212:215], v252 offset:8192
    ds_read_b128 v[220:223], v252 offset:10240
    ds_read_b128 v[224:227], v252 offset:11264
    ds_read_b128 v[232:235], v252 offset:12288
    ds_read_b128 v[236:239], v252 offset:13312
    s_cmp_ge_u32 s24, 8
    s_cbranch_scc1 L_m3118
    ds_read_b128 v[216:219], v250 offset:9728
    ds_read_b128 v[228:231], v250 offset:14336
    ds_read_b128 v[240:243], v250 offset:14848
L_m3118:
L_g31:
    s_bitcmp0_b32 s15, 2
    s_cbranch_scc1 L_g32
    buffer_load_dwordx4 v[40:43], v253, s[60:63], s53 offen offset:2048 sc1
    buffer_load_dwordx4 v[44:47], v253, s[60:63], s53 offen offset:3072 sc1
    buffer_load_dwordx4 v[48:51], v253, s[60:63], s54 offen offset:0 sc1
L_g32:
    s_bitcmp0_b32 s15, 3
    s_cbranch_scc1 L_g33
    buffer_load_dwordx4 v[52:55], v253, s[60:63], s54 offen offset:1024 sc1
    buffer_load_dwordx4 v[56:59], v253, s[60:63], s54 offen offset:2048 sc1
    buffer_load_dwordx4 v[60:63], v253, s[60:63], s54 offen offset:3072 sc1
L_g33:
    s_bitcmp0_b32 s15, 4
    s_cbranch_scc1 L_g34
    buffer_load_dwordx4 v[64:67], v253, s[60:63], s55 offen offset:0 sc1
    buffer_load_dwordx4 v[68:71], v253, s[60:63], s55 offen offset:1024 sc1
    buffer_load_dwordx4 v[72:75], v253, s[60:63], s55 offen offset:2048 sc1
L_g34:
    s_bitcmp0_b32 s15, 5
    s_cbranch_scc1 L_g35
    buffer_load_dwordx4 v[76:79], v253, s[60:63], s55 offen offset:3072 sc1
    buffer_load_dwordx2 v[80:81], v251, s[60:63], s43 offen offset:0 sc1
    buffer_load_dwordx2 v[82:83], v251, s[60:63], s43 offen offset:128 sc1
    buffer_load_dwordx2 v[84:85], v251, s[60:63], s43 offen offset:1024 sc1
    buffer_load_dwordx2 v[86:87], v251, s[60:63], s43 offen offset:1152 sc1
L_g35:
    s_sub_u32 s82, s82, 1
    s_cselect_b32 s13, 1, 0
    s_add_u32 s82, s82, s13
    s_waitcnt vmcnt(0) lgkmcnt(0)
    s_bitcmp0_b32 s15, 2
    s_cbranch_scc1 L_g42
    v_max3_u32 v7, v43, v47, v51
    v_cmp_eq_u32 vcc, -1, v7
    s_cbranch_vccz L_g52
    s_cmp_eq_u32 s13, 0
    s_cbranch_scc1 L_g42
L_g52:
    s_bitset0_b32 s15, 2
    v_mfma_f32_16x16x32_bf16 v[88:91], v[172:175], v[40:43], v[88:91]
    v_mfma_f32_16x16x32_bf16 v[92:95], v[176:179], v[40:43], v[92:95]
    v_mfma_f32_16x16x32_bf16 v[88:91], v[184:187], v[44:47], v[88:91]
    v_mfma_f32_16x16x32_bf16 v[92:95], v[188:191], v[44:47], v[92:95]
    v_mfma_f32_16x16x32_bf16 v[88:91], v[196:199], v[48:51], v[88:91]
    v_mfma_f32_16x16x32_bf16 v[92:95], v[200:203], v[48:51], v[92:95]
    s_cmp_ge_u32 s24, 8
    s_cbranch_scc1 L_m3119
    v_mfma_f32_16x16x32_bf16 v[96:99], v[180:183], v[40:43], v[96:99]
    v_mfma_f32_16x16x32_bf16 v[96:99], v[192:195], v[44:47], v[96:99]
    v_mfma_f32_16x16x32_bf16 v[96:99], v[204:207], v[48:51], v[96:99]
L_m3119:
    s_bitcmp0_b32 s15, 0
    s_cbranch_scc1 L_g42
    s_bitset1_b32 s14, 0
    s_waitcnt lgkmcnt(0)
    ds_read_b128 v[172:175], v252 offset:0
    ds_read_b128 v[176:179], v252 offset:1024
    ds_read_b128 v[184:187], v252 offset:2048
    ds_read_b128 v[188:191], v252 offset:3072
    ds_read_b128 v[196:199], v252 offset:5120
    ds_read_b128 v[200:203], v252 offset:6144
    s_cmp_ge_u32 s24, 8
    s_cbranch_scc1 L_m3120
    ds_read_b128 v[180:183], v250 offset:4096
    ds_read_b128 v[192:195], v250 offset:4608
    ds_read_b128 v[204:207], v250 offset:9216
L_m3120:
L_g42:
    s_bitcmp0_b32 s15, 3
    s_cbranch_scc1 L_g43
    v_max3_u32 v7, v55, v59, v63
    v_cmp_eq_u32 vcc, -1, v7
    s_cbranch_vccz L_g53
    s_cmp_eq_u32 s13, 0
    s_cbranch_scc1 L_g43
L_g53:
    s_bitset0_b32 s15, 3
    v_mfma_f32_16x16x32_bf16 v[88:91], v[208:211], v[52:55], v[88:91]
    v_mfma_f32_16x16x32_bf16 v[92:95], v[212:215], v[52:55], v[92:95]
    v_mfma_f32_16x16x32_bf16 v[88:91], v[220:223], v[56:59], v[88:91]
    v_mfma_f32_16x16x32_bf16 v[92:95], v[224:227], v[56:59], v[92:95]
    v_mfma_f32_16x16x32_bf16 v[88:91], v[232:235], v[60:63], v[88:91]
    v_mfma_f32_16x16x32_bf16 v[92:95], v[236:239], v[60:63], v[92:95]
    s_cmp_ge_u32 s24, 8
    s_cbranch_scc1 L_m3121
    v_mfma_f32_16x16x32_bf16 v[96:99], v[216:219], v[52:55], v[96:99]
    v_mfma_f32_16x16x32_bf16 v[96:99], v[228:231], v[56:59], v[96:99]
    v_mfma_f32_16x16x32_bf16 v[96:99], v[240:243], v[60:63], v[96:99]
L_m3121:
    s_bitcmp0_b32 s15, 1
    s_cbranch_scc1 L_g43
    s_bitset1_b32 s14, 1
    s_waitcnt lgkmcnt(0)
    ds_read_b128 v[208:211], v252 offset:7168
    ds_read_b128 v[212:215], v252 offset:8192
    ds_read_b128 v[220:223], v252 offset:10240
    ds_read_b128 v[224:227], v252 offset:11264
    ds_read_b128 v[232:235], v252 offset:12288
    ds_read_b128 v[236:239], v252 offset:13312
    s_cmp_ge_u32 s24, 8
    s_cbranch_scc1 L_m3122
    ds_read_b128 v[216:219], v250 offset:9728
    ds_read_b128 v[228:231], v250 offset:14336
    ds_read_b128 v[240:243], v250 offset:14848
L_m3122:
L_g43:
    s_bitcmp0_b32 s15, 4
    s_cbranch_scc1 L_g44
    v_max3_u32 v7, v67, v71, v75
    v_cmp_eq_u32 vcc, -1, v7
    s_cbranch_vccz L_g54
    s_cmp_eq_u32 s13, 0
    s_cbranch_scc1 L_g44
L_g54:
    s_bitset0_b32 s15, 4
    v_mfma_f32_16x16x32_bf16 v[88:91], v[100:103], v[64:67], v[88:91]
    v_mfma_f32_16x16x32_bf16 v[92:95], v[104:107], v[64:67], v[92:95]
    v_mfma_f32_16x16x32_bf16 v[88:91], v[112:115], v[68:71], v[88:91]
    v_mfma_f32_16x16x32_bf16 v[92:95], v[116:119], v[68:71], v[92:95]
    v_mfma_f32_16x16x32_bf16 v[88:91], v[124:127], v[72:75], v[88:91]
    v_mfma_f32_16x16x32_bf16 v[92:95], v[128:131], v[72:75], v[92:95]
    s_cmp_ge_u32 s24, 8
    s_cbranch_scc1 L_m3123
    v_mfma_f32_16x16x32_bf16 v[96:99], v[108:111], v[64:67], v[96:99]
    v_mfma_f32_16x16x32_bf16 v[96:99], v[120:123], v[68:71], v[96:99]
    v_mfma_f32_16x16x32_bf16 v[96:99], v[132:135], v[72:75], v[96:99]
L_m3123:
L_g44:
    s_bitcmp0_b32 s15, 5
    s_cbranch_scc1 L_g45
    v_max3_u32 v7, v79, v80, v81
    v_max3_u32 v7, v7, v82, v83
    v_max3_u32 v7, v7, v84, v85
    v_max3_u32 v7, v7, v86, v87
    v_cmp_eq_u32 vcc, -1, v7
    s_cbranch_vccz L_g55
    s_cmp_eq_u32 s13, 0
    s_cbranch_scc1 L_g45
L_g55:
    s_bitset0_b32 s15, 5
    v_mfma_f32_16x16x32_bf16 v[88:91], v[136:139], v[76:79], v[88:91]
    v_mfma_f32_16x16x32_bf16 v[92:95], v[140:143], v[76:79], v[92:95]
    v_mfma_f32_16x16x32_bf16 v[88:91], v[148:151], v[80:83], v[88:91]
    v_mfma_f32_16x16x32_bf16 v[92:95], v[152:155], v[80:83], v[92:95]
    v_mfma_f32_16x16x32_bf16 v[88:91], v[160:163], v[84:87], v[88:91]
    v_mfma_f32_16x16x32_bf16 v[92:95], v[164:167], v[84:87], v[92:95]
    s_cmp_ge_u32 s24, 8
    s_cbranch_scc1 L_m3124
    v_mfma_f32_16x16x32_bf16 v[96:99], v[144:147], v[76:79], v[96:99]
    v_mfma_f32_16x16x32_bf16 v[96:99], v[156:159], v[80:83], v[96:99]
    v_mfma_f32_16x16x32_bf16 v[96:99], v[168:171], v[84:87], v[96:99]
L_m3124:
L_g45:
    s_bitcmp0_b32 s15, 0
    s_cbranch_scc1 L_g40
    s_bitcmp0_b32 s14, 0
    s_cbranch_scc1 L_g40
    v_max3_u32 v7, v19, v23, v27
    v_cmp_eq_u32 vcc, -1, v7
    s_cbranch_vccz L_g50
    s_cmp_eq_u32 s13, 0
    s_cbranch_scc1 L_g40
L_g50:
    s_bitset0_b32 s15, 0
    s_waitcnt lgkmcnt(0)
    v_mfma_f32_16x16x32_bf16 v[88:91], v[172:175], v[16:19], v[88:91]
    v_mfma_f32_16x16x32_bf16 v[92:95], v[176:179], v[16:19], v[92:95]
    v_mfma_f32_16x16x32_bf16 v[88:91], v[184:187], v[20:23], v[88:91]
    v_mfma_f32_16x16x32_bf16 v[92:95], v[188:191], v[20:23], v[92:95]
    v_mfma_f32_16x16x32_bf16 v[88:91], v[196:199], v[24:27], v[88:91]
    v_mfma_f32_16x16x32_bf16 v[92:95], v[200:203], v[24:27], v[92:95]
    s_cmp_ge_u32 s24, 8
    s_cbranch_scc1 L_m3125
    v_mfma_f32_16x16x32_bf16 v[96:99], v[180:183], v[16:19], v[96:99]
    v_mfma_f32_16x16x32_bf16 v[96:99], v[192:195], v[20:23], v[96:99]
    v_mfma_f32_16x16x32_bf16 v[96:99], v[204:207], v[24:27], v[96:99]
L_m3125:
L_g40:
    s_bitcmp0_b32 s15, 1
    s_cbranch_scc1 L_g41
    s_bitcmp0_b32 s14, 1
    s_cbranch_scc1 L_g41
    v_max3_u32 v7, v31, v35, v39
    v_cmp_eq_u32 vcc, -1, v7
    s_cbranch_vccz L_g51
    s_cmp_eq_u32 s13, 0
    s_cbranch_scc1 L_g41
L_g51:
    s_bitset0_b32 s15, 1
    s_waitcnt lgkmcnt(0)
    v_mfma_f32_16x16x32_bf16 v[88:91], v[208:211], v[28:31], v[88:91]
    v_mfma_f32_16x16x32_bf16 v[92:95], v[212:215], v[28:31], v[92:95]
    v_mfma_f32_16x16x32_bf16 v[88:91], v[220:223], v[32:35], v[88:91]
    v_mfma_f32_16x16x32_bf16 v[92:95], v[224:227], v[32:35], v[92:95]
    v_mfma_f32_16x16x32_bf16 v[88:91], v[232:235], v[36:39], v[88:91]
    v_mfma_f32_16x16x32_bf16 v[92:95], v[236:239], v[36:39], v[92:95]
    s_cmp_ge_u32 s24, 8
    s_cbranch_scc1 L_m3126
    v_mfma_f32_16x16x32_bf16 v[96:99], v[216:219], v[28:31], v[96:99]
    v_mfma_f32_16x16x32_bf16 v[96:99], v[228:231], v[32:35], v[96:99]
    v_mfma_f32_16x16x32_bf16 v[96:99], v[240:243], v[36:39], v[96:99]
L_m3126:
L_g41:
    s_branch L_gp
L_gdone:
    s_lshl_b32 s13, s10, 2
    s_add_u32 s13, s13, 162080
    v_mov_b32 v2, s13
    s_mov_b32 s82, 262144
L_ls127:
    ds_read_b32 v3, v2
    ds_read_b128 v[16:19], v6 offset:0
    ds_read_b128 v[20:23], v6 offset:1024
    ds_read_b128 v[24:27], v6 offset:2048
    s_waitcnt lgkmcnt(0)
    v_cmp_eq_u32 vcc, 0, v3
    s_cbranch_vccz L_lo128
    s_sleep 1
    s_sub_u32 s82, s82, 1
    s_cbranch_scc0 L_ls127
L_lo128:
    v_add_f32 v88, v88, v16
    v_add_f32 v89, v89, v17
    v_add_f32 v90, v90, v18
    v_add_f32 v91, v91, v19
    v_add_f32 v92, v92, v20
    v_add_f32 v93, v93, v21
    v_add_f32 v94, v94, v22
    v_add_f32 v95, v95, v23
    v_add_f32 v96, v96, v24
    v_add_f32 v97, v97, v25
    v_add_f32 v98, v98, v26
    v_add_f32 v99, v99, v27
    v_cvt_pk_bf16_f32 v28, v88, v89
    v_cvt_pk_bf16_f32 v29, v90, v91
    v_cvt_pk_bf16_f32 v30, v92, v93
    v_cvt_pk_bf16_f32 v31, v94, v95
    v_cvt_pk_bf16_f32 v32, v96, v97
    v_cvt_pk_bf16_f32 v33, v98, v99
    buffer_store_dwordx2 v[28:29], v249, s[68:71], s76 offen
    buffer_store_dwordx2 v[30:31], v249, s[68:71], s76 offen offset:32
    s_cmp_ge_u32 s24, 8
    s_cbranch_scc1 L_o3129
    s_mov_b32 exec_hi, 0
    buffer_store_dwordx2 v[32:33], v249, s[68:71], s76 offen offset:64
    s_mov_b64 exec, -1
L_o3129:
    s_branch L_fin
L_slow:
    v_and_b32 v9, 31, v1
    v_lshrrev_b32 v10, 5, v1
    v_lshlrev_b32 v10, 4, v10
    s_mul_i32 s12, s75, 1536
    s_add_u32 s12, s12, 61440
    v_mul_u32_u24 v11, 48, v9
    v_add_u32 v11, s12, v11
    v_add_u32 v13, v11, v10
    ds_read_b128 v[4:7], v13
    ds_read_b32 v2, v11 offset:32
    v_mov_b32 v3, 0
    v_mov_b32 v15, 0x3f803f80
    v_mov_b32 v8, 0xff800000
    v_mov_b32 v9, 0xdddddddd
    s_mov_b32 s3, 0
L_spass:
    v_mov_b32 v160, 0
    v_mov_b32 v161, 0
    v_mov_b32 v162, 0
    v_mov_b32 v163, 0
    v_mov_b32 v164, 0
    v_mov_b32 v165, 0
    v_mov_b32 v166, 0
    v_mov_b32 v167, 0
    v_mov_b32 v168, 0
    v_mov_b32 v169, 0
    v_mov_b32 v170, 0
    v_mov_b32 v171, 0
    v_mov_b32 v172, 0
    v_mov_b32 v173, 0
    v_mov_b32 v174, 0
    v_mov_b32 v175, 0
    s_mov_b32 s12, 65536
    s_mov_b32 s13, 131072
    s_mov_b32 s14, 163840
L_sloop:
    buffer_load_dwordx4 v[208:211], v245, s[60:63], s12 offen sc1
    buffer_load_dwordx4 v[212:215], v245, s[60:63], s12 offen offset:512 sc1
    buffer_load_dword v14, v246, s[60:63], s13 offen sc1
    buffer_load_dwordx4 v[216:219], v247, s[60:63], s14 offen offset:0 sc1
    buffer_load_dwordx4 v[220:223], v247, s[60:63], s14 offen offset:256 sc1
    buffer_load_dwordx4 v[224:227], v247, s[60:63], s14 offen offset:512 sc1
    buffer_load_dwordx4 v[228:231], v247, s[60:63], s14 offen offset:768 sc1
    s_waitcnt vmcnt(0) lgkmcnt(0)
    v_mfma_f32_32x32x4_2b_bf16 v[176:207], v[14:15], v[2:3], 0
    s_nop 15
    s_nop 1
    v_mfma_f32_32x32x16_bf16 v[176:191], v[208:211], v[4:7], v[176:191]
    v_mfma_f32_32x32x16_bf16 v[192:207], v[212:215], v[4:7], v[192:207]
    s_nop 10
    v_max3_f32 v8, v8, v176, v177
    v_max3_f32 v8, v8, v178, v179
    v_max3_f32 v8, v8, v180, v181
    v_max3_f32 v8, v8, v182, v183
    v_max3_f32 v8, v8, v184, v185
    v_max3_f32 v8, v8, v186, v187
    v_max3_f32 v8, v8, v188, v189
    v_max3_f32 v8, v8, v190, v191
    v_max3_f32 v8, v8, v192, v193
    v_max3_f32 v8, v8, v194, v195
    v_max3_f32 v8, v8, v196, v197
    v_max3_f32 v8, v8, v198, v199
    v_max3_f32 v8, v8, v200, v201
    v_max3_f32 v8, v8, v202, v203
    v_max3_f32 v8, v8, v204, v205
    v_max3_f32 v8, v8, v206, v207
    v_exp_f32 v176, v176
    v_exp_f32 v177, v177
    v_exp_f32 v178, v178
    v_exp_f32 v179, v179
    v_exp_f32 v180, v180
    v_exp_f32 v181, v181
    v_exp_f32 v182, v182
    v_exp_f32 v183, v183
    v_exp_f32 v184, v184
    v_exp_f32 v185, v185
    v_exp_f32 v186, v186
    v_exp_f32 v187, v187
    v_exp_f32 v188, v188
    v_exp_f32 v189, v189
    v_exp_f32 v190, v190
    v_exp_f32 v191, v191
    v_exp_f32 v192, v192
    v_exp_f32 v193, v193
    v_exp_f32 v194, v194
    v_exp_f32 v195, v195
    v_exp_f32 v196, v196
    v_exp_f32 v197, v197
    v_exp_f32 v198, v198
    v_exp_f32 v199, v199
    v_exp_f32 v200, v200
    v_exp_f32 v201, v201
    v_exp_f32 v202, v202
    v_exp_f32 v203, v203
    v_exp_f32 v204, v204
    v_exp_f32 v205, v205
    v_exp_f32 v206, v206
    v_exp_f32 v207, v207
    v_smfmac_f32_32x32x32_bf16 v[160:175], v[216:219], v[176:183], v9
    v_smfmac_f32_32x32x32_bf16 v[160:175], v[220:223], v[184:191], v9
    v_smfmac_f32_32x32x32_bf16 v[160:175], v[224:227], v[192:199], v9
    v_smfmac_f32_32x32x32_bf16 v[160:175], v[228:231], v[200:207], v9
    s_add_u32 s12, s12, 1024
    s_add_u32 s13, s13, 256
    s_add_u32 s14, s14, 1024
    s_cmp_lt_u32 s12, 98304
    s_nop 7
    s_cbranch_scc1 L_sloop
    s_cmp_eq_u32 s3, 1
    s_cbranch_scc1 L_sdone
    v_mov_b32 v13, v8
    s_nop 1
    v_permlane32_swap_b32 v8, v13
    v_max_f32 v8, v8, v13
    v_and_b32 v13, 0xffff0000, v8
    v_sub_f32 v11, v8, v13
    v_cvt_pk_bf16_f32 v3, -v13, -v11
    s_mov_b32 s3, 1
    s_branch L_spass
L_sdone:
    v_mov_b32 v170, v168
    v_mov_b32 v13, v168
    s_nop 1
    v_permlane32_swap_b32 v13, v170
    v_rcp_f32 v12, v170
    s_branch L_fnorm
L_fin:
L_end:
    s_endpgm
.section .rodata,"a"
.p2align 6
.amdhsa_kernel gated_mix__linear_kernel_hedgehog__grouped_kv_mqa__prompt_kernel
  .amdhsa_next_free_vgpr 256
  .amdhsa_next_free_sgpr 102
  .amdhsa_accum_offset 256
  .amdhsa_group_segment_fixed_size 0
  .amdhsa_kernarg_size 104
  .amdhsa_user_sgpr_count 2
  .amdhsa_user_sgpr_kernarg_segment_ptr 1
  .amdhsa_system_sgpr_workgroup_id_x 1
.end_amdhsa_kernel
```
